```python
import torch

def _softmax(x, axis=-1):
    return torch.softmax(x, dim=axis)
def _gelu(x):
    return torch.nn.functional.gelu(x, approximate="tanh")
def _silu(x):
    return torch.nn.functional.silu(x)
def _sigmoid(x):
    return torch.sigmoid(x)
def _layernorm(x, axis=-1, eps=1e-5):
    m = x.mean(dim=axis, keepdim=True)
    v = x.var(dim=axis, keepdim=True, unbiased=False)
    return (x - m) / torch.sqrt(v + eps)
def _scatter_add(tgt, idx, src, axis=0):
    return tgt.clone().index_add_(axis, idx, src)
def _segment_sum(src, seg, n):
    out = torch.zeros((n,) + src.shape[1:], dtype=src.dtype)
    return out.index_add_(0, seg, src)
def _pad(x, pw):
    flat = tuple(v for pair in reversed(pw) for v in pair)
    return torch.nn.functional.pad(x, flat)

kernel_name = 'interleave_layers__spectral_fnet__dense_activation_relu__prompt'

def setup_inputs():

    _w = (lambda a: (lambda t: t.to(torch.bfloat16) if t.is_floating_point() else t)(torch.as_tensor(a)))
    def _A_setup():
        B, S, D = 1, 2048, 576
        ns = torch.arange(S)[:, None] * torch.arange(S)[None, :]
        nd = torch.arange(D)[:, None] * torch.arange(D)[None, :]
        Ws_re = torch.cos(-2.0 * torch.pi * ns / S).to(float)
        Ws_im = torch.sin(-2.0 * torch.pi * ns / S).to(float)
        Wd_re = torch.cos(-2.0 * torch.pi * nd / D).to(float)
        Wd_im = torch.sin(-2.0 * torch.pi * nd / D).to(float)
        return {
            "x": _w((lambda *s: torch.randn(*s, dtype=torch.bfloat16) * 0.05)(B, S, D)),
            "dft_seq_re": _w(Ws_re),
            "dft_seq_im": _w(Ws_im),
            "dft_hid_re": _w(Wd_re),
            "dft_hid_im": _w(Wd_im),
        }
    _A_in = _A_setup()

    def _B_setup():
        B, S, D, Dff = 1, 2048, 576, 4608
        return {
            "x": _w((lambda *s: torch.randn(*s, dtype=torch.bfloat16) * 0.05)(B, S, D)),
            "w1": _w((lambda *s: torch.randn(*s, dtype=torch.bfloat16) * 1.6)(D, Dff)),
            "w2": _w((lambda *s: torch.randn(*s, dtype=torch.bfloat16) * 1.6)(Dff, D)),
        }
    _B_in = _B_setup()

    return {
        "A_x": _A_in["x"],
        "A_dft_seq_re": _A_in["dft_seq_re"],
        "A_dft_seq_im": _A_in["dft_seq_im"],
        "A_dft_hid_re": _A_in["dft_hid_re"],
        "A_dft_hid_im": _A_in["dft_hid_im"],
        "B_x": _B_in["x"],
        "B_w1": _B_in["w1"],
        "B_w2": _B_in["w2"],
    }

def reference(A_x, A_dft_seq_re, A_dft_seq_im, A_dft_hid_re, A_dft_hid_im, B_x, B_w1, B_w2):
    def _A_ref(x, dft_seq_re, dft_seq_im, dft_hid_re, dft_hid_im):
        a = torch.einsum("bsd,ed->bse", x, dft_hid_re)
        b = torch.einsum("bsd,ed->bse", x, dft_hid_im)
        y = torch.einsum("ts,bse->bte", dft_seq_re, a) - torch.einsum("ts,bse->bte", dft_seq_im, b)
        return y

    def _B_ref(x, w1, w2):
        h = torch.einsum("bsd,df->bsf", x, w1)
        zero = torch.zeros_like(h)
        h = torch.maximum(h, zero)
        return torch.einsum("bsf,fd->bsd", h, w2)

    x = A_x
    x = x + _A_ref(_layernorm(x, axis=-1), A_dft_seq_re, A_dft_seq_im, A_dft_hid_re, A_dft_hid_im)
    x = x + _B_ref(_layernorm(x, axis=-1), B_w1, B_w2)
    x = x + _A_ref(_layernorm(x, axis=-1), A_dft_seq_re, A_dft_seq_im, A_dft_hid_re, A_dft_hid_im)
    x = x + _B_ref(_layernorm(x, axis=-1), B_w1, B_w2)
    return x
```

```asm
; @launch kernel=row1_kernel grid=(256,1,1) block=(576,1,1) lds=76032
; @launch kernel=sf_kernel grid=(256,1,1) block=(256,1,1) lds=147456
; @launch kernel=row2_kernel grid=(256,1,1) block=(576,1,1) lds=39168
; @launch kernel=sf_kernel grid=(256,1,1) block=(256,1,1) lds=147456
.amdgcn_target "amdgcn-amd-amdhsa--gfx950"
.text
.globl row1_kernel
.p2align 8
.type row1_kernel,@function
row1_kernel:
    s_cmp_ge_u32 s2, 256
    s_cbranch_scc1 row1_kernel_end
    s_load_dwordx2 s[4:5], s[0:1], 80
    s_load_dwordx2 s[6:7], s[0:1], 0
    s_load_dwordx4 s[40:43], s[0:1], 48
    v_lshrrev_b32 v1, 3, v0
    v_and_b32 v2, 7, v0
    v_lshrrev_b32 v4, 6, v0
    v_lshlrev_b32 v3, 8, v1
    v_readfirstlane_b32 s20, v4
    v_lshl_add_u32 v3, v2, 4, v3
    v_and_b32 v4, 63, v0
    s_lshr_b32 s21, s2, 1
    s_mul_i32 s21, s21, 18432
    s_and_b32 s22, s2, 1
    s_lshl_b32 s22, s22, 7
    s_add_u32 s21, s21, s22
    s_and_b32 s23, s2, 127
    s_lshl_b32 s23, s23, 2
    s_lshr_b32 s24, s2, 7
    s_add_u32 s23, s23, s24
    s_mov_b32 s30, 0x3ae38e39
    s_mov_b32 s31, 0x3727c5ac
    s_mov_b32 s32, 0xffff0000
    s_mov_b32 s33, 0x3b638e39
    v_and_b32 v5, 1, v2
    v_lshl_add_u32 v5, v5, 1, s23
    v_lshrrev_b32 v6, 1, v2
    v_sub_u32 v7, 0, v5
    v_add_u32 v28, 1, v6
    v_and_b32 v28, 2, v28
    v_cmp_ne_u32 vcc, 0, v28
    v_mov_b32 v29, 1024
    v_lshlrev_b32 v28, 10, v6
    v_cndmask_b32 v7, v5, v7, vcc
    v_cmp_eq_u32 vcc, 3, v6
    s_nop 1
    v_cndmask_b32 v28, v28, v29, vcc
    v_add_u32 v7, v7, v28
    v_cmp_eq_u32 vcc, 0, v5
    v_lshlrev_b32 v28, 9, v6
    s_nop 0
    v_cndmask_b32 v7, v7, v28, vcc
    v_mul_u32_u24 v7, 1152, v7
    v_lshl_add_u32 v7, v1, 4, v7
    s_waitcnt lgkmcnt(0)
    s_mov_b32 s8, s6
    s_mov_b32 s9, s7
    s_mov_b32 s10, 2359296
    s_mov_b32 s11, 0x20000
    buffer_load_dwordx4 v[8:11], v7, s[8:11], 0 offen
    s_add_u32 s16, s4, 211943424
    s_addc_u32 s17, s5, 0
    s_mov_b32 s18, 2359296
    s_mov_b32 s19, 0x20000
    s_add_u32 s36, s4, 216662016
    s_addc_u32 s37, s5, 0
    s_mov_b32 s38, 1181696
    s_mov_b32 s39, 0x20000
    s_cmp_lg_u32 s2, 255
    s_cbranch_scc1 row1_kernel_nz
    v_lshlrev_b32 v20, 3, v0
    v_mov_b32 v22, 0
    v_mov_b32 v23, 0
    s_add_u32 s44, s4, 236718080
    s_addc_u32 s45, s5, 0
    s_mov_b32 s46, 8192
    s_mov_b32 s47, 0x20000
    buffer_store_dwordx2 v[22:23], v20, s[44:47], 0 offen
row1_kernel_nz:
    v_lshlrev_b32 v144, 3, v1
    v_cmp_le_u32 vcc, 36, v1
    v_subrev_u32 v145, 287, v144
    v_mov_b32 v28, 288
    v_cndmask_b32 v144, v144, v145, vcc
    v_cmp_eq_u32 vcc, 0, v1
    v_sub_u32 v145, 570, v144
    v_sub_u32 v147, 576, v144
    v_mov_b32 v29, 0
    v_cndmask_b32 v146, v144, v28, vcc
    v_cndmask_b32 v147, v147, v29, vcc
    v_mul_u32_u24 v28, 1168, v2
    v_lshl_add_u32 v144, v144, 1, v28
    v_lshl_add_u32 v145, v145, 1, v28
    v_lshl_add_u32 v146, v146, 1, v28
    v_lshl_add_u32 v147, v147, 1, v28
    v_lshl_add_u32 v148, v1, 4, v28
    s_and_b32 s22, s2, 7
    s_mul_i32 s50, s22, 18
    s_lshr_b32 s24, s2, 3
    s_lshl_b32 s54, s20, 12
    s_add_u32 s50, s50, s24
    s_lshl_b32 s48, s50, 6
    s_add_u32 s54, s54, 39168
    v_lshrrev_b32 v5, 2, v4
    s_lshl_b32 s26, s20, 6
    v_add_u32 v5, s26, v5
    v_mul_u32_u24 v5, 9216, v5
    v_and_b32 v6, 3, v4
    v_lshl_add_u32 v149, v6, 4, v5
    s_mov_b32 s44, s40
    s_mov_b32 s45, s41
    s_mov_b32 s46, 5308416
    s_mov_b32 s47, 0x20000
    s_add_u32 m0, s54, 0
    s_cmp_ge_u32 s2, 144
    s_cbranch_scc1 row1_kernel_sk0
    buffer_load_dwordx4 v149, s[44:47], s48 offen lds
    s_add_u32 s48, s48, 147456
row1_kernel_sk0:
    v_and_b32 v5, 15, v4
    s_lshl_b32 s26, s20, 4
    v_add_u32 v5, s26, v5
    v_lshrrev_b32 v6, 4, v4
    v_cmp_eq_u32 vcc, 0, v5
    v_mov_b32 v20, 144
    s_nop 0
    v_cndmask_b32 v5, v5, v20, vcc
    v_lshlrev_b32 v5, 1, v5
    v_lshlrev_b32 v6, 3, v6
    v_mul_u32_u24 v22, v5, v6
    v_lshlrev_b32 v23, 5, v5
    v_add_u32 v30, v22, v5
    v_add_u32 v44, v22, v23
    v_add_u32 v46, v44, v5
    v_cvt_f32_u32 v29, v22
    v_mul_f32 v29, 0x3ae38e39, v29
    v_fract_f32 v29, v29
    v_cvt_f32_u32 v31, v30
    v_mul_f32 v31, 0x3ae38e39, v31
    v_fract_f32 v31, v31
    v_cvt_f32_u32 v45, v44
    v_mul_f32 v45, 0x3ae38e39, v45
    v_fract_f32 v45, v45
    v_cvt_f32_u32 v47, v46
    v_mul_f32 v47, 0x3ae38e39, v47
    v_fract_f32 v47, v47
    v_cvt_f32_u32 v20, v5
    v_mul_f32 v20, 0x3ae38e39, v20
    v_fract_f32 v20, v20
    v_cvt_f32_u32 v21, v23
    v_mul_f32 v21, 0x3ae38e39, v21
    v_fract_f32 v21, v21
    v_cos_f32 v20, v20
    v_cos_f32 v21, v21
    v_cos_f32 v28, v29
    v_sin_f32 v29, -v29
    v_cos_f32 v30, v31
    v_sin_f32 v31, -v31
    v_cos_f32 v44, v45
    v_sin_f32 v45, -v45
    v_cos_f32 v46, v47
    v_sin_f32 v47, -v47
    v_add_f32 v20, v20, v20
    v_add_f32 v21, v21, v21
    v_pk_fma_f32 v[32:33], v[20:21], v[30:31], v[28:29] op_sel:[0,0,0] op_sel_hi:[0,1,1] neg_lo:[0,0,1] neg_hi:[0,0,1]
    v_pk_fma_f32 v[48:49], v[20:21], v[46:47], v[44:45] op_sel:[0,0,0] op_sel_hi:[0,1,1] neg_lo:[0,0,1] neg_hi:[0,0,1]
    v_pk_fma_f32 v[34:35], v[20:21], v[32:33], v[30:31] op_sel:[0,0,0] op_sel_hi:[0,1,1] neg_lo:[0,0,1] neg_hi:[0,0,1]
    v_pk_fma_f32 v[50:51], v[20:21], v[48:49], v[46:47] op_sel:[0,0,0] op_sel_hi:[0,1,1] neg_lo:[0,0,1] neg_hi:[0,0,1]
    v_pk_fma_f32 v[36:37], v[20:21], v[34:35], v[32:33] op_sel:[0,0,0] op_sel_hi:[0,1,1] neg_lo:[0,0,1] neg_hi:[0,0,1]
    v_pk_fma_f32 v[52:53], v[20:21], v[50:51], v[48:49] op_sel:[0,0,0] op_sel_hi:[0,1,1] neg_lo:[0,0,1] neg_hi:[0,0,1]
    v_pk_fma_f32 v[38:39], v[20:21], v[36:37], v[34:35] op_sel:[0,0,0] op_sel_hi:[0,1,1] neg_lo:[0,0,1] neg_hi:[0,0,1]
    v_pk_fma_f32 v[54:55], v[20:21], v[52:53], v[50:51] op_sel:[0,0,0] op_sel_hi:[0,1,1] neg_lo:[0,0,1] neg_hi:[0,0,1]
    v_pk_fma_f32 v[40:41], v[20:21], v[38:39], v[36:37] op_sel:[0,0,0] op_sel_hi:[0,1,1] neg_lo:[0,0,1] neg_hi:[0,0,1]
    v_pk_fma_f32 v[56:57], v[20:21], v[54:55], v[52:53] op_sel:[0,0,0] op_sel_hi:[0,1,1] neg_lo:[0,0,1] neg_hi:[0,0,1]
    v_pk_fma_f32 v[42:43], v[20:21], v[40:41], v[38:39] op_sel:[0,0,0] op_sel_hi:[0,1,1] neg_lo:[0,0,1] neg_hi:[0,0,1]
    v_pk_fma_f32 v[58:59], v[20:21], v[56:57], v[54:55] op_sel:[0,0,0] op_sel_hi:[0,1,1] neg_lo:[0,0,1] neg_hi:[0,0,1]
    v_cvt_pk_bf16_f32 v64, v28, v30
    v_cvt_pk_bf16_f32 v84, v29, v31
    v_cvt_pk_bf16_f32 v65, v32, v34
    v_cvt_pk_bf16_f32 v85, v33, v35
    v_cvt_pk_bf16_f32 v66, v36, v38
    v_cvt_pk_bf16_f32 v86, v37, v39
    v_cvt_pk_bf16_f32 v67, v40, v42
    v_cvt_pk_bf16_f32 v87, v41, v43
    v_pk_fma_f32 v[28:29], v[20:21], v[44:45], v[28:29] op_sel:[1,0,0] op_sel_hi:[1,1,1] neg_lo:[0,0,1] neg_hi:[0,0,1]
    v_pk_fma_f32 v[30:31], v[20:21], v[46:47], v[30:31] op_sel:[1,0,0] op_sel_hi:[1,1,1] neg_lo:[0,0,1] neg_hi:[0,0,1]
    v_pk_fma_f32 v[32:33], v[20:21], v[48:49], v[32:33] op_sel:[1,0,0] op_sel_hi:[1,1,1] neg_lo:[0,0,1] neg_hi:[0,0,1]
    v_pk_fma_f32 v[34:35], v[20:21], v[50:51], v[34:35] op_sel:[1,0,0] op_sel_hi:[1,1,1] neg_lo:[0,0,1] neg_hi:[0,0,1]
    v_pk_fma_f32 v[36:37], v[20:21], v[52:53], v[36:37] op_sel:[1,0,0] op_sel_hi:[1,1,1] neg_lo:[0,0,1] neg_hi:[0,0,1]
    s_add_u32 m0, s54, 1024
    s_cmp_ge_u32 s2, 144
    s_cbranch_scc1 row1_kernel_sk1
    buffer_load_dwordx4 v149, s[44:47], s48 offen lds
    s_add_u32 s48, s48, 147456
row1_kernel_sk1:
    v_pk_fma_f32 v[38:39], v[20:21], v[54:55], v[38:39] op_sel:[1,0,0] op_sel_hi:[1,1,1] neg_lo:[0,0,1] neg_hi:[0,0,1]
    v_pk_fma_f32 v[40:41], v[20:21], v[56:57], v[40:41] op_sel:[1,0,0] op_sel_hi:[1,1,1] neg_lo:[0,0,1] neg_hi:[0,0,1]
    v_pk_fma_f32 v[42:43], v[20:21], v[58:59], v[42:43] op_sel:[1,0,0] op_sel_hi:[1,1,1] neg_lo:[0,0,1] neg_hi:[0,0,1]
    v_cvt_pk_bf16_f32 v68, v44, v46
    v_cvt_pk_bf16_f32 v88, v45, v47
    v_cvt_pk_bf16_f32 v69, v48, v50
    v_cvt_pk_bf16_f32 v89, v49, v51
    v_cvt_pk_bf16_f32 v70, v52, v54
    v_cvt_pk_bf16_f32 v90, v53, v55
    v_cvt_pk_bf16_f32 v71, v56, v58
    v_cvt_pk_bf16_f32 v91, v57, v59
    v_pk_fma_f32 v[44:45], v[20:21], v[28:29], v[44:45] op_sel:[1,0,0] op_sel_hi:[1,1,1] neg_lo:[0,0,1] neg_hi:[0,0,1]
    v_pk_fma_f32 v[46:47], v[20:21], v[30:31], v[46:47] op_sel:[1,0,0] op_sel_hi:[1,1,1] neg_lo:[0,0,1] neg_hi:[0,0,1]
    v_pk_fma_f32 v[48:49], v[20:21], v[32:33], v[48:49] op_sel:[1,0,0] op_sel_hi:[1,1,1] neg_lo:[0,0,1] neg_hi:[0,0,1]
    v_pk_fma_f32 v[50:51], v[20:21], v[34:35], v[50:51] op_sel:[1,0,0] op_sel_hi:[1,1,1] neg_lo:[0,0,1] neg_hi:[0,0,1]
    v_pk_fma_f32 v[52:53], v[20:21], v[36:37], v[52:53] op_sel:[1,0,0] op_sel_hi:[1,1,1] neg_lo:[0,0,1] neg_hi:[0,0,1]
    v_pk_fma_f32 v[54:55], v[20:21], v[38:39], v[54:55] op_sel:[1,0,0] op_sel_hi:[1,1,1] neg_lo:[0,0,1] neg_hi:[0,0,1]
    v_pk_fma_f32 v[56:57], v[20:21], v[40:41], v[56:57] op_sel:[1,0,0] op_sel_hi:[1,1,1] neg_lo:[0,0,1] neg_hi:[0,0,1]
    v_pk_fma_f32 v[58:59], v[20:21], v[42:43], v[58:59] op_sel:[1,0,0] op_sel_hi:[1,1,1] neg_lo:[0,0,1] neg_hi:[0,0,1]
    v_cvt_pk_bf16_f32 v72, v28, v30
    v_cvt_pk_bf16_f32 v92, v29, v31
    v_cvt_pk_bf16_f32 v73, v32, v34
    v_cvt_pk_bf16_f32 v93, v33, v35
    v_cvt_pk_bf16_f32 v74, v36, v38
    v_cvt_pk_bf16_f32 v94, v37, v39
    v_cvt_pk_bf16_f32 v75, v40, v42
    v_cvt_pk_bf16_f32 v95, v41, v43
    v_pk_fma_f32 v[28:29], v[20:21], v[44:45], v[28:29] op_sel:[1,0,0] op_sel_hi:[1,1,1] neg_lo:[0,0,1] neg_hi:[0,0,1]
    v_pk_fma_f32 v[30:31], v[20:21], v[46:47], v[30:31] op_sel:[1,0,0] op_sel_hi:[1,1,1] neg_lo:[0,0,1] neg_hi:[0,0,1]
    v_pk_fma_f32 v[32:33], v[20:21], v[48:49], v[32:33] op_sel:[1,0,0] op_sel_hi:[1,1,1] neg_lo:[0,0,1] neg_hi:[0,0,1]
    v_pk_fma_f32 v[34:35], v[20:21], v[50:51], v[34:35] op_sel:[1,0,0] op_sel_hi:[1,1,1] neg_lo:[0,0,1] neg_hi:[0,0,1]
    v_pk_fma_f32 v[36:37], v[20:21], v[52:53], v[36:37] op_sel:[1,0,0] op_sel_hi:[1,1,1] neg_lo:[0,0,1] neg_hi:[0,0,1]
    v_pk_fma_f32 v[38:39], v[20:21], v[54:55], v[38:39] op_sel:[1,0,0] op_sel_hi:[1,1,1] neg_lo:[0,0,1] neg_hi:[0,0,1]
    v_pk_fma_f32 v[40:41], v[20:21], v[56:57], v[40:41] op_sel:[1,0,0] op_sel_hi:[1,1,1] neg_lo:[0,0,1] neg_hi:[0,0,1]
    v_pk_fma_f32 v[42:43], v[20:21], v[58:59], v[42:43] op_sel:[1,0,0] op_sel_hi:[1,1,1] neg_lo:[0,0,1] neg_hi:[0,0,1]
    v_cvt_pk_bf16_f32 v76, v44, v46
    v_cvt_pk_bf16_f32 v96, v45, v47
    v_cvt_pk_bf16_f32 v77, v48, v50
    v_cvt_pk_bf16_f32 v97, v49, v51
    v_cvt_pk_bf16_f32 v78, v52, v54
    v_cvt_pk_bf16_f32 v98, v53, v55
    v_cvt_pk_bf16_f32 v79, v56, v58
    v_cvt_pk_bf16_f32 v99, v57, v59
    v_cvt_pk_bf16_f32 v80, v28, v30
    v_cvt_pk_bf16_f32 v100, v29, v31
    v_cvt_pk_bf16_f32 v81, v32, v34
    v_cvt_pk_bf16_f32 v101, v33, v35
    v_cvt_pk_bf16_f32 v82, v36, v38
    v_cvt_pk_bf16_f32 v102, v37, v39
    v_cvt_pk_bf16_f32 v83, v40, v42
    v_cvt_pk_bf16_f32 v103, v41, v43
    s_add_u32 m0, s54, 2048
    s_cmp_ge_u32 s2, 144
    s_cbranch_scc1 row1_kernel_sk2
    buffer_load_dwordx4 v149, s[44:47], s48 offen lds
    s_add_u32 s48, s48, 147456
row1_kernel_sk2:
    v_and_b32 v5, 15, v4
    s_lshl_b32 s26, s20, 4
    v_add_u32 v5, s26, v5
    v_lshrrev_b32 v6, 4, v4
    v_lshl_add_u32 v5, v5, 1, 1
    v_lshlrev_b32 v6, 3, v6
    v_mul_u32_u24 v22, v5, v6
    v_lshlrev_b32 v23, 5, v5
    v_add_u32 v30, v22, v5
    v_add_u32 v44, v22, v23
    v_add_u32 v46, v44, v5
    v_cvt_f32_u32 v29, v22
    v_mul_f32 v29, 0x3ae38e39, v29
    v_fract_f32 v29, v29
    v_cvt_f32_u32 v31, v30
    v_mul_f32 v31, 0x3ae38e39, v31
    v_fract_f32 v31, v31
    v_cvt_f32_u32 v45, v44
    v_mul_f32 v45, 0x3ae38e39, v45
    v_fract_f32 v45, v45
    v_cvt_f32_u32 v47, v46
    v_mul_f32 v47, 0x3ae38e39, v47
    v_fract_f32 v47, v47
    v_cvt_f32_u32 v20, v5
    v_mul_f32 v20, 0x3ae38e39, v20
    v_fract_f32 v20, v20
    v_cvt_f32_u32 v21, v23
    v_mul_f32 v21, 0x3ae38e39, v21
    v_fract_f32 v21, v21
    v_cos_f32 v20, v20
    v_cos_f32 v21, v21
    v_cos_f32 v28, v29
    v_sin_f32 v29, -v29
    v_cos_f32 v30, v31
    v_sin_f32 v31, -v31
    v_cos_f32 v44, v45
    v_sin_f32 v45, -v45
    v_cos_f32 v46, v47
    v_sin_f32 v47, -v47
    v_add_f32 v20, v20, v20
    v_add_f32 v21, v21, v21
    v_pk_fma_f32 v[32:33], v[20:21], v[30:31], v[28:29] op_sel:[0,0,0] op_sel_hi:[0,1,1] neg_lo:[0,0,1] neg_hi:[0,0,1]
    v_pk_fma_f32 v[48:49], v[20:21], v[46:47], v[44:45] op_sel:[0,0,0] op_sel_hi:[0,1,1] neg_lo:[0,0,1] neg_hi:[0,0,1]
    v_pk_fma_f32 v[34:35], v[20:21], v[32:33], v[30:31] op_sel:[0,0,0] op_sel_hi:[0,1,1] neg_lo:[0,0,1] neg_hi:[0,0,1]
    v_pk_fma_f32 v[50:51], v[20:21], v[48:49], v[46:47] op_sel:[0,0,0] op_sel_hi:[0,1,1] neg_lo:[0,0,1] neg_hi:[0,0,1]
    v_pk_fma_f32 v[36:37], v[20:21], v[34:35], v[32:33] op_sel:[0,0,0] op_sel_hi:[0,1,1] neg_lo:[0,0,1] neg_hi:[0,0,1]
    v_pk_fma_f32 v[52:53], v[20:21], v[50:51], v[48:49] op_sel:[0,0,0] op_sel_hi:[0,1,1] neg_lo:[0,0,1] neg_hi:[0,0,1]
    v_pk_fma_f32 v[38:39], v[20:21], v[36:37], v[34:35] op_sel:[0,0,0] op_sel_hi:[0,1,1] neg_lo:[0,0,1] neg_hi:[0,0,1]
    v_pk_fma_f32 v[54:55], v[20:21], v[52:53], v[50:51] op_sel:[0,0,0] op_sel_hi:[0,1,1] neg_lo:[0,0,1] neg_hi:[0,0,1]
    v_pk_fma_f32 v[40:41], v[20:21], v[38:39], v[36:37] op_sel:[0,0,0] op_sel_hi:[0,1,1] neg_lo:[0,0,1] neg_hi:[0,0,1]
    v_pk_fma_f32 v[56:57], v[20:21], v[54:55], v[52:53] op_sel:[0,0,0] op_sel_hi:[0,1,1] neg_lo:[0,0,1] neg_hi:[0,0,1]
    v_pk_fma_f32 v[42:43], v[20:21], v[40:41], v[38:39] op_sel:[0,0,0] op_sel_hi:[0,1,1] neg_lo:[0,0,1] neg_hi:[0,0,1]
    v_pk_fma_f32 v[58:59], v[20:21], v[56:57], v[54:55] op_sel:[0,0,0] op_sel_hi:[0,1,1] neg_lo:[0,0,1] neg_hi:[0,0,1]
    v_cvt_pk_bf16_f32 v104, v28, v30
    v_cvt_pk_bf16_f32 v124, v29, v31
    v_cvt_pk_bf16_f32 v105, v32, v34
    v_cvt_pk_bf16_f32 v125, v33, v35
    v_cvt_pk_bf16_f32 v106, v36, v38
    v_cvt_pk_bf16_f32 v126, v37, v39
    v_cvt_pk_bf16_f32 v107, v40, v42
    v_cvt_pk_bf16_f32 v127, v41, v43
    v_pk_fma_f32 v[28:29], v[20:21], v[44:45], v[28:29] op_sel:[1,0,0] op_sel_hi:[1,1,1] neg_lo:[0,0,1] neg_hi:[0,0,1]
    v_pk_fma_f32 v[30:31], v[20:21], v[46:47], v[30:31] op_sel:[1,0,0] op_sel_hi:[1,1,1] neg_lo:[0,0,1] neg_hi:[0,0,1]
    v_pk_fma_f32 v[32:33], v[20:21], v[48:49], v[32:33] op_sel:[1,0,0] op_sel_hi:[1,1,1] neg_lo:[0,0,1] neg_hi:[0,0,1]
    v_pk_fma_f32 v[34:35], v[20:21], v[50:51], v[34:35] op_sel:[1,0,0] op_sel_hi:[1,1,1] neg_lo:[0,0,1] neg_hi:[0,0,1]
    v_pk_fma_f32 v[36:37], v[20:21], v[52:53], v[36:37] op_sel:[1,0,0] op_sel_hi:[1,1,1] neg_lo:[0,0,1] neg_hi:[0,0,1]
    v_pk_fma_f32 v[38:39], v[20:21], v[54:55], v[38:39] op_sel:[1,0,0] op_sel_hi:[1,1,1] neg_lo:[0,0,1] neg_hi:[0,0,1]
    v_pk_fma_f32 v[40:41], v[20:21], v[56:57], v[40:41] op_sel:[1,0,0] op_sel_hi:[1,1,1] neg_lo:[0,0,1] neg_hi:[0,0,1]
    v_pk_fma_f32 v[42:43], v[20:21], v[58:59], v[42:43] op_sel:[1,0,0] op_sel_hi:[1,1,1] neg_lo:[0,0,1] neg_hi:[0,0,1]
    v_cvt_pk_bf16_f32 v108, v44, v46
    s_add_u32 m0, s54, 3072
    s_cmp_ge_u32 s2, 144
    s_cbranch_scc1 row1_kernel_sk3
    buffer_load_dwordx4 v149, s[44:47], s48 offen lds
    s_add_u32 s48, s48, 147456
row1_kernel_sk3:
    v_cvt_pk_bf16_f32 v128, v45, v47
    v_cvt_pk_bf16_f32 v109, v48, v50
    v_cvt_pk_bf16_f32 v129, v49, v51
    v_cvt_pk_bf16_f32 v110, v52, v54
    v_cvt_pk_bf16_f32 v130, v53, v55
    v_cvt_pk_bf16_f32 v111, v56, v58
    v_cvt_pk_bf16_f32 v131, v57, v59
    v_pk_fma_f32 v[44:45], v[20:21], v[28:29], v[44:45] op_sel:[1,0,0] op_sel_hi:[1,1,1] neg_lo:[0,0,1] neg_hi:[0,0,1]
    v_pk_fma_f32 v[46:47], v[20:21], v[30:31], v[46:47] op_sel:[1,0,0] op_sel_hi:[1,1,1] neg_lo:[0,0,1] neg_hi:[0,0,1]
    v_pk_fma_f32 v[48:49], v[20:21], v[32:33], v[48:49] op_sel:[1,0,0] op_sel_hi:[1,1,1] neg_lo:[0,0,1] neg_hi:[0,0,1]
    v_pk_fma_f32 v[50:51], v[20:21], v[34:35], v[50:51] op_sel:[1,0,0] op_sel_hi:[1,1,1] neg_lo:[0,0,1] neg_hi:[0,0,1]
    v_pk_fma_f32 v[52:53], v[20:21], v[36:37], v[52:53] op_sel:[1,0,0] op_sel_hi:[1,1,1] neg_lo:[0,0,1] neg_hi:[0,0,1]
    v_pk_fma_f32 v[54:55], v[20:21], v[38:39], v[54:55] op_sel:[1,0,0] op_sel_hi:[1,1,1] neg_lo:[0,0,1] neg_hi:[0,0,1]
    v_pk_fma_f32 v[56:57], v[20:21], v[40:41], v[56:57] op_sel:[1,0,0] op_sel_hi:[1,1,1] neg_lo:[0,0,1] neg_hi:[0,0,1]
    v_pk_fma_f32 v[58:59], v[20:21], v[42:43], v[58:59] op_sel:[1,0,0] op_sel_hi:[1,1,1] neg_lo:[0,0,1] neg_hi:[0,0,1]
    v_cvt_pk_bf16_f32 v112, v28, v30
    v_cvt_pk_bf16_f32 v132, v29, v31
    v_cvt_pk_bf16_f32 v113, v32, v34
    v_cvt_pk_bf16_f32 v133, v33, v35
    v_cvt_pk_bf16_f32 v114, v36, v38
    v_cvt_pk_bf16_f32 v134, v37, v39
    v_cvt_pk_bf16_f32 v115, v40, v42
    v_cvt_pk_bf16_f32 v135, v41, v43
    v_pk_fma_f32 v[28:29], v[20:21], v[44:45], v[28:29] op_sel:[1,0,0] op_sel_hi:[1,1,1] neg_lo:[0,0,1] neg_hi:[0,0,1]
    v_pk_fma_f32 v[30:31], v[20:21], v[46:47], v[30:31] op_sel:[1,0,0] op_sel_hi:[1,1,1] neg_lo:[0,0,1] neg_hi:[0,0,1]
    v_pk_fma_f32 v[32:33], v[20:21], v[48:49], v[32:33] op_sel:[1,0,0] op_sel_hi:[1,1,1] neg_lo:[0,0,1] neg_hi:[0,0,1]
    v_pk_fma_f32 v[34:35], v[20:21], v[50:51], v[34:35] op_sel:[1,0,0] op_sel_hi:[1,1,1] neg_lo:[0,0,1] neg_hi:[0,0,1]
    v_pk_fma_f32 v[36:37], v[20:21], v[52:53], v[36:37] op_sel:[1,0,0] op_sel_hi:[1,1,1] neg_lo:[0,0,1] neg_hi:[0,0,1]
    v_pk_fma_f32 v[38:39], v[20:21], v[54:55], v[38:39] op_sel:[1,0,0] op_sel_hi:[1,1,1] neg_lo:[0,0,1] neg_hi:[0,0,1]
    v_pk_fma_f32 v[40:41], v[20:21], v[56:57], v[40:41] op_sel:[1,0,0] op_sel_hi:[1,1,1] neg_lo:[0,0,1] neg_hi:[0,0,1]
    v_pk_fma_f32 v[42:43], v[20:21], v[58:59], v[42:43] op_sel:[1,0,0] op_sel_hi:[1,1,1] neg_lo:[0,0,1] neg_hi:[0,0,1]
    v_cvt_pk_bf16_f32 v116, v44, v46
    v_cvt_pk_bf16_f32 v136, v45, v47
    v_cvt_pk_bf16_f32 v117, v48, v50
    v_cvt_pk_bf16_f32 v137, v49, v51
    v_cvt_pk_bf16_f32 v118, v52, v54
    v_cvt_pk_bf16_f32 v138, v53, v55
    v_cvt_pk_bf16_f32 v119, v56, v58
    v_cvt_pk_bf16_f32 v139, v57, v59
    v_cvt_pk_bf16_f32 v120, v28, v30
    v_cvt_pk_bf16_f32 v140, v29, v31
    v_cvt_pk_bf16_f32 v121, v32, v34
    v_cvt_pk_bf16_f32 v141, v33, v35
    v_cvt_pk_bf16_f32 v122, v36, v38
    v_cvt_pk_bf16_f32 v142, v37, v39
    v_cvt_pk_bf16_f32 v123, v40, v42
    v_cvt_pk_bf16_f32 v143, v41, v43
    v_and_b32 v50, 15, v4
    v_lshrrev_b32 v52, 4, v4
    v_min_u32 v51, 5, v50
    v_mul_u32_u24 v51, 336, v51
    v_lshl_add_u32 v55, v52, 4, v51
    v_and_b32 v53, 1, v50
    v_mul_u32_u24 v53, 589824, v53
    v_lshrrev_b32 v54, 1, v50
    v_lshl_add_u32 v53, v54, 7, v53
    v_lshl_add_u32 v5, v52, 3, v53
    v_lshlrev_b32 v6, 3, v52
    s_lshr_b32 s22, s2, 1
    s_and_b32 s22, s22, 1
    s_lshl_b32 s24, s23, 6
    s_add_u32 s25, s20, 0
    s_lshr_b32 s26, s25, 1
    s_lshl_b32 s26, s26, 16
    s_and_b32 s27, s25, 1
    s_xor_b32 s27, s27, s22
    s_lshl_b32 s27, s27, 5
    s_add_u32 s66, s26, s27
    s_add_u32 s66, s66, s24
    s_add_u32 s68, s66, 32768
    s_lshl_b32 s25, s25, 5
    s_add_u32 s70, s25, 1179648
    s_add_u32 s72, s25, 1180224
    s_add_u32 s25, s20, 9
    s_lshr_b32 s26, s25, 1
    s_lshl_b32 s26, s26, 16
    s_and_b32 s27, s25, 1
    s_xor_b32 s27, s27, s22
    s_lshl_b32 s27, s27, 5
    s_add_u32 s67, s26, s27
    s_add_u32 s67, s67, s24
    s_add_u32 s69, s67, 32768
    s_lshl_b32 s25, s25, 5
    s_add_u32 s71, s25, 1179648
    s_add_u32 s73, s25, 1180224
    v_cmp_gt_u32 s[40:41], 4, v50
    v_cmp_eq_u32 s[42:43], 4, v50
    v_mov_b32 v28, 0
    s_lshr_b32 s52, s20, 1
    s_and_b32 s52, s52, 3
    s_and_b32 s53, s52, 1
    s_lshr_b32 s54, s52, 1
    s_cmp_eq_u32 s54, 0
    s_cselect_b32 s55, 1.0, -1.0
    s_or_b32 s22, s2, s53
    s_cmp_eq_u32 s22, 0
    s_cselect_b32 s56, 0, 1.0
    s_or_b32 s22, s22, s54
    s_cmp_eq_u32 s22, 0
    s_cselect_b32 s57, 1.0, 0
    s_cmp_eq_u32 s54, 0
    s_cselect_b32 s58, 1.0, s56
    s_mov_b32 s59, s56
    s_lshl_b32 s60, s54, 3
    s_add_u32 s60, s60, s53
    s_mul_i32 s60, s60, 1168
    s_mul_i32 s22, s54, 12
    s_lshl_b32 s24, s53, 1
    s_add_u32 s24, s24, s22
    s_add_u32 s62, s24, s54
    s_add_u32 s61, s24, 1
    s_sub_u32 s61, s61, s54
    s_add_u32 s63, s22, s53
    s_add_u32 s63, s63, 4
    s_mul_i32 s61, s61, 336
    s_mul_i32 s62, s62, 336
    s_mul_i32 s63, s63, 336
    v_and_b32 v50, 127, v0
    v_min_u32 v50, 79, v50
    v_cmp_eq_u32 vcc, 0, v50
    v_sub_u32 v52, 144, v50
    v_mov_b32 v53, 288
    v_cndmask_b32 v51, v50, v53, vcc
    v_cndmask_b32 v52, v52, v28, vcc
    v_add_u32 v53, 144, v50
    v_sub_u32 v54, 287, v50
    v_lshl_add_u32 v44 , v51, 2, s60
    v_lshl_add_u32 v45 , v52, 2, s60
    v_lshl_add_u32 v46 , v53, 2, s60
    v_lshl_add_u32 v47 , v54, 2, s60
    s_movk_i32 s22, 72
    v_cmp_gt_u32 vcc, 72, v50
    v_cmp_eq_u32 s[64:65], s22, v50
    s_nop 0
    v_cndmask_b32 v49, 0, 1.0, vcc
    v_cndmask_b32 v48, v49, 0.5, s[64:65]
    v_lshl_add_u32 v52, v50, 2, s61
    v_lshl_add_u32 v53, v50, 2, s62
    v_lshl_add_u32 v54, v50, 2, s63
    v_mul_u32_u24 v50, 1168, v2
    v_lshl_add_u32 v51, v1, 4, v50
    v_lshlrev_b32 v41, 2, v2
    v_mul_u32_u24 v63, 48, v4
    v_mul_u32_u24 v7, 48, v2
    s_lshl_b32 s26, s20, 2
    v_lshrrev_b32 v28, 4, v4
    v_add_u32 v7, s26, v7
    v_mul_u32_u24 v29, 384, v28
    v_lshrrev_b32 v28, 1, v28
    v_add_u32 v62, v29, v7
    v_mul_u32_u24 v28, 384, v28
    v_add_u32 v7, v28, v7
    s_cmp_ge_u32 s2, 144
    s_cbranch_scc1 row1_kernel_nw
    s_waitcnt vmcnt(4)
    s_branch row1_kernel_nw2
row1_kernel_nw:
    s_waitcnt vmcnt(0)
row1_kernel_nw2:
    ds_write_b128 v148, v[8:11] offset:0
    s_waitcnt lgkmcnt(0)
    s_barrier
    ds_read_u16 v12, v146 offset:0
    ds_read_u16 v13, v144 offset:4
    ds_read_u16 v14, v144 offset:8
    ds_read_u16 v15, v144 offset:12
    ds_read_u16 v16, v147 offset:0
    ds_read_u16 v17, v145 offset:8
    ds_read_u16 v18, v145 offset:4
    ds_read_u16 v19, v145 offset:0
    s_waitcnt lgkmcnt(0)
    v_lshl_or_b32 v56, v13, 16, v12
    v_lshl_or_b32 v57, v15, 16, v14
    v_lshl_or_b32 v58, v17, 16, v16
    v_lshl_or_b32 v59, v19, 16, v18
    v_lshlrev_b32 v12, 16, v56
    v_and_b32 v13, s32, v56
    v_lshlrev_b32 v14, 16, v57
    v_and_b32 v15, s32, v57
    v_lshlrev_b32 v16, 16, v58
    v_and_b32 v17, s32, v58
    v_lshlrev_b32 v18, 16, v59
    v_and_b32 v19, s32, v59
    v_pk_add_f32 v[28:29], v[12:13], v[14:15]
    v_pk_add_f32 v[30:31], v[16:17], v[18:19]
    v_pk_add_f32 v[28:29], v[28:29], v[30:31]
    v_add_f32 v34, v28, v29
    v_pk_mul_f32 v[32:33], v[12:13], v[12:13]
    v_pk_fma_f32 v[32:33], v[14:15], v[14:15], v[32:33]
    v_pk_fma_f32 v[32:33], v[16:17], v[16:17], v[32:33]
    v_pk_fma_f32 v[32:33], v[18:19], v[18:19], v[32:33]
    v_add_f32 v35, v32, v33
    s_nop 1
    v_permlane32_swap_b32 v34, v35
    v_add_f32 v34, v34, v35
    v_mov_b32 v35, v34
    s_nop 1
    v_permlane16_swap_b32 v34, v35
    v_add_f32 v34, v34, v35
    s_nop 1
    v_add_f32_dpp v34, v34, v34 row_ror:8 row_mask:0xf bank_mask:0xf
    ds_write_b32 v7, v34 offset:37632
    s_waitcnt lgkmcnt(0)
    s_barrier
    ds_read_b128 v[28:31], v63 offset:36096
    ds_read_b128 v[32:35], v63 offset:36112
    ds_read_b32 v36, v63 offset:36128
    s_waitcnt lgkmcnt(0)
    v_pk_add_f32 v[28:29], v[28:29], v[30:31]
    v_pk_add_f32 v[32:33], v[32:33], v[34:35]
    v_add_f32 v36, v36, v28
    v_add_f32 v32, v32, v33
    v_add_f32 v36, v36, v29
    v_add_f32 v36, v36, v32
    ds_bpermute_b32 v60, v41, v36 offset:128
    ds_bpermute_b32 v61, v41, v36 offset:160
    s_waitcnt lgkmcnt(0)
    v_pk_mul_f32 v[60:61], s[30:31], v[60:61] op_sel_hi:[0,1]
    v_fma_f32 v61, -v60, v60, v61
    v_max_f32 v61, 0, v61
    v_add_f32 v61, s31, v61
    v_rsq_f32 v61, v61
    s_nop 0
    v_mul_f32 v60, v60, v61
    v_cmp_eq_u32 vcc, 0, v1
    v_mov_b32 v28, 0
    v_pk_fma_f32 v[12:13], v[12:13], v[60:61], v[60:61] op_sel:[0,1,0] op_sel_hi:[1,1,0] neg_lo:[0,0,1] neg_hi:[0,0,1]
    v_pk_fma_f32 v[14:15], v[14:15], v[60:61], v[60:61] op_sel:[0,1,0] op_sel_hi:[1,1,0] neg_lo:[0,0,1] neg_hi:[0,0,1]
    v_pk_fma_f32 v[16:17], v[16:17], v[60:61], v[60:61] op_sel:[0,1,0] op_sel_hi:[1,1,0] neg_lo:[0,0,1] neg_hi:[0,0,1]
    v_pk_fma_f32 v[18:19], v[18:19], v[60:61], v[60:61] op_sel:[0,1,0] op_sel_hi:[1,1,0] neg_lo:[0,0,1] neg_hi:[0,0,1]
    v_pk_add_f32 v[20:21], v[12:13], v[16:17]
    v_pk_add_f32 v[24:25], v[12:13], v[16:17] neg_lo:[0,1] neg_hi:[0,1]
    v_pk_add_f32 v[22:23], v[14:15], v[18:19]
    v_pk_add_f32 v[26:27], v[14:15], v[18:19] neg_lo:[0,1] neg_hi:[0,1]
    v_cndmask_b32 v20, v20, v12, vcc
    v_cndmask_b32 v24, v24, v28, vcc
    ds_write_b128 v51, v[20:23] offset:9344
    ds_write_b128 v51, v[24:27] offset:18688
    s_and_saveexec_b64 s[34:35], vcc
    s_cbranch_execz row1_kernel_no0
    ds_write_b32 v50, v16 offset:10496
    ds_write_b32 v50, v28 offset:19840
row1_kernel_no0:
    s_mov_b64 exec, s[34:35]
    s_waitcnt lgkmcnt(0)
    s_barrier
    ds_read_b32 v8, v44 offset:9344
    ds_read_b32 v9, v44 offset:11680
    ds_read_b32 v10, v44 offset:16352
    ds_read_b32 v11, v44 offset:14016
    ds_read_b32 v12, v45 offset:9344
    ds_read_b32 v13, v45 offset:11680
    ds_read_b32 v14, v45 offset:16352
    ds_read_b32 v15, v45 offset:14016
    ds_read_b32 v16, v46 offset:9344
    ds_read_b32 v17, v46 offset:11680
    ds_read_b32 v18, v46 offset:16352
    ds_read_b32 v19, v46 offset:14016
    ds_read_b32 v20, v47 offset:9344
    ds_read_b32 v21, v47 offset:11680
    ds_read_b32 v22, v47 offset:16352
    ds_read_b32 v23, v47 offset:14016
    s_waitcnt lgkmcnt(8)
    v_fma_f32 v24, s55, v12, v8
    v_fma_f32 v28, -s55, v12, v8
    v_fma_f32 v25, s55, v13, v9
    v_fma_f32 v29, -s55, v13, v9
    v_fma_f32 v26, s55, v14, v10
    v_fma_f32 v30, -s55, v14, v10
    v_fma_f32 v27, s55, v15, v11
    v_fma_f32 v31, -s55, v15, v11
    v_mul_f32 v24, v48, v24
    v_mul_f32 v28, v48, v28
    v_mul_f32 v25, v48, v25
    v_mul_f32 v29, v48, v29
    v_mul_f32 v26, v48, v26
    v_mul_f32 v30, v48, v30
    v_mul_f32 v27, v48, v27
    v_mul_f32 v31, v48, v31
    s_waitcnt lgkmcnt(0)
    v_fma_f32 v32, s55, v20, v16
    v_fma_f32 v36, -s55, v20, v16
    v_fma_f32 v33, s55, v21, v17
    v_fma_f32 v37, -s55, v21, v17
    v_fma_f32 v34, s55, v22, v18
    v_fma_f32 v38, -s55, v22, v18
    v_fma_f32 v35, s55, v23, v19
    v_fma_f32 v39, -s55, v23, v19
    v_mul_f32 v32, v49, v32
    v_mul_f32 v36, v49, v36
    v_mul_f32 v33, v49, v33
    v_mul_f32 v37, v49, v37
    v_mul_f32 v34, v49, v34
    v_mul_f32 v38, v49, v38
    v_mul_f32 v35, v49, v35
    v_mul_f32 v39, v49, v39
    v_fma_f32 v40, s55, v27, v24
    v_fma_f32 v10, s55, v26, v25
    v_sub_f32 v42, v24, v27
    v_sub_f32 v8, v40, v10
    v_mul_f32 v8, s56, v8
    v_fmac_f32 v8, s57, v42
    v_mul_f32 v9, s58, v40
    v_fmac_f32 v9, s59, v10
    v_fma_f32 v40, s55, v31, v28
    v_fma_f32 v13, s55, v30, v29
    v_sub_f32 v42, v28, v31
    v_sub_f32 v11, v40, v13
    v_mul_f32 v11, s56, v11
    v_fmac_f32 v11, s57, v42
    v_mul_f32 v12, s58, v40
    v_fmac_f32 v12, s59, v13
    v_fma_f32 v40, s55, v35, v32
    v_fma_f32 v16, s55, v34, v33
    v_sub_f32 v42, v32, v35
    v_sub_f32 v14, v40, v16
    v_mul_f32 v14, s56, v14
    v_fmac_f32 v14, s57, v42
    v_mul_f32 v15, s58, v40
    v_fmac_f32 v15, s59, v16
    v_fma_f32 v40, s55, v39, v36
    v_fma_f32 v19, s55, v38, v37
    v_sub_f32 v42, v36, v39
    v_sub_f32 v17, v40, v19
    v_mul_f32 v17, s56, v17
    v_fmac_f32 v17, s57, v42
    v_mul_f32 v18, s58, v40
    v_fmac_f32 v18, s59, v19
    v_cvt_pk_bf16_f32 v24, v8, v14
    ds_write_b32 v52, v24 offset:28032
    v_cvt_pk_bf16_f32 v25, v9, v15
    ds_write_b32 v53, v25 offset:28032
    v_cvt_pk_bf16_f32 v26, v10, v16
    ds_write_b32 v54, v26 offset:28032
    v_cvt_pk_bf16_f32 v27, v11, v17
    ds_write_b32 v52, v27 offset:30048
    v_cvt_pk_bf16_f32 v28, v12, v18
    ds_write_b32 v53, v28 offset:30048
    v_cvt_pk_bf16_f32 v29, v13, v19
    ds_write_b32 v54, v29 offset:30048
    s_waitcnt lgkmcnt(0)
    s_barrier
    ds_read_b128 v[8:11], v55 offset:28032
    ds_read_b128 v[12:15], v55 offset:28096
    ds_read_b128 v[16:19], v55 offset:28160
    ds_read_b128 v[20:23], v55 offset:28224
    ds_read_b128 v[24:27], v55 offset:28288
    ds_read_b128 v[28:31], v55 offset:30048
    ds_read_b128 v[32:35], v55 offset:30112
    ds_read_b128 v[36:39], v55 offset:30176
    ds_read_b128 v[40:43], v55 offset:30240
    ds_read_b128 v[44:47], v55 offset:30304
    s_waitcnt lgkmcnt(5)
    v_mfma_f32_16x16x32_bf16 v[144:147], v[64:67], v[8:11], 0
    v_mfma_f32_16x16x32_bf16 v[144:147], v[68:71], v[12:15], v[144:147]
    v_mfma_f32_16x16x32_bf16 v[144:147], v[72:75], v[16:19], v[144:147]
    v_mfma_f32_16x16x32_bf16 v[144:147], v[76:79], v[20:23], v[144:147]
    v_mfma_f32_16x16x32_bf16 v[144:147], v[80:83], v[24:27], v[144:147]
    s_waitcnt lgkmcnt(0)
    v_mfma_f32_16x16x32_bf16 v[148:151], v[104:107], v[28:31], 0
    v_mfma_f32_16x16x32_bf16 v[148:151], v[108:111], v[32:35], v[148:151]
    v_mfma_f32_16x16x32_bf16 v[148:151], v[112:115], v[36:39], v[148:151]
    v_mfma_f32_16x16x32_bf16 v[148:151], v[116:119], v[40:43], v[148:151]
    v_mfma_f32_16x16x32_bf16 v[148:151], v[120:123], v[44:47], v[148:151]
    ds_read_b128 v[8:11], v55 offset:32064
    ds_read_b128 v[12:15], v55 offset:32128
    ds_read_b128 v[16:19], v55 offset:32192
    ds_read_b128 v[20:23], v55 offset:32256
    ds_read_b128 v[24:27], v55 offset:32320
    ds_read_b128 v[28:31], v55 offset:34080
    ds_read_b128 v[32:35], v55 offset:34144
    ds_read_b128 v[36:39], v55 offset:34208
    ds_read_b128 v[40:43], v55 offset:34272
    ds_read_b128 v[44:47], v55 offset:34336
    s_waitcnt lgkmcnt(5)
    v_mfma_f32_16x16x32_bf16 v[152:155], v[84:87], v[8:11], 0
    v_mfma_f32_16x16x32_bf16 v[152:155], v[88:91], v[12:15], v[152:155]
    v_mfma_f32_16x16x32_bf16 v[152:155], v[92:95], v[16:19], v[152:155]
    v_mfma_f32_16x16x32_bf16 v[152:155], v[96:99], v[20:23], v[152:155]
    v_mfma_f32_16x16x32_bf16 v[152:155], v[100:103], v[24:27], v[152:155]
    s_waitcnt lgkmcnt(0)
    v_mfma_f32_16x16x32_bf16 v[156:159], v[124:127], v[28:31], 0
    v_mfma_f32_16x16x32_bf16 v[156:159], v[128:131], v[32:35], v[156:159]
    v_mfma_f32_16x16x32_bf16 v[156:159], v[132:135], v[36:39], v[156:159]
    v_mfma_f32_16x16x32_bf16 v[156:159], v[136:139], v[40:43], v[156:159]
    v_mfma_f32_16x16x32_bf16 v[156:159], v[140:143], v[44:47], v[156:159]
    buffer_store_dwordx4 v[56:59], v3, s[16:19], s21 offen sc1
    s_mov_b64 vcc, s[40:41]
    s_mov_b64 s[64:65], s[42:43]
    s_nop 7
    v_cvt_pk_bf16_f32 v160, v144, v145
    v_cvt_pk_bf16_f32 v161, v146, v147
    v_cvt_pk_bf16_f32 v162, v148, v149
    v_cvt_pk_bf16_f32 v163, v150, v151
    v_cvt_pk_bf16_f32 v164, v152, v153
    v_cvt_pk_bf16_f32 v165, v154, v155
    v_cvt_pk_bf16_f32 v166, v156, v157
    v_cvt_pk_bf16_f32 v167, v158, v159
    s_mov_b64 exec, vcc
    buffer_store_dwordx2 v[160:161], v5, s[36:39], s66 offen
    buffer_store_dwordx2 v[162:163], v5, s[36:39], s67 offen
    buffer_store_dwordx2 v[164:165], v5, s[36:39], s68 offen
    buffer_store_dwordx2 v[166:167], v5, s[36:39], s69 offen
    s_cmp_lg_u32 s2, 0
    s_cbranch_scc1 row1_kernel_fin
    s_mov_b64 exec, s[64:65]
    buffer_store_dwordx2 v[160:161], v6, s[36:39], s70 offen
    buffer_store_dwordx2 v[162:163], v6, s[36:39], s71 offen
    buffer_store_dwordx2 v[164:165], v6, s[36:39], s72 offen
    buffer_store_dwordx2 v[166:167], v6, s[36:39], s73 offen
row1_kernel_fin:
    s_mov_b64 exec, -1
    s_cmp_lt_u32 s2, 144
    s_cbranch_scc1 row1_kernel_go
    s_endpgm
row1_kernel_go:
    s_waitcnt vmcnt(5)
    s_barrier
    v_and_b32 v1, 15, v0
    v_lshrrev_b32 v2, 4, v0
    v_lshlrev_b32 v3, 4, v2
    v_cmp_le_u32 vcc, 18, v2
    v_subrev_u32 v4, 287, v3
    v_mov_b32 v28, 288
    v_cndmask_b32 v3, v3, v4, vcc
    v_cmp_eq_u32 vcc, 0, v2
    v_sub_u32 v11, 562, v3
    v_sub_u32 v13, 576, v3
    v_mov_b32 v29, 0
    v_cndmask_b32 v12, v3, v28, vcc
    v_cndmask_b32 v13, v13, v29, vcc
    v_mov_b32 v10, v3
    v_lshlrev_b32 v4, 1, v1
    v_lshl_add_u32 v10, v10, 6, v4
    v_lshl_add_u32 v11, v11, 6, v4
    v_lshl_add_u32 v12, v12, 6, v4
    v_lshl_add_u32 v13, v13, 6, v4
    ds_read_u16 v80, v12 offset:39168
    ds_read_u16 v88, v13 offset:39168
    ds_read_u16 v81, v10 offset:39296
    ds_read_u16 v89, v11 offset:39936
    ds_read_u16 v82, v10 offset:39424
    ds_read_u16 v90, v11 offset:39808
    ds_read_u16 v83, v10 offset:39552
    ds_read_u16 v91, v11 offset:39680
    ds_read_u16 v84, v10 offset:39680
    ds_read_u16 v92, v11 offset:39552
    ds_read_u16 v85, v10 offset:39808
    ds_read_u16 v93, v11 offset:39424
    ds_read_u16 v86, v10 offset:39936
    ds_read_u16 v94, v11 offset:39296
    ds_read_u16 v87, v10 offset:40064
    ds_read_u16 v95, v11 offset:39168
    ds_read_u16 v96, v12 offset:39200
    ds_read_u16 v104, v13 offset:39200
    ds_read_u16 v97, v10 offset:39328
    ds_read_u16 v105, v11 offset:39968
    ds_read_u16 v98, v10 offset:39456
    ds_read_u16 v106, v11 offset:39840
    ds_read_u16 v99, v10 offset:39584
    ds_read_u16 v107, v11 offset:39712
    ds_read_u16 v100, v10 offset:39712
    ds_read_u16 v108, v11 offset:39584
    ds_read_u16 v101, v10 offset:39840
    ds_read_u16 v109, v11 offset:39456
    ds_read_u16 v102, v10 offset:39968
    ds_read_u16 v110, v11 offset:39328
    ds_read_u16 v103, v10 offset:40096
    ds_read_u16 v111, v11 offset:39200
    s_mul_i32 s51, s50, 57
    s_lshr_b32 s51, s51, 10
    s_mul_i32 s52, s51, 18
    s_sub_u32 s52, s50, s52
    s_mul_i32 s54, s51, 1327104
    s_add_u32 s16, s4, 201326592
    s_addc_u32 s17, s5, 0
    s_add_u32 s16, s16, s54
    s_addc_u32 s17, s17, 0
    s_mov_b32 s18, 1327104
    s_mov_b32 s19, 0x20000
    v_lshrrev_b32 v16, 1, v2
    v_and_b32 v15, 1, v2
    v_lshlrev_b32 v15, 9, v15
    v_lshl_add_u32 v17, v1, 4, v15
    s_lshl_b32 s55, s52, 1
    s_add_u32 s55, s55, 0
    s_mul_i32 s57, s55, 57
    s_lshr_b32 s57, s57, 9
    s_mul_i32 s58, s57, 9
    s_sub_u32 s55, s55, s58
    s_mul_i32 s57, s57, 324
    s_add_u32 s57, s57, s55
    s_cmp_lt_u32 s55, 5
    s_cselect_b32 s58, 0, 85
    s_cselect_b32 s59, 5, 4
    s_add_u32 s57, s57, s58
    s_lshl_b32 s66, s57, 10
    s_lshl_b32 s59, s59, 10
    v_mul_u32_u24 v14, s59, v16
    v_add_u32 v14, v14, v17
    s_lshl_b32 s55, s52, 1
    s_add_u32 s55, s55, 1
    s_mul_i32 s57, s55, 57
    s_lshr_b32 s57, s57, 9
    s_mul_i32 s58, s57, 9
    s_sub_u32 s55, s55, s58
    s_mul_i32 s57, s57, 324
    s_add_u32 s57, s57, s55
    s_cmp_lt_u32 s55, 5
    s_cselect_b32 s58, 0, 85
    s_cselect_b32 s59, 5, 4
    s_add_u32 s57, s57, s58
    s_lshl_b32 s67, s57, 10
    s_lshl_b32 s59, s59, 10
    v_mul_u32_u24 v15, s59, v16
    v_add_u32 v15, v15, v17
    v_lshlrev_b32 v63, 3, v1
    s_lshl_b32 s26, s20, 7
    v_add_u32 v62, s26, v63
    s_waitcnt lgkmcnt(0)
    v_lshlrev_b32 v80, 16, v80
    v_lshlrev_b32 v81, 16, v81
    v_lshlrev_b32 v82, 16, v82
    v_lshlrev_b32 v83, 16, v83
    v_lshlrev_b32 v84, 16, v84
    v_lshlrev_b32 v85, 16, v85
    v_lshlrev_b32 v86, 16, v86
    v_lshlrev_b32 v87, 16, v87
    v_lshlrev_b32 v88, 16, v88
    v_lshlrev_b32 v89, 16, v89
    v_lshlrev_b32 v90, 16, v90
    v_lshlrev_b32 v91, 16, v91
    v_lshlrev_b32 v92, 16, v92
    v_lshlrev_b32 v93, 16, v93
    v_lshlrev_b32 v94, 16, v94
    v_lshlrev_b32 v95, 16, v95
    v_lshlrev_b32 v96, 16, v96
    v_lshlrev_b32 v97, 16, v97
    v_lshlrev_b32 v98, 16, v98
    v_lshlrev_b32 v99, 16, v99
    v_lshlrev_b32 v100, 16, v100
    v_lshlrev_b32 v101, 16, v101
    v_lshlrev_b32 v102, 16, v102
    v_lshlrev_b32 v103, 16, v103
    v_lshlrev_b32 v104, 16, v104
    v_lshlrev_b32 v105, 16, v105
    v_lshlrev_b32 v106, 16, v106
    v_lshlrev_b32 v107, 16, v107
    v_lshlrev_b32 v108, 16, v108
    v_lshlrev_b32 v109, 16, v109
    v_lshlrev_b32 v110, 16, v110
    v_lshlrev_b32 v111, 16, v111
    v_add_f32 v60, v80, v81
    v_add_f32 v60, v60, v82
    v_add_f32 v60, v60, v83
    v_add_f32 v60, v60, v84
    v_add_f32 v60, v60, v85
    v_add_f32 v60, v60, v86
    v_add_f32 v60, v60, v87
    v_add_f32 v60, v60, v88
    v_add_f32 v60, v60, v89
    v_add_f32 v60, v60, v90
    v_add_f32 v60, v60, v91
    v_add_f32 v60, v60, v92
    v_add_f32 v60, v60, v93
    v_add_f32 v60, v60, v94
    v_add_f32 v60, v60, v95
    v_add_f32 v61, v96, v97
    v_add_f32 v61, v61, v98
    v_add_f32 v61, v61, v99
    v_add_f32 v61, v61, v100
    v_add_f32 v61, v61, v101
    v_add_f32 v61, v61, v102
    v_add_f32 v61, v61, v103
    v_add_f32 v61, v61, v104
    v_add_f32 v61, v61, v105
    v_add_f32 v61, v61, v106
    v_add_f32 v61, v61, v107
    v_add_f32 v61, v61, v108
    v_add_f32 v61, v61, v109
    v_add_f32 v61, v61, v110
    v_add_f32 v61, v61, v111
    s_nop 1
    v_mov_b32 v5, v60
    v_mov_b32 v6, v61
    s_nop 1
    v_permlane16_swap_b32 v60, v5
    v_permlane16_swap_b32 v61, v6
    s_nop 1
    v_add_f32 v60, v60, v5
    v_add_f32 v61, v61, v6
    v_mov_b32 v5, v60
    v_mov_b32 v6, v61
    s_nop 1
    v_permlane32_swap_b32 v60, v5
    v_permlane32_swap_b32 v61, v6
    s_nop 1
    v_add_f32 v60, v60, v5
    v_add_f32 v61, v61, v6
    ds_write_b64 v62, v[60:61] offset:0
    s_waitcnt lgkmcnt(0)
    s_barrier
    ds_read_b64 v[28:29], v63 offset:0
    ds_read_b64 v[30:31], v63 offset:128
    ds_read_b64 v[32:33], v63 offset:256
    ds_read_b64 v[34:35], v63 offset:384
    ds_read_b64 v[36:37], v63 offset:512
    ds_read_b64 v[38:39], v63 offset:640
    ds_read_b64 v[40:41], v63 offset:768
    ds_read_b64 v[42:43], v63 offset:896
    ds_read_b64 v[44:45], v63 offset:1024
    s_waitcnt lgkmcnt(0)
    v_pk_add_f32 v[28:29], v[28:29], v[30:31]
    v_pk_add_f32 v[32:33], v[32:33], v[34:35]
    v_pk_add_f32 v[36:37], v[36:37], v[38:39]
    v_pk_add_f32 v[40:41], v[40:41], v[42:43]
    v_pk_add_f32 v[28:29], v[28:29], v[32:33]
    v_pk_add_f32 v[36:37], v[36:37], v[40:41]
    v_pk_add_f32 v[28:29], v[28:29], v[36:37]
    v_pk_add_f32 v[60:61], v[28:29], v[44:45]
    v_mul_f32 v60, s30, v60
    v_mul_f32 v61, s30, v61
    v_sub_f32 v80, v80, v60
    v_sub_f32 v81, v81, v60
    v_sub_f32 v82, v82, v60
    v_sub_f32 v83, v83, v60
    v_sub_f32 v84, v84, v60
    v_sub_f32 v85, v85, v60
    v_sub_f32 v86, v86, v60
    v_sub_f32 v87, v87, v60
    v_sub_f32 v88, v88, v60
    v_sub_f32 v89, v89, v60
    v_sub_f32 v90, v90, v60
    v_sub_f32 v91, v91, v60
    v_sub_f32 v92, v92, v60
    v_sub_f32 v93, v93, v60
    v_sub_f32 v94, v94, v60
    v_sub_f32 v95, v95, v60
    v_sub_f32 v96, v96, v61
    v_sub_f32 v97, v97, v61
    v_sub_f32 v98, v98, v61
    v_sub_f32 v99, v99, v61
    v_sub_f32 v100, v100, v61
    v_sub_f32 v101, v101, v61
    v_sub_f32 v102, v102, v61
    v_sub_f32 v103, v103, v61
    v_sub_f32 v104, v104, v61
    v_sub_f32 v105, v105, v61
    v_sub_f32 v106, v106, v61
    v_sub_f32 v107, v107, v61
    v_sub_f32 v108, v108, v61
    v_sub_f32 v109, v109, v61
    v_sub_f32 v110, v110, v61
    v_sub_f32 v111, v111, v61
    v_cvt_pk_bf16_f32 v112, v80, v81
    v_cvt_pk_bf16_f32 v113, v82, v83
    v_cvt_pk_bf16_f32 v114, v88, v89
    v_cvt_pk_bf16_f32 v115, v90, v91
    buffer_store_dwordx4 v[112:115], v14, s[16:19], s66 offen offset:0 sc1
    v_cvt_pk_bf16_f32 v116, v96, v97
    v_cvt_pk_bf16_f32 v117, v98, v99
    v_cvt_pk_bf16_f32 v118, v104, v105
    v_cvt_pk_bf16_f32 v119, v106, v107
    buffer_store_dwordx4 v[116:119], v15, s[16:19], s67 offen offset:0 sc1
    v_cvt_pk_bf16_f32 v120, v84, v85
    v_cvt_pk_bf16_f32 v121, v86, v87
    v_cvt_pk_bf16_f32 v122, v92, v93
    v_cvt_pk_bf16_f32 v123, v94, v95
    buffer_store_dwordx4 v[120:123], v14, s[16:19], s66 offen offset:256 sc1
    v_cvt_pk_bf16_f32 v124, v100, v101
    v_cvt_pk_bf16_f32 v125, v102, v103
    v_cvt_pk_bf16_f32 v126, v108, v109
    v_cvt_pk_bf16_f32 v127, v110, v111
    buffer_store_dwordx4 v[124:127], v15, s[16:19], s67 offen offset:256 sc1
row1_kernel_end:
    s_endpgm

.globl sf_kernel
.p2align 8
.type sf_kernel,@function
sf_kernel:
    s_cmp_ge_u32 s2, 256
    s_cbranch_scc1 sf_kernel_end
    s_load_dwordx2 s[4:5], s[0:1], 80
    s_load_dwordx2 s[42:43], s[0:1], 56
    s_load_dwordx2 s[66:67], s[0:1], 64
    v_lshrrev_b32 v2, 6, v0
    v_and_b32 v14, 63, v0
    v_readfirstlane_b32 s20, v2
    v_lshlrev_b32 v14, 4, v14
    s_and_b32 s6, s2, 7
    s_lshr_b32 s7, s2, 3
    s_and_b32 s8, s6, 1
    s_and_b32 s9, s7, 1
    s_andn2_b32 s6, s6, 1
    s_or_b32 s6, s6, s9
    s_lshr_b32 s7, s7, 1
    s_lshl_b32 s8, s8, 4
    s_add_u32 s7, s7, s8
    s_mul_i32 s72, s6, 1327104
    s_mul_i32 s22, s20, 331776
    s_add_u32 s72, s72, s22
    s_waitcnt lgkmcnt(0)
    s_add_u32 s68, s4, 201326592
    s_addc_u32 s69, s5, 0
    s_add_u32 s68, s68, s72
    s_addc_u32 s69, s69, 0
    s_mov_b32 s70, 331776
    s_mov_b32 s71, 0x20000
    s_mov_b32 s74, -1
    s_cmp_ge_u32 s2, 153
    s_cbranch_scc1 sf_kernel_ns
    v_lshrrev_b32 v2, 6, v0
    v_and_b32 v1, 63, v0
    v_readfirstlane_b32 s20, v2
    v_and_b32 v2, 15, v1
    v_lshrrev_b32 v3, 4, v1
    s_lshr_b32 s21, s2, 3
    s_and_b32 s22, s2, 7
    s_sub_u32 s23, s2, 144
    s_cmp_ge_u32 s2, 144
    s_cselect_b32 s21, s23, s21
    s_cselect_b32 s22, 0, s22
    s_cselect_b32 s24, 1, 0
    s_cmp_ge_u32 s21, 9
    s_cselect_b32 s25, 1, 0
    s_mul_i32 s26, s25, 9
    s_sub_u32 s26, s21, s26
    s_lshl_b32 s27, s22, 4
    s_lshl_b32 s28, s20, 2
    s_add_u32 s27, s27, s28
    v_lshrrev_b32 v4, 2, v2
    v_add_u32 v4, s27, v4
    v_and_b32 v5, 1, v2
    v_bfe_u32 v6, v2, 1, 1
    v_lshl_add_u32 v7, v4, 1, v5
    v_lshl_add_u32 v7, v7, 1, s25
    v_cmp_eq_u32 vcc, 1, v6
    v_sub_u32 v8, 1024, v7
    v_lshlrev_b32 v9, 9, v6
    v_cndmask_b32 v8, v7, v8, vcc
    v_cmp_eq_u32 vcc, 0, v7
    s_lshl_b32 s28, s24, 10
    s_cmp_eq_u32 s24, 1
    v_cndmask_b32 v8, v8, v9, vcc
    s_cselect_b64 vcc, -1, 0
    v_mov_b32 v9, s28
    v_cndmask_b32 v8, v8, v9, vcc
    v_cmp_ne_u32 s[60:61], 0, v8
    v_lshrrev_b32 v12, 1, v4
    v_mul_u32_u24 v12, 18432, v12
    v_and_b32 v13, 1, v4
    v_lshl_add_u32 v13, v13, 2, v6
    v_lshl_add_u32 v13, v13, 1, v5
    v_lshl_add_u32 v12, v13, 4, v12
    v_mov_b32 v13, 64
    v_cndmask_b32 v12, v12, v13, vcc
    v_lshl_add_u32 v12, v3, 8, v12
    s_mul_i32 s29, s25, 1179648
    s_lshl_b32 s28, s26, 11
    s_add_u32 s29, s29, s28
    v_lshlrev_b32 v14, 4, v1
    s_lshl_b32 s30, s21, 16
    s_lshl_b32 s31, s20, 10
    s_waitcnt lgkmcnt(0)
    s_add_u32 s8, s4, 216662016
    s_addc_u32 s9, s5, 0
    s_add_u32 s8, s8, s30
    s_addc_u32 s9, s9, 0
    s_mov_b32 s10, 65536
    s_mov_b32 s11, 0x20000
    s_add_u32 m0, s31, 0
    s_add_u32 s33, s31, 0
    buffer_load_dwordx4 v14, s[8:11], s33 offen lds
    s_add_u32 m0, s31, 32768
    s_add_u32 s33, s31, 32768
    buffer_load_dwordx4 v14, s[8:11], s33 offen lds
    s_add_u32 m0, s31, 4096
    s_add_u32 s33, s31, 4096
    buffer_load_dwordx4 v14, s[8:11], s33 offen lds
    s_add_u32 m0, s31, 36864
    s_add_u32 s33, s31, 36864
    buffer_load_dwordx4 v14, s[8:11], s33 offen lds
    s_add_u32 m0, s31, 8192
    s_add_u32 s33, s31, 8192
    buffer_load_dwordx4 v14, s[8:11], s33 offen lds
    s_add_u32 m0, s31, 40960
    s_add_u32 s33, s31, 40960
    buffer_load_dwordx4 v14, s[8:11], s33 offen lds
    s_add_u32 m0, s31, 12288
    s_add_u32 s33, s31, 12288
    buffer_load_dwordx4 v14, s[8:11], s33 offen lds
    s_add_u32 m0, s31, 45056
    s_add_u32 s33, s31, 45056
    buffer_load_dwordx4 v14, s[8:11], s33 offen lds
    s_add_u32 m0, s31, 16384
    s_add_u32 s33, s31, 16384
    buffer_load_dwordx4 v14, s[8:11], s33 offen lds
    s_add_u32 m0, s31, 49152
    s_add_u32 s33, s31, 49152
    buffer_load_dwordx4 v14, s[8:11], s33 offen lds
    s_add_u32 m0, s31, 20480
    s_add_u32 s33, s31, 20480
    buffer_load_dwordx4 v14, s[8:11], s33 offen lds
    s_add_u32 m0, s31, 53248
    s_add_u32 s33, s31, 53248
    buffer_load_dwordx4 v14, s[8:11], s33 offen lds
    s_add_u32 m0, s31, 24576
    s_add_u32 s33, s31, 24576
    buffer_load_dwordx4 v14, s[8:11], s33 offen lds
    s_add_u32 m0, s31, 57344
    s_add_u32 s33, s31, 57344
    buffer_load_dwordx4 v14, s[8:11], s33 offen lds
    s_add_u32 m0, s31, 28672
    s_add_u32 s33, s31, 28672
    buffer_load_dwordx4 v14, s[8:11], s33 offen lds
    s_add_u32 m0, s31, 61440
    s_add_u32 s33, s31, 61440
    buffer_load_dwordx4 v14, s[8:11], s33 offen lds
    s_add_u32 s12, s4, 217841664
    s_addc_u32 s13, s5, 0
    s_mov_b32 s14, 2048
    s_mov_b32 s15, 0x20000
    s_add_u32 s16, s4, 211943424
    s_addc_u32 s17, s5, 0
    s_mov_b32 s18, 2359296
    s_mov_b32 s19, 0x20000
    s_add_u32 s52, s4, 214302720
    s_addc_u32 s53, s5, 0
    s_mov_b32 s54, 2359296
    s_mov_b32 s55, 0x20000
    s_cmp_eq_u32 s25, 0
    s_cselect_b32 s34, 1.0, -1.0
    s_mul_i32 s35, s25, 576
    s_lshl_b32 s36, s26, 6
    s_add_u32 s35, s35, s36
    v_lshlrev_b32 v15, 3, v3
    buffer_load_dwordx2 v[18:19], v15, s[12:15], s35 offen offset:0
    buffer_load_dwordx2 v[20:21], v15, s[12:15], s35 offen offset:32
    buffer_load_dwordx4 v[24:27], v12, s[16:19], s29 offen offset:0
    buffer_load_dwordx4 v[28:31], v12, s[16:19], s29 offen offset:64
    buffer_load_dwordx4 v[32:35], v12, s[16:19], s29 offen offset:1024
    buffer_load_dwordx4 v[36:39], v12, s[16:19], s29 offen offset:1088
    v_lshrrev_b32 v40, 2, v2
    v_lshl_add_u32 v40, v3, 3, v40
    v_lshlrev_b32 v40, 6, v40
    v_and_b32 v41, 3, v2
    v_lshl_add_u32 v40, v41, 3, v40
    v_and_b32 v41, 1, v3
    v_lshl_add_u32 v40, v41, 5, v40
    v_xor_b32 v41, 32, v40
    v_lshlrev_b32 v16, 30, v8
    v_and_b32 v16, 0x80000000, v16
    v_xor_b32 v16, s34, v16
    v_mul_u32_u24 v62, v8, v15
    v_lshlrev_b32 v63, 5, v8
    v_add_u32 v226, v62, v8
    v_add_u32 v240, v62, v63
    v_add_u32 v242, v240, v8
    v_and_b32 v225, 2047, v62
    v_cvt_f32_u32 v225, v225
    v_mul_f32 v225, 0x3a000000, v225
    v_and_b32 v227, 2047, v226
    v_cvt_f32_u32 v227, v227
    v_mul_f32 v227, 0x3a000000, v227
    v_and_b32 v241, 2047, v240
    v_cvt_f32_u32 v241, v241
    v_mul_f32 v241, 0x3a000000, v241
    v_and_b32 v243, 2047, v242
    v_cvt_f32_u32 v243, v243
    v_mul_f32 v243, 0x3a000000, v243
    v_and_b32 v60, 2047, v8
    v_cvt_f32_u32 v60, v60
    v_mul_f32 v60, 0x3a000000, v60
    v_and_b32 v61, 2047, v63
    v_cvt_f32_u32 v61, v61
    v_mul_f32 v61, 0x3a000000, v61
    v_cos_f32 v60, v60
    v_cos_f32 v61, v61
    v_cos_f32 v224, v225
    v_sin_f32 v225, -v225
    v_cos_f32 v226, v227
    v_sin_f32 v227, -v227
    v_cos_f32 v240, v241
    v_sin_f32 v241, -v241
    v_cos_f32 v242, v243
    v_sin_f32 v243, -v243
    v_add_f32 v60, v60, v60
    v_add_f32 v61, v61, v61
    v_pk_fma_f32 v[228:229], v[60:61], v[226:227], v[224:225] op_sel:[0,0,0] op_sel_hi:[0,1,1] neg_lo:[0,0,1] neg_hi:[0,0,1]
    v_pk_fma_f32 v[244:245], v[60:61], v[242:243], v[240:241] op_sel:[0,0,0] op_sel_hi:[0,1,1] neg_lo:[0,0,1] neg_hi:[0,0,1]
    v_pk_fma_f32 v[230:231], v[60:61], v[228:229], v[226:227] op_sel:[0,0,0] op_sel_hi:[0,1,1] neg_lo:[0,0,1] neg_hi:[0,0,1]
    v_pk_fma_f32 v[246:247], v[60:61], v[244:245], v[242:243] op_sel:[0,0,0] op_sel_hi:[0,1,1] neg_lo:[0,0,1] neg_hi:[0,0,1]
    v_pk_fma_f32 v[232:233], v[60:61], v[230:231], v[228:229] op_sel:[0,0,0] op_sel_hi:[0,1,1] neg_lo:[0,0,1] neg_hi:[0,0,1]
    v_pk_fma_f32 v[248:249], v[60:61], v[246:247], v[244:245] op_sel:[0,0,0] op_sel_hi:[0,1,1] neg_lo:[0,0,1] neg_hi:[0,0,1]
    v_pk_fma_f32 v[234:235], v[60:61], v[232:233], v[230:231] op_sel:[0,0,0] op_sel_hi:[0,1,1] neg_lo:[0,0,1] neg_hi:[0,0,1]
    v_pk_fma_f32 v[250:251], v[60:61], v[248:249], v[246:247] op_sel:[0,0,0] op_sel_hi:[0,1,1] neg_lo:[0,0,1] neg_hi:[0,0,1]
    v_pk_fma_f32 v[236:237], v[60:61], v[234:235], v[232:233] op_sel:[0,0,0] op_sel_hi:[0,1,1] neg_lo:[0,0,1] neg_hi:[0,0,1]
    v_pk_fma_f32 v[252:253], v[60:61], v[250:251], v[248:249] op_sel:[0,0,0] op_sel_hi:[0,1,1] neg_lo:[0,0,1] neg_hi:[0,0,1]
    v_pk_fma_f32 v[238:239], v[60:61], v[236:237], v[234:235] op_sel:[0,0,0] op_sel_hi:[0,1,1] neg_lo:[0,0,1] neg_hi:[0,0,1]
    v_pk_fma_f32 v[254:255], v[60:61], v[252:253], v[250:251] op_sel:[0,0,0] op_sel_hi:[0,1,1] neg_lo:[0,0,1] neg_hi:[0,0,1]
    v_cvt_pk_bf16_f32 v64, v224, v226
    v_cvt_pk_bf16_f32 v128, v225, v227
    v_cvt_pk_bf16_f32 v65, v228, v230
    v_cvt_pk_bf16_f32 v129, v229, v231
    v_cvt_pk_bf16_f32 v66, v232, v234
    v_cvt_pk_bf16_f32 v130, v233, v235
    v_cvt_pk_bf16_f32 v67, v236, v238
    v_cvt_pk_bf16_f32 v131, v237, v239
    v_pk_fma_f32 v[224:225], v[60:61], v[240:241], v[224:225] op_sel:[1,0,0] op_sel_hi:[1,1,1] neg_lo:[0,0,1] neg_hi:[0,0,1]
    v_pk_fma_f32 v[226:227], v[60:61], v[242:243], v[226:227] op_sel:[1,0,0] op_sel_hi:[1,1,1] neg_lo:[0,0,1] neg_hi:[0,0,1]
    v_pk_fma_f32 v[228:229], v[60:61], v[244:245], v[228:229] op_sel:[1,0,0] op_sel_hi:[1,1,1] neg_lo:[0,0,1] neg_hi:[0,0,1]
    v_pk_fma_f32 v[230:231], v[60:61], v[246:247], v[230:231] op_sel:[1,0,0] op_sel_hi:[1,1,1] neg_lo:[0,0,1] neg_hi:[0,0,1]
    v_pk_fma_f32 v[232:233], v[60:61], v[248:249], v[232:233] op_sel:[1,0,0] op_sel_hi:[1,1,1] neg_lo:[0,0,1] neg_hi:[0,0,1]
    v_pk_fma_f32 v[234:235], v[60:61], v[250:251], v[234:235] op_sel:[1,0,0] op_sel_hi:[1,1,1] neg_lo:[0,0,1] neg_hi:[0,0,1]
    v_pk_fma_f32 v[236:237], v[60:61], v[252:253], v[236:237] op_sel:[1,0,0] op_sel_hi:[1,1,1] neg_lo:[0,0,1] neg_hi:[0,0,1]
    v_pk_fma_f32 v[238:239], v[60:61], v[254:255], v[238:239] op_sel:[1,0,0] op_sel_hi:[1,1,1] neg_lo:[0,0,1] neg_hi:[0,0,1]
    v_cvt_pk_bf16_f32 v68, v240, v242
    v_cvt_pk_bf16_f32 v132, v241, v243
    v_cvt_pk_bf16_f32 v69, v244, v246
    v_cvt_pk_bf16_f32 v133, v245, v247
    v_cvt_pk_bf16_f32 v70, v248, v250
    v_cvt_pk_bf16_f32 v134, v249, v251
    v_cvt_pk_bf16_f32 v71, v252, v254
    v_cvt_pk_bf16_f32 v135, v253, v255
    v_pk_fma_f32 v[240:241], v[60:61], v[224:225], v[240:241] op_sel:[1,0,0] op_sel_hi:[1,1,1] neg_lo:[0,0,1] neg_hi:[0,0,1]
    v_pk_fma_f32 v[242:243], v[60:61], v[226:227], v[242:243] op_sel:[1,0,0] op_sel_hi:[1,1,1] neg_lo:[0,0,1] neg_hi:[0,0,1]
    v_pk_fma_f32 v[244:245], v[60:61], v[228:229], v[244:245] op_sel:[1,0,0] op_sel_hi:[1,1,1] neg_lo:[0,0,1] neg_hi:[0,0,1]
    v_pk_fma_f32 v[246:247], v[60:61], v[230:231], v[246:247] op_sel:[1,0,0] op_sel_hi:[1,1,1] neg_lo:[0,0,1] neg_hi:[0,0,1]
    v_pk_fma_f32 v[248:249], v[60:61], v[232:233], v[248:249] op_sel:[1,0,0] op_sel_hi:[1,1,1] neg_lo:[0,0,1] neg_hi:[0,0,1]
    v_pk_fma_f32 v[250:251], v[60:61], v[234:235], v[250:251] op_sel:[1,0,0] op_sel_hi:[1,1,1] neg_lo:[0,0,1] neg_hi:[0,0,1]
    v_pk_fma_f32 v[252:253], v[60:61], v[236:237], v[252:253] op_sel:[1,0,0] op_sel_hi:[1,1,1] neg_lo:[0,0,1] neg_hi:[0,0,1]
    v_pk_fma_f32 v[254:255], v[60:61], v[238:239], v[254:255] op_sel:[1,0,0] op_sel_hi:[1,1,1] neg_lo:[0,0,1] neg_hi:[0,0,1]
    v_cvt_pk_bf16_f32 v72, v224, v226
    v_cvt_pk_bf16_f32 v136, v225, v227
    v_cvt_pk_bf16_f32 v73, v228, v230
    v_cvt_pk_bf16_f32 v137, v229, v231
    v_cvt_pk_bf16_f32 v74, v232, v234
    v_cvt_pk_bf16_f32 v138, v233, v235
    v_cvt_pk_bf16_f32 v75, v236, v238
    v_cvt_pk_bf16_f32 v139, v237, v239
    v_pk_fma_f32 v[224:225], v[60:61], v[240:241], v[224:225] op_sel:[1,0,0] op_sel_hi:[1,1,1] neg_lo:[0,0,1] neg_hi:[0,0,1]
    v_pk_fma_f32 v[226:227], v[60:61], v[242:243], v[226:227] op_sel:[1,0,0] op_sel_hi:[1,1,1] neg_lo:[0,0,1] neg_hi:[0,0,1]
    v_pk_fma_f32 v[228:229], v[60:61], v[244:245], v[228:229] op_sel:[1,0,0] op_sel_hi:[1,1,1] neg_lo:[0,0,1] neg_hi:[0,0,1]
    v_pk_fma_f32 v[230:231], v[60:61], v[246:247], v[230:231] op_sel:[1,0,0] op_sel_hi:[1,1,1] neg_lo:[0,0,1] neg_hi:[0,0,1]
    v_pk_fma_f32 v[232:233], v[60:61], v[248:249], v[232:233] op_sel:[1,0,0] op_sel_hi:[1,1,1] neg_lo:[0,0,1] neg_hi:[0,0,1]
    v_pk_fma_f32 v[234:235], v[60:61], v[250:251], v[234:235] op_sel:[1,0,0] op_sel_hi:[1,1,1] neg_lo:[0,0,1] neg_hi:[0,0,1]
    v_pk_fma_f32 v[236:237], v[60:61], v[252:253], v[236:237] op_sel:[1,0,0] op_sel_hi:[1,1,1] neg_lo:[0,0,1] neg_hi:[0,0,1]
    v_pk_fma_f32 v[238:239], v[60:61], v[254:255], v[238:239] op_sel:[1,0,0] op_sel_hi:[1,1,1] neg_lo:[0,0,1] neg_hi:[0,0,1]
    v_cvt_pk_bf16_f32 v76, v240, v242
    v_cvt_pk_bf16_f32 v140, v241, v243
    v_cvt_pk_bf16_f32 v77, v244, v246
    v_cvt_pk_bf16_f32 v141, v245, v247
    v_cvt_pk_bf16_f32 v78, v248, v250
    v_cvt_pk_bf16_f32 v142, v249, v251
    v_cvt_pk_bf16_f32 v79, v252, v254
    v_cvt_pk_bf16_f32 v143, v253, v255
    v_pk_fma_f32 v[240:241], v[60:61], v[224:225], v[240:241] op_sel:[1,0,0] op_sel_hi:[1,1,1] neg_lo:[0,0,1] neg_hi:[0,0,1]
    v_pk_fma_f32 v[242:243], v[60:61], v[226:227], v[242:243] op_sel:[1,0,0] op_sel_hi:[1,1,1] neg_lo:[0,0,1] neg_hi:[0,0,1]
    v_pk_fma_f32 v[244:245], v[60:61], v[228:229], v[244:245] op_sel:[1,0,0] op_sel_hi:[1,1,1] neg_lo:[0,0,1] neg_hi:[0,0,1]
    v_pk_fma_f32 v[246:247], v[60:61], v[230:231], v[246:247] op_sel:[1,0,0] op_sel_hi:[1,1,1] neg_lo:[0,0,1] neg_hi:[0,0,1]
    v_pk_fma_f32 v[248:249], v[60:61], v[232:233], v[248:249] op_sel:[1,0,0] op_sel_hi:[1,1,1] neg_lo:[0,0,1] neg_hi:[0,0,1]
    v_pk_fma_f32 v[250:251], v[60:61], v[234:235], v[250:251] op_sel:[1,0,0] op_sel_hi:[1,1,1] neg_lo:[0,0,1] neg_hi:[0,0,1]
    v_pk_fma_f32 v[252:253], v[60:61], v[236:237], v[252:253] op_sel:[1,0,0] op_sel_hi:[1,1,1] neg_lo:[0,0,1] neg_hi:[0,0,1]
    v_pk_fma_f32 v[254:255], v[60:61], v[238:239], v[254:255] op_sel:[1,0,0] op_sel_hi:[1,1,1] neg_lo:[0,0,1] neg_hi:[0,0,1]
    v_cvt_pk_bf16_f32 v80, v224, v226
    v_cvt_pk_bf16_f32 v144, v225, v227
    v_cvt_pk_bf16_f32 v81, v228, v230
    v_cvt_pk_bf16_f32 v145, v229, v231
    v_cvt_pk_bf16_f32 v82, v232, v234
    v_cvt_pk_bf16_f32 v146, v233, v235
    v_cvt_pk_bf16_f32 v83, v236, v238
    v_cvt_pk_bf16_f32 v147, v237, v239
    v_pk_fma_f32 v[224:225], v[60:61], v[240:241], v[224:225] op_sel:[1,0,0] op_sel_hi:[1,1,1] neg_lo:[0,0,1] neg_hi:[0,0,1]
    v_pk_fma_f32 v[226:227], v[60:61], v[242:243], v[226:227] op_sel:[1,0,0] op_sel_hi:[1,1,1] neg_lo:[0,0,1] neg_hi:[0,0,1]
    v_pk_fma_f32 v[228:229], v[60:61], v[244:245], v[228:229] op_sel:[1,0,0] op_sel_hi:[1,1,1] neg_lo:[0,0,1] neg_hi:[0,0,1]
    v_pk_fma_f32 v[230:231], v[60:61], v[246:247], v[230:231] op_sel:[1,0,0] op_sel_hi:[1,1,1] neg_lo:[0,0,1] neg_hi:[0,0,1]
    v_pk_fma_f32 v[232:233], v[60:61], v[248:249], v[232:233] op_sel:[1,0,0] op_sel_hi:[1,1,1] neg_lo:[0,0,1] neg_hi:[0,0,1]
    v_pk_fma_f32 v[234:235], v[60:61], v[250:251], v[234:235] op_sel:[1,0,0] op_sel_hi:[1,1,1] neg_lo:[0,0,1] neg_hi:[0,0,1]
    v_pk_fma_f32 v[236:237], v[60:61], v[252:253], v[236:237] op_sel:[1,0,0] op_sel_hi:[1,1,1] neg_lo:[0,0,1] neg_hi:[0,0,1]
    v_pk_fma_f32 v[238:239], v[60:61], v[254:255], v[238:239] op_sel:[1,0,0] op_sel_hi:[1,1,1] neg_lo:[0,0,1] neg_hi:[0,0,1]
    v_cvt_pk_bf16_f32 v84, v240, v242
    v_cvt_pk_bf16_f32 v148, v241, v243
    v_cvt_pk_bf16_f32 v85, v244, v246
    v_cvt_pk_bf16_f32 v149, v245, v247
    v_cvt_pk_bf16_f32 v86, v248, v250
    v_cvt_pk_bf16_f32 v150, v249, v251
    v_cvt_pk_bf16_f32 v87, v252, v254
    v_cvt_pk_bf16_f32 v151, v253, v255
    v_pk_fma_f32 v[240:241], v[60:61], v[224:225], v[240:241] op_sel:[1,0,0] op_sel_hi:[1,1,1] neg_lo:[0,0,1] neg_hi:[0,0,1]
    v_pk_fma_f32 v[242:243], v[60:61], v[226:227], v[242:243] op_sel:[1,0,0] op_sel_hi:[1,1,1] neg_lo:[0,0,1] neg_hi:[0,0,1]
    v_pk_fma_f32 v[244:245], v[60:61], v[228:229], v[244:245] op_sel:[1,0,0] op_sel_hi:[1,1,1] neg_lo:[0,0,1] neg_hi:[0,0,1]
    v_pk_fma_f32 v[246:247], v[60:61], v[230:231], v[246:247] op_sel:[1,0,0] op_sel_hi:[1,1,1] neg_lo:[0,0,1] neg_hi:[0,0,1]
    v_pk_fma_f32 v[248:249], v[60:61], v[232:233], v[248:249] op_sel:[1,0,0] op_sel_hi:[1,1,1] neg_lo:[0,0,1] neg_hi:[0,0,1]
    v_pk_fma_f32 v[250:251], v[60:61], v[234:235], v[250:251] op_sel:[1,0,0] op_sel_hi:[1,1,1] neg_lo:[0,0,1] neg_hi:[0,0,1]
    v_pk_fma_f32 v[252:253], v[60:61], v[236:237], v[252:253] op_sel:[1,0,0] op_sel_hi:[1,1,1] neg_lo:[0,0,1] neg_hi:[0,0,1]
    v_pk_fma_f32 v[254:255], v[60:61], v[238:239], v[254:255] op_sel:[1,0,0] op_sel_hi:[1,1,1] neg_lo:[0,0,1] neg_hi:[0,0,1]
    v_cvt_pk_bf16_f32 v88, v224, v226
    v_cvt_pk_bf16_f32 v152, v225, v227
    v_cvt_pk_bf16_f32 v89, v228, v230
    v_cvt_pk_bf16_f32 v153, v229, v231
    v_cvt_pk_bf16_f32 v90, v232, v234
    v_cvt_pk_bf16_f32 v154, v233, v235
    v_cvt_pk_bf16_f32 v91, v236, v238
    v_cvt_pk_bf16_f32 v155, v237, v239
    v_pk_fma_f32 v[224:225], v[60:61], v[240:241], v[224:225] op_sel:[1,0,0] op_sel_hi:[1,1,1] neg_lo:[0,0,1] neg_hi:[0,0,1]
    v_pk_fma_f32 v[226:227], v[60:61], v[242:243], v[226:227] op_sel:[1,0,0] op_sel_hi:[1,1,1] neg_lo:[0,0,1] neg_hi:[0,0,1]
    v_pk_fma_f32 v[228:229], v[60:61], v[244:245], v[228:229] op_sel:[1,0,0] op_sel_hi:[1,1,1] neg_lo:[0,0,1] neg_hi:[0,0,1]
    v_pk_fma_f32 v[230:231], v[60:61], v[246:247], v[230:231] op_sel:[1,0,0] op_sel_hi:[1,1,1] neg_lo:[0,0,1] neg_hi:[0,0,1]
    v_pk_fma_f32 v[232:233], v[60:61], v[248:249], v[232:233] op_sel:[1,0,0] op_sel_hi:[1,1,1] neg_lo:[0,0,1] neg_hi:[0,0,1]
    v_pk_fma_f32 v[234:235], v[60:61], v[250:251], v[234:235] op_sel:[1,0,0] op_sel_hi:[1,1,1] neg_lo:[0,0,1] neg_hi:[0,0,1]
    v_pk_fma_f32 v[236:237], v[60:61], v[252:253], v[236:237] op_sel:[1,0,0] op_sel_hi:[1,1,1] neg_lo:[0,0,1] neg_hi:[0,0,1]
    v_pk_fma_f32 v[238:239], v[60:61], v[254:255], v[238:239] op_sel:[1,0,0] op_sel_hi:[1,1,1] neg_lo:[0,0,1] neg_hi:[0,0,1]
    v_cvt_pk_bf16_f32 v92, v240, v242
    v_cvt_pk_bf16_f32 v156, v241, v243
    v_cvt_pk_bf16_f32 v93, v244, v246
    v_cvt_pk_bf16_f32 v157, v245, v247
    v_cvt_pk_bf16_f32 v94, v248, v250
    v_cvt_pk_bf16_f32 v158, v249, v251
    v_cvt_pk_bf16_f32 v95, v252, v254
    v_cvt_pk_bf16_f32 v159, v253, v255
    v_pk_fma_f32 v[240:241], v[60:61], v[224:225], v[240:241] op_sel:[1,0,0] op_sel_hi:[1,1,1] neg_lo:[0,0,1] neg_hi:[0,0,1]
    v_pk_fma_f32 v[242:243], v[60:61], v[226:227], v[242:243] op_sel:[1,0,0] op_sel_hi:[1,1,1] neg_lo:[0,0,1] neg_hi:[0,0,1]
    v_pk_fma_f32 v[244:245], v[60:61], v[228:229], v[244:245] op_sel:[1,0,0] op_sel_hi:[1,1,1] neg_lo:[0,0,1] neg_hi:[0,0,1]
    v_pk_fma_f32 v[246:247], v[60:61], v[230:231], v[246:247] op_sel:[1,0,0] op_sel_hi:[1,1,1] neg_lo:[0,0,1] neg_hi:[0,0,1]
    v_pk_fma_f32 v[248:249], v[60:61], v[232:233], v[248:249] op_sel:[1,0,0] op_sel_hi:[1,1,1] neg_lo:[0,0,1] neg_hi:[0,0,1]
    v_pk_fma_f32 v[250:251], v[60:61], v[234:235], v[250:251] op_sel:[1,0,0] op_sel_hi:[1,1,1] neg_lo:[0,0,1] neg_hi:[0,0,1]
    v_pk_fma_f32 v[252:253], v[60:61], v[236:237], v[252:253] op_sel:[1,0,0] op_sel_hi:[1,1,1] neg_lo:[0,0,1] neg_hi:[0,0,1]
    v_pk_fma_f32 v[254:255], v[60:61], v[238:239], v[254:255] op_sel:[1,0,0] op_sel_hi:[1,1,1] neg_lo:[0,0,1] neg_hi:[0,0,1]
    v_cvt_pk_bf16_f32 v96, v224, v226
    v_cvt_pk_bf16_f32 v160, v225, v227
    v_cvt_pk_bf16_f32 v97, v228, v230
    v_cvt_pk_bf16_f32 v161, v229, v231
    v_cvt_pk_bf16_f32 v98, v232, v234
    v_cvt_pk_bf16_f32 v162, v233, v235
    v_cvt_pk_bf16_f32 v99, v236, v238
    v_cvt_pk_bf16_f32 v163, v237, v239
    v_pk_fma_f32 v[224:225], v[60:61], v[240:241], v[224:225] op_sel:[1,0,0] op_sel_hi:[1,1,1] neg_lo:[0,0,1] neg_hi:[0,0,1]
    v_pk_fma_f32 v[226:227], v[60:61], v[242:243], v[226:227] op_sel:[1,0,0] op_sel_hi:[1,1,1] neg_lo:[0,0,1] neg_hi:[0,0,1]
    v_pk_fma_f32 v[228:229], v[60:61], v[244:245], v[228:229] op_sel:[1,0,0] op_sel_hi:[1,1,1] neg_lo:[0,0,1] neg_hi:[0,0,1]
    v_pk_fma_f32 v[230:231], v[60:61], v[246:247], v[230:231] op_sel:[1,0,0] op_sel_hi:[1,1,1] neg_lo:[0,0,1] neg_hi:[0,0,1]
    v_pk_fma_f32 v[232:233], v[60:61], v[248:249], v[232:233] op_sel:[1,0,0] op_sel_hi:[1,1,1] neg_lo:[0,0,1] neg_hi:[0,0,1]
    v_pk_fma_f32 v[234:235], v[60:61], v[250:251], v[234:235] op_sel:[1,0,0] op_sel_hi:[1,1,1] neg_lo:[0,0,1] neg_hi:[0,0,1]
    v_pk_fma_f32 v[236:237], v[60:61], v[252:253], v[236:237] op_sel:[1,0,0] op_sel_hi:[1,1,1] neg_lo:[0,0,1] neg_hi:[0,0,1]
    v_pk_fma_f32 v[238:239], v[60:61], v[254:255], v[238:239] op_sel:[1,0,0] op_sel_hi:[1,1,1] neg_lo:[0,0,1] neg_hi:[0,0,1]
    v_cvt_pk_bf16_f32 v100, v240, v242
    v_cvt_pk_bf16_f32 v164, v241, v243
    v_cvt_pk_bf16_f32 v101, v244, v246
    v_cvt_pk_bf16_f32 v165, v245, v247
    v_cvt_pk_bf16_f32 v102, v248, v250
    v_cvt_pk_bf16_f32 v166, v249, v251
    v_cvt_pk_bf16_f32 v103, v252, v254
    v_cvt_pk_bf16_f32 v167, v253, v255
    v_pk_fma_f32 v[240:241], v[60:61], v[224:225], v[240:241] op_sel:[1,0,0] op_sel_hi:[1,1,1] neg_lo:[0,0,1] neg_hi:[0,0,1]
    v_pk_fma_f32 v[242:243], v[60:61], v[226:227], v[242:243] op_sel:[1,0,0] op_sel_hi:[1,1,1] neg_lo:[0,0,1] neg_hi:[0,0,1]
    v_pk_fma_f32 v[244:245], v[60:61], v[228:229], v[244:245] op_sel:[1,0,0] op_sel_hi:[1,1,1] neg_lo:[0,0,1] neg_hi:[0,0,1]
    v_pk_fma_f32 v[246:247], v[60:61], v[230:231], v[246:247] op_sel:[1,0,0] op_sel_hi:[1,1,1] neg_lo:[0,0,1] neg_hi:[0,0,1]
    v_pk_fma_f32 v[248:249], v[60:61], v[232:233], v[248:249] op_sel:[1,0,0] op_sel_hi:[1,1,1] neg_lo:[0,0,1] neg_hi:[0,0,1]
    v_pk_fma_f32 v[250:251], v[60:61], v[234:235], v[250:251] op_sel:[1,0,0] op_sel_hi:[1,1,1] neg_lo:[0,0,1] neg_hi:[0,0,1]
    v_pk_fma_f32 v[252:253], v[60:61], v[236:237], v[252:253] op_sel:[1,0,0] op_sel_hi:[1,1,1] neg_lo:[0,0,1] neg_hi:[0,0,1]
    v_pk_fma_f32 v[254:255], v[60:61], v[238:239], v[254:255] op_sel:[1,0,0] op_sel_hi:[1,1,1] neg_lo:[0,0,1] neg_hi:[0,0,1]
    v_cvt_pk_bf16_f32 v104, v224, v226
    v_cvt_pk_bf16_f32 v168, v225, v227
    v_cvt_pk_bf16_f32 v105, v228, v230
    v_cvt_pk_bf16_f32 v169, v229, v231
    v_cvt_pk_bf16_f32 v106, v232, v234
    v_cvt_pk_bf16_f32 v170, v233, v235
    v_cvt_pk_bf16_f32 v107, v236, v238
    v_cvt_pk_bf16_f32 v171, v237, v239
    v_pk_fma_f32 v[224:225], v[60:61], v[240:241], v[224:225] op_sel:[1,0,0] op_sel_hi:[1,1,1] neg_lo:[0,0,1] neg_hi:[0,0,1]
    v_pk_fma_f32 v[226:227], v[60:61], v[242:243], v[226:227] op_sel:[1,0,0] op_sel_hi:[1,1,1] neg_lo:[0,0,1] neg_hi:[0,0,1]
    v_pk_fma_f32 v[228:229], v[60:61], v[244:245], v[228:229] op_sel:[1,0,0] op_sel_hi:[1,1,1] neg_lo:[0,0,1] neg_hi:[0,0,1]
    v_pk_fma_f32 v[230:231], v[60:61], v[246:247], v[230:231] op_sel:[1,0,0] op_sel_hi:[1,1,1] neg_lo:[0,0,1] neg_hi:[0,0,1]
    v_pk_fma_f32 v[232:233], v[60:61], v[248:249], v[232:233] op_sel:[1,0,0] op_sel_hi:[1,1,1] neg_lo:[0,0,1] neg_hi:[0,0,1]
    v_pk_fma_f32 v[234:235], v[60:61], v[250:251], v[234:235] op_sel:[1,0,0] op_sel_hi:[1,1,1] neg_lo:[0,0,1] neg_hi:[0,0,1]
    v_pk_fma_f32 v[236:237], v[60:61], v[252:253], v[236:237] op_sel:[1,0,0] op_sel_hi:[1,1,1] neg_lo:[0,0,1] neg_hi:[0,0,1]
    v_pk_fma_f32 v[238:239], v[60:61], v[254:255], v[238:239] op_sel:[1,0,0] op_sel_hi:[1,1,1] neg_lo:[0,0,1] neg_hi:[0,0,1]
    v_cvt_pk_bf16_f32 v108, v240, v242
    v_cvt_pk_bf16_f32 v172, v241, v243
    v_cvt_pk_bf16_f32 v109, v244, v246
    v_cvt_pk_bf16_f32 v173, v245, v247
    v_cvt_pk_bf16_f32 v110, v248, v250
    v_cvt_pk_bf16_f32 v174, v249, v251
    v_cvt_pk_bf16_f32 v111, v252, v254
    v_cvt_pk_bf16_f32 v175, v253, v255
    v_pk_fma_f32 v[240:241], v[60:61], v[224:225], v[240:241] op_sel:[1,0,0] op_sel_hi:[1,1,1] neg_lo:[0,0,1] neg_hi:[0,0,1]
    v_pk_fma_f32 v[242:243], v[60:61], v[226:227], v[242:243] op_sel:[1,0,0] op_sel_hi:[1,1,1] neg_lo:[0,0,1] neg_hi:[0,0,1]
    v_pk_fma_f32 v[244:245], v[60:61], v[228:229], v[244:245] op_sel:[1,0,0] op_sel_hi:[1,1,1] neg_lo:[0,0,1] neg_hi:[0,0,1]
    v_pk_fma_f32 v[246:247], v[60:61], v[230:231], v[246:247] op_sel:[1,0,0] op_sel_hi:[1,1,1] neg_lo:[0,0,1] neg_hi:[0,0,1]
    v_pk_fma_f32 v[248:249], v[60:61], v[232:233], v[248:249] op_sel:[1,0,0] op_sel_hi:[1,1,1] neg_lo:[0,0,1] neg_hi:[0,0,1]
    v_pk_fma_f32 v[250:251], v[60:61], v[234:235], v[250:251] op_sel:[1,0,0] op_sel_hi:[1,1,1] neg_lo:[0,0,1] neg_hi:[0,0,1]
    v_pk_fma_f32 v[252:253], v[60:61], v[236:237], v[252:253] op_sel:[1,0,0] op_sel_hi:[1,1,1] neg_lo:[0,0,1] neg_hi:[0,0,1]
    v_pk_fma_f32 v[254:255], v[60:61], v[238:239], v[254:255] op_sel:[1,0,0] op_sel_hi:[1,1,1] neg_lo:[0,0,1] neg_hi:[0,0,1]
    v_cvt_pk_bf16_f32 v112, v224, v226
    v_cvt_pk_bf16_f32 v176, v225, v227
    v_cvt_pk_bf16_f32 v113, v228, v230
    v_cvt_pk_bf16_f32 v177, v229, v231
    v_cvt_pk_bf16_f32 v114, v232, v234
    v_cvt_pk_bf16_f32 v178, v233, v235
    v_cvt_pk_bf16_f32 v115, v236, v238
    v_cvt_pk_bf16_f32 v179, v237, v239
    v_pk_fma_f32 v[224:225], v[60:61], v[240:241], v[224:225] op_sel:[1,0,0] op_sel_hi:[1,1,1] neg_lo:[0,0,1] neg_hi:[0,0,1]
    v_pk_fma_f32 v[226:227], v[60:61], v[242:243], v[226:227] op_sel:[1,0,0] op_sel_hi:[1,1,1] neg_lo:[0,0,1] neg_hi:[0,0,1]
    v_pk_fma_f32 v[228:229], v[60:61], v[244:245], v[228:229] op_sel:[1,0,0] op_sel_hi:[1,1,1] neg_lo:[0,0,1] neg_hi:[0,0,1]
    v_pk_fma_f32 v[230:231], v[60:61], v[246:247], v[230:231] op_sel:[1,0,0] op_sel_hi:[1,1,1] neg_lo:[0,0,1] neg_hi:[0,0,1]
    v_pk_fma_f32 v[232:233], v[60:61], v[248:249], v[232:233] op_sel:[1,0,0] op_sel_hi:[1,1,1] neg_lo:[0,0,1] neg_hi:[0,0,1]
    v_pk_fma_f32 v[234:235], v[60:61], v[250:251], v[234:235] op_sel:[1,0,0] op_sel_hi:[1,1,1] neg_lo:[0,0,1] neg_hi:[0,0,1]
    v_pk_fma_f32 v[236:237], v[60:61], v[252:253], v[236:237] op_sel:[1,0,0] op_sel_hi:[1,1,1] neg_lo:[0,0,1] neg_hi:[0,0,1]
    v_pk_fma_f32 v[238:239], v[60:61], v[254:255], v[238:239] op_sel:[1,0,0] op_sel_hi:[1,1,1] neg_lo:[0,0,1] neg_hi:[0,0,1]
    v_cvt_pk_bf16_f32 v116, v240, v242
    v_cvt_pk_bf16_f32 v180, v241, v243
    v_cvt_pk_bf16_f32 v117, v244, v246
    v_cvt_pk_bf16_f32 v181, v245, v247
    v_cvt_pk_bf16_f32 v118, v248, v250
    v_cvt_pk_bf16_f32 v182, v249, v251
    v_cvt_pk_bf16_f32 v119, v252, v254
    v_cvt_pk_bf16_f32 v183, v253, v255
    v_pk_fma_f32 v[240:241], v[60:61], v[224:225], v[240:241] op_sel:[1,0,0] op_sel_hi:[1,1,1] neg_lo:[0,0,1] neg_hi:[0,0,1]
    v_pk_fma_f32 v[242:243], v[60:61], v[226:227], v[242:243] op_sel:[1,0,0] op_sel_hi:[1,1,1] neg_lo:[0,0,1] neg_hi:[0,0,1]
    v_pk_fma_f32 v[244:245], v[60:61], v[228:229], v[244:245] op_sel:[1,0,0] op_sel_hi:[1,1,1] neg_lo:[0,0,1] neg_hi:[0,0,1]
    v_pk_fma_f32 v[246:247], v[60:61], v[230:231], v[246:247] op_sel:[1,0,0] op_sel_hi:[1,1,1] neg_lo:[0,0,1] neg_hi:[0,0,1]
    v_pk_fma_f32 v[248:249], v[60:61], v[232:233], v[248:249] op_sel:[1,0,0] op_sel_hi:[1,1,1] neg_lo:[0,0,1] neg_hi:[0,0,1]
    v_pk_fma_f32 v[250:251], v[60:61], v[234:235], v[250:251] op_sel:[1,0,0] op_sel_hi:[1,1,1] neg_lo:[0,0,1] neg_hi:[0,0,1]
    v_pk_fma_f32 v[252:253], v[60:61], v[236:237], v[252:253] op_sel:[1,0,0] op_sel_hi:[1,1,1] neg_lo:[0,0,1] neg_hi:[0,0,1]
    v_pk_fma_f32 v[254:255], v[60:61], v[238:239], v[254:255] op_sel:[1,0,0] op_sel_hi:[1,1,1] neg_lo:[0,0,1] neg_hi:[0,0,1]
    v_cvt_pk_bf16_f32 v120, v224, v226
    v_cvt_pk_bf16_f32 v184, v225, v227
    v_cvt_pk_bf16_f32 v121, v228, v230
    v_cvt_pk_bf16_f32 v185, v229, v231
    v_cvt_pk_bf16_f32 v122, v232, v234
    v_cvt_pk_bf16_f32 v186, v233, v235
    v_cvt_pk_bf16_f32 v123, v236, v238
    v_cvt_pk_bf16_f32 v187, v237, v239
    v_cvt_pk_bf16_f32 v124, v240, v242
    v_cvt_pk_bf16_f32 v188, v241, v243
    v_cvt_pk_bf16_f32 v125, v244, v246
    v_cvt_pk_bf16_f32 v189, v245, v247
    v_cvt_pk_bf16_f32 v126, v248, v250
    v_cvt_pk_bf16_f32 v190, v249, v251
    v_cvt_pk_bf16_f32 v127, v252, v254
    v_cvt_pk_bf16_f32 v191, v253, v255
    s_waitcnt vmcnt(18)
    s_barrier
    ds_read_b64_tr_b16 v[192:193], v40 offset:0
    ds_read_b64_tr_b16 v[194:195], v40 offset:256
    ds_read_b64_tr_b16 v[196:197], v41 offset:0
    ds_read_b64_tr_b16 v[198:199], v41 offset:256
    ds_read_b64_tr_b16 v[200:201], v40 offset:32768
    ds_read_b64_tr_b16 v[202:203], v40 offset:33024
    ds_read_b64_tr_b16 v[204:205], v41 offset:32768
    ds_read_b64_tr_b16 v[206:207], v41 offset:33024
    ds_read_b64_tr_b16 v[208:209], v40 offset:2048
    ds_read_b64_tr_b16 v[210:211], v40 offset:2304
    ds_read_b64_tr_b16 v[212:213], v41 offset:2048
    ds_read_b64_tr_b16 v[214:215], v41 offset:2304
    ds_read_b64_tr_b16 v[216:217], v40 offset:34816
    ds_read_b64_tr_b16 v[218:219], v40 offset:35072
    ds_read_b64_tr_b16 v[220:221], v41 offset:34816
    ds_read_b64_tr_b16 v[222:223], v41 offset:35072
    s_waitcnt lgkmcnt(8)
    v_mfma_f32_16x16x32_bf16 v[44:47], v[192:195], v[64:67], 0
    v_mfma_f32_16x16x32_bf16 v[48:51], v[196:199], v[64:67], 0
    s_mov_b32 s73, 0
    buffer_load_dwordx4 a[0:3], v14, s[68:71], s73 offen offset:0
    v_mfma_f32_16x16x32_bf16 v[52:55], v[200:203], v[128:131], 0
    v_mfma_f32_16x16x32_bf16 v[56:59], v[204:207], v[128:131], 0
    buffer_load_dwordx4 a[4:7], v14, s[68:71], s73 offen offset:1024
    ds_read_b64_tr_b16 v[192:193], v40 offset:4096
    ds_read_b64_tr_b16 v[194:195], v40 offset:4352
    ds_read_b64_tr_b16 v[196:197], v41 offset:4096
    ds_read_b64_tr_b16 v[198:199], v41 offset:4352
    ds_read_b64_tr_b16 v[200:201], v40 offset:36864
    ds_read_b64_tr_b16 v[202:203], v40 offset:37120
    ds_read_b64_tr_b16 v[204:205], v41 offset:36864
    ds_read_b64_tr_b16 v[206:207], v41 offset:37120
    s_waitcnt lgkmcnt(8)
    v_mfma_f32_16x16x32_bf16 v[44:47], v[208:211], v[68:71], v[44:47]
    v_mfma_f32_16x16x32_bf16 v[48:51], v[212:215], v[68:71], v[48:51]
    buffer_load_dwordx4 a[8:11], v14, s[68:71], s73 offen offset:2048
    v_mfma_f32_16x16x32_bf16 v[52:55], v[216:219], v[132:135], v[52:55]
    v_mfma_f32_16x16x32_bf16 v[56:59], v[220:223], v[132:135], v[56:59]
    buffer_load_dwordx4 a[12:15], v14, s[68:71], s73 offen offset:3072
    ds_read_b64_tr_b16 v[208:209], v40 offset:6144
    ds_read_b64_tr_b16 v[210:211], v40 offset:6400
    ds_read_b64_tr_b16 v[212:213], v41 offset:6144
    ds_read_b64_tr_b16 v[214:215], v41 offset:6400
    ds_read_b64_tr_b16 v[216:217], v40 offset:38912
    ds_read_b64_tr_b16 v[218:219], v40 offset:39168
    ds_read_b64_tr_b16 v[220:221], v41 offset:38912
    ds_read_b64_tr_b16 v[222:223], v41 offset:39168
    s_waitcnt lgkmcnt(8)
    v_mfma_f32_16x16x32_bf16 v[44:47], v[192:195], v[72:75], v[44:47]
    v_mfma_f32_16x16x32_bf16 v[48:51], v[196:199], v[72:75], v[48:51]
    s_mov_b32 s73, 4096
    buffer_load_dwordx4 a[16:19], v14, s[68:71], s73 offen offset:0
    v_mfma_f32_16x16x32_bf16 v[52:55], v[200:203], v[136:139], v[52:55]
    v_mfma_f32_16x16x32_bf16 v[56:59], v[204:207], v[136:139], v[56:59]
    buffer_load_dwordx4 a[20:23], v14, s[68:71], s73 offen offset:1024
    s_waitcnt vmcnt(20)
    s_barrier
    ds_read_b64_tr_b16 v[192:193], v40 offset:8192
    ds_read_b64_tr_b16 v[194:195], v40 offset:8448
    ds_read_b64_tr_b16 v[196:197], v41 offset:8192
    ds_read_b64_tr_b16 v[198:199], v41 offset:8448
    ds_read_b64_tr_b16 v[200:201], v40 offset:40960
    ds_read_b64_tr_b16 v[202:203], v40 offset:41216
    ds_read_b64_tr_b16 v[204:205], v41 offset:40960
    ds_read_b64_tr_b16 v[206:207], v41 offset:41216
    s_waitcnt lgkmcnt(8)
    v_mfma_f32_16x16x32_bf16 v[44:47], v[208:211], v[76:79], v[44:47]
    v_mfma_f32_16x16x32_bf16 v[48:51], v[212:215], v[76:79], v[48:51]
    buffer_load_dwordx4 a[24:27], v14, s[68:71], s73 offen offset:2048
    v_mfma_f32_16x16x32_bf16 v[52:55], v[216:219], v[140:143], v[52:55]
    v_mfma_f32_16x16x32_bf16 v[56:59], v[220:223], v[140:143], v[56:59]
    buffer_load_dwordx4 a[28:31], v14, s[68:71], s73 offen offset:3072
    ds_read_b64_tr_b16 v[208:209], v40 offset:10240
    ds_read_b64_tr_b16 v[210:211], v40 offset:10496
    ds_read_b64_tr_b16 v[212:213], v41 offset:10240
    ds_read_b64_tr_b16 v[214:215], v41 offset:10496
    ds_read_b64_tr_b16 v[216:217], v40 offset:43008
    ds_read_b64_tr_b16 v[218:219], v40 offset:43264
    ds_read_b64_tr_b16 v[220:221], v41 offset:43008
    ds_read_b64_tr_b16 v[222:223], v41 offset:43264
    s_waitcnt lgkmcnt(8)
    v_mfma_f32_16x16x32_bf16 v[44:47], v[192:195], v[80:83], v[44:47]
    v_mfma_f32_16x16x32_bf16 v[48:51], v[196:199], v[80:83], v[48:51]
    s_mov_b32 s73, 8192
    buffer_load_dwordx4 a[32:35], v14, s[68:71], s73 offen offset:0
    v_mfma_f32_16x16x32_bf16 v[52:55], v[200:203], v[144:147], v[52:55]
    v_mfma_f32_16x16x32_bf16 v[56:59], v[204:207], v[144:147], v[56:59]
    buffer_load_dwordx4 a[36:39], v14, s[68:71], s73 offen offset:1024
    ds_read_b64_tr_b16 v[192:193], v40 offset:12288
    ds_read_b64_tr_b16 v[194:195], v40 offset:12544
    ds_read_b64_tr_b16 v[196:197], v41 offset:12288
    ds_read_b64_tr_b16 v[198:199], v41 offset:12544
    ds_read_b64_tr_b16 v[200:201], v40 offset:45056
    ds_read_b64_tr_b16 v[202:203], v40 offset:45312
    ds_read_b64_tr_b16 v[204:205], v41 offset:45056
    ds_read_b64_tr_b16 v[206:207], v41 offset:45312
    s_waitcnt lgkmcnt(8)
    v_mfma_f32_16x16x32_bf16 v[44:47], v[208:211], v[84:87], v[44:47]
    v_mfma_f32_16x16x32_bf16 v[48:51], v[212:215], v[84:87], v[48:51]
    buffer_load_dwordx4 a[40:43], v14, s[68:71], s73 offen offset:2048
    v_mfma_f32_16x16x32_bf16 v[52:55], v[216:219], v[148:151], v[52:55]
    v_mfma_f32_16x16x32_bf16 v[56:59], v[220:223], v[148:151], v[56:59]
    buffer_load_dwordx4 a[44:47], v14, s[68:71], s73 offen offset:3072
    ds_read_b64_tr_b16 v[208:209], v40 offset:14336
    ds_read_b64_tr_b16 v[210:211], v40 offset:14592
    ds_read_b64_tr_b16 v[212:213], v41 offset:14336
    ds_read_b64_tr_b16 v[214:215], v41 offset:14592
    ds_read_b64_tr_b16 v[216:217], v40 offset:47104
    ds_read_b64_tr_b16 v[218:219], v40 offset:47360
    ds_read_b64_tr_b16 v[220:221], v41 offset:47104
    ds_read_b64_tr_b16 v[222:223], v41 offset:47360
    s_waitcnt lgkmcnt(8)
    v_mfma_f32_16x16x32_bf16 v[44:47], v[192:195], v[88:91], v[44:47]
    v_mfma_f32_16x16x32_bf16 v[48:51], v[196:199], v[88:91], v[48:51]
    s_mov_b32 s73, 12288
    buffer_load_dwordx4 a[48:51], v14, s[68:71], s73 offen offset:0
    v_mfma_f32_16x16x32_bf16 v[52:55], v[200:203], v[152:155], v[52:55]
    v_mfma_f32_16x16x32_bf16 v[56:59], v[204:207], v[152:155], v[56:59]
    buffer_load_dwordx4 a[52:55], v14, s[68:71], s73 offen offset:1024
    s_waitcnt vmcnt(24)
    s_barrier
    ds_read_b64_tr_b16 v[192:193], v40 offset:16384
    ds_read_b64_tr_b16 v[194:195], v40 offset:16640
    ds_read_b64_tr_b16 v[196:197], v41 offset:16384
    ds_read_b64_tr_b16 v[198:199], v41 offset:16640
    ds_read_b64_tr_b16 v[200:201], v40 offset:49152
    ds_read_b64_tr_b16 v[202:203], v40 offset:49408
    ds_read_b64_tr_b16 v[204:205], v41 offset:49152
    ds_read_b64_tr_b16 v[206:207], v41 offset:49408
    s_waitcnt lgkmcnt(8)
    v_mfma_f32_16x16x32_bf16 v[44:47], v[208:211], v[92:95], v[44:47]
    v_mfma_f32_16x16x32_bf16 v[48:51], v[212:215], v[92:95], v[48:51]
    buffer_load_dwordx4 a[56:59], v14, s[68:71], s73 offen offset:2048
    v_mfma_f32_16x16x32_bf16 v[52:55], v[216:219], v[156:159], v[52:55]
    v_mfma_f32_16x16x32_bf16 v[56:59], v[220:223], v[156:159], v[56:59]
    buffer_load_dwordx4 a[60:63], v14, s[68:71], s73 offen offset:3072
    ds_read_b64_tr_b16 v[208:209], v40 offset:18432
    ds_read_b64_tr_b16 v[210:211], v40 offset:18688
    ds_read_b64_tr_b16 v[212:213], v41 offset:18432
    ds_read_b64_tr_b16 v[214:215], v41 offset:18688
    ds_read_b64_tr_b16 v[216:217], v40 offset:51200
    ds_read_b64_tr_b16 v[218:219], v40 offset:51456
    ds_read_b64_tr_b16 v[220:221], v41 offset:51200
    ds_read_b64_tr_b16 v[222:223], v41 offset:51456
    s_waitcnt lgkmcnt(8)
    v_mfma_f32_16x16x32_bf16 v[44:47], v[192:195], v[96:99], v[44:47]
    v_mfma_f32_16x16x32_bf16 v[48:51], v[196:199], v[96:99], v[48:51]
    s_mov_b32 s73, 16384
    buffer_load_dwordx4 a[64:67], v14, s[68:71], s73 offen offset:0
    v_mfma_f32_16x16x32_bf16 v[52:55], v[200:203], v[160:163], v[52:55]
    v_mfma_f32_16x16x32_bf16 v[56:59], v[204:207], v[160:163], v[56:59]
    buffer_load_dwordx4 a[68:71], v14, s[68:71], s73 offen offset:1024
    ds_read_b64_tr_b16 v[192:193], v40 offset:20480
    ds_read_b64_tr_b16 v[194:195], v40 offset:20736
    ds_read_b64_tr_b16 v[196:197], v41 offset:20480
    ds_read_b64_tr_b16 v[198:199], v41 offset:20736
    ds_read_b64_tr_b16 v[200:201], v40 offset:53248
    ds_read_b64_tr_b16 v[202:203], v40 offset:53504
    ds_read_b64_tr_b16 v[204:205], v41 offset:53248
    ds_read_b64_tr_b16 v[206:207], v41 offset:53504
    s_waitcnt lgkmcnt(8)
    v_mfma_f32_16x16x32_bf16 v[44:47], v[208:211], v[100:103], v[44:47]
    v_mfma_f32_16x16x32_bf16 v[48:51], v[212:215], v[100:103], v[48:51]
    buffer_load_dwordx4 a[72:75], v14, s[68:71], s73 offen offset:2048
    v_mfma_f32_16x16x32_bf16 v[52:55], v[216:219], v[164:167], v[52:55]
    v_mfma_f32_16x16x32_bf16 v[56:59], v[220:223], v[164:167], v[56:59]
    buffer_load_dwordx4 a[76:79], v14, s[68:71], s73 offen offset:3072
    ds_read_b64_tr_b16 v[208:209], v40 offset:22528
    ds_read_b64_tr_b16 v[210:211], v40 offset:22784
    ds_read_b64_tr_b16 v[212:213], v41 offset:22528
    ds_read_b64_tr_b16 v[214:215], v41 offset:22784
    ds_read_b64_tr_b16 v[216:217], v40 offset:55296
    ds_read_b64_tr_b16 v[218:219], v40 offset:55552
    ds_read_b64_tr_b16 v[220:221], v41 offset:55296
    ds_read_b64_tr_b16 v[222:223], v41 offset:55552
    s_waitcnt lgkmcnt(8)
    v_mfma_f32_16x16x32_bf16 v[44:47], v[192:195], v[104:107], v[44:47]
    v_mfma_f32_16x16x32_bf16 v[48:51], v[196:199], v[104:107], v[48:51]
    s_mov_b32 s73, 20480
    buffer_load_dwordx4 a[80:83], v14, s[68:71], s73 offen offset:0
    v_mfma_f32_16x16x32_bf16 v[52:55], v[200:203], v[168:171], v[52:55]
    v_mfma_f32_16x16x32_bf16 v[56:59], v[204:207], v[168:171], v[56:59]
    buffer_load_dwordx4 a[84:87], v14, s[68:71], s73 offen offset:1024
    s_waitcnt vmcnt(28)
    s_barrier
    ds_read_b64_tr_b16 v[192:193], v40 offset:24576
    ds_read_b64_tr_b16 v[194:195], v40 offset:24832
    ds_read_b64_tr_b16 v[196:197], v41 offset:24576
    ds_read_b64_tr_b16 v[198:199], v41 offset:24832
    ds_read_b64_tr_b16 v[200:201], v40 offset:57344
    ds_read_b64_tr_b16 v[202:203], v40 offset:57600
    ds_read_b64_tr_b16 v[204:205], v41 offset:57344
    ds_read_b64_tr_b16 v[206:207], v41 offset:57600
    s_waitcnt lgkmcnt(8)
    v_mfma_f32_16x16x32_bf16 v[44:47], v[208:211], v[108:111], v[44:47]
    v_mfma_f32_16x16x32_bf16 v[48:51], v[212:215], v[108:111], v[48:51]
    buffer_load_dwordx4 a[88:91], v14, s[68:71], s73 offen offset:2048
    v_mfma_f32_16x16x32_bf16 v[52:55], v[216:219], v[172:175], v[52:55]
    v_mfma_f32_16x16x32_bf16 v[56:59], v[220:223], v[172:175], v[56:59]
    buffer_load_dwordx4 a[92:95], v14, s[68:71], s73 offen offset:3072
    ds_read_b64_tr_b16 v[208:209], v40 offset:26624
    ds_read_b64_tr_b16 v[210:211], v40 offset:26880
    ds_read_b64_tr_b16 v[212:213], v41 offset:26624
    ds_read_b64_tr_b16 v[214:215], v41 offset:26880
    ds_read_b64_tr_b16 v[216:217], v40 offset:59392
    ds_read_b64_tr_b16 v[218:219], v40 offset:59648
    ds_read_b64_tr_b16 v[220:221], v41 offset:59392
    ds_read_b64_tr_b16 v[222:223], v41 offset:59648
    s_waitcnt lgkmcnt(8)
    v_mfma_f32_16x16x32_bf16 v[44:47], v[192:195], v[112:115], v[44:47]
    v_mfma_f32_16x16x32_bf16 v[48:51], v[196:199], v[112:115], v[48:51]
    v_mfma_f32_16x16x32_bf16 v[52:55], v[200:203], v[176:179], v[52:55]
    v_mfma_f32_16x16x32_bf16 v[56:59], v[204:207], v[176:179], v[56:59]
    ds_read_b64_tr_b16 v[192:193], v40 offset:28672
    ds_read_b64_tr_b16 v[194:195], v40 offset:28928
    ds_read_b64_tr_b16 v[196:197], v41 offset:28672
    ds_read_b64_tr_b16 v[198:199], v41 offset:28928
    ds_read_b64_tr_b16 v[200:201], v40 offset:61440
    ds_read_b64_tr_b16 v[202:203], v40 offset:61696
    ds_read_b64_tr_b16 v[204:205], v41 offset:61440
    ds_read_b64_tr_b16 v[206:207], v41 offset:61696
    s_waitcnt lgkmcnt(8)
    v_mfma_f32_16x16x32_bf16 v[44:47], v[208:211], v[116:119], v[44:47]
    v_mfma_f32_16x16x32_bf16 v[48:51], v[212:215], v[116:119], v[48:51]
    v_mfma_f32_16x16x32_bf16 v[52:55], v[216:219], v[180:183], v[52:55]
    v_mfma_f32_16x16x32_bf16 v[56:59], v[220:223], v[180:183], v[56:59]
    ds_read_b64_tr_b16 v[208:209], v40 offset:30720
    ds_read_b64_tr_b16 v[210:211], v40 offset:30976
    ds_read_b64_tr_b16 v[212:213], v41 offset:30720
    ds_read_b64_tr_b16 v[214:215], v41 offset:30976
    ds_read_b64_tr_b16 v[216:217], v40 offset:63488
    ds_read_b64_tr_b16 v[218:219], v40 offset:63744
    ds_read_b64_tr_b16 v[220:221], v41 offset:63488
    ds_read_b64_tr_b16 v[222:223], v41 offset:63744
    s_waitcnt lgkmcnt(8)
    v_mfma_f32_16x16x32_bf16 v[44:47], v[192:195], v[120:123], v[44:47]
    v_mfma_f32_16x16x32_bf16 v[48:51], v[196:199], v[120:123], v[48:51]
    v_mfma_f32_16x16x32_bf16 v[52:55], v[200:203], v[184:187], v[52:55]
    v_mfma_f32_16x16x32_bf16 v[56:59], v[204:207], v[184:187], v[56:59]
    s_waitcnt lgkmcnt(0)
    v_mfma_f32_16x16x32_bf16 v[44:47], v[208:211], v[124:127], v[44:47]
    v_mfma_f32_16x16x32_bf16 v[48:51], v[212:215], v[124:127], v[48:51]
    v_mfma_f32_16x16x32_bf16 v[52:55], v[216:219], v[188:191], v[52:55]
    v_mfma_f32_16x16x32_bf16 v[56:59], v[220:223], v[188:191], v[56:59]
    s_waitcnt vmcnt(24)
    s_mov_b32 s32, 0xffff0000
    v_lshlrev_b32 v64, 16, v18
    v_and_b32 v65, s32, v18
    v_lshlrev_b32 v66, 16, v19
    v_and_b32 v67, s32, v19
    v_lshlrev_b32 v68, 16, v20
    v_and_b32 v69, s32, v20
    v_lshlrev_b32 v70, 16, v21
    v_and_b32 v71, s32, v21
    v_mul_f32 v64, v16, v64
    v_mul_f32 v65, v16, v65
    v_mul_f32 v66, v16, v66
    v_mul_f32 v67, v16, v67
    v_mul_f32 v68, v16, v68
    v_mul_f32 v69, v16, v69
    v_mul_f32 v70, v16, v70
    v_mul_f32 v71, v16, v71
    v_lshlrev_b32 v88, 16, v24
    v_and_b32 v89, s32, v24
    v_lshlrev_b32 v90, 16, v25
    v_and_b32 v91, s32, v25
    v_lshlrev_b32 v92, 16, v26
    v_and_b32 v93, s32, v26
    v_lshlrev_b32 v94, 16, v27
    v_and_b32 v95, s32, v27
    v_lshlrev_b32 v96, 16, v28
    v_and_b32 v97, s32, v28
    v_lshlrev_b32 v98, 16, v29
    v_and_b32 v99, s32, v29
    v_lshlrev_b32 v100, 16, v30
    v_and_b32 v101, s32, v30
    v_lshlrev_b32 v102, 16, v31
    v_and_b32 v103, s32, v31
    v_lshlrev_b32 v104, 16, v32
    v_and_b32 v105, s32, v32
    v_lshlrev_b32 v106, 16, v33
    v_and_b32 v107, s32, v33
    v_lshlrev_b32 v108, 16, v34
    v_and_b32 v109, s32, v34
    v_lshlrev_b32 v110, 16, v35
    v_and_b32 v111, s32, v35
    v_lshlrev_b32 v112, 16, v36
    v_and_b32 v113, s32, v36
    v_lshlrev_b32 v114, 16, v37
    v_and_b32 v115, s32, v37
    v_lshlrev_b32 v116, 16, v38
    v_and_b32 v117, s32, v38
    v_lshlrev_b32 v118, 16, v39
    v_and_b32 v119, s32, v39
    s_cmp_eq_u32 s26, 0
    s_cselect_b32 s36, 0, 99
    v_cmp_ne_u32 vcc, s36, v3
    v_sub_f32 v72, v44, v52
    v_add_f32 v80, v44, v52
    v_fmac_f32 v72, s34, v64
    v_add_f32 v80, v80, v64
    v_sub_f32 v73, v45, v53
    v_add_f32 v81, v45, v53
    v_fmac_f32 v73, s34, v65
    v_add_f32 v81, v81, v65
    v_sub_f32 v74, v46, v54
    v_add_f32 v82, v46, v54
    v_fmac_f32 v74, s34, v66
    v_add_f32 v82, v82, v66
    v_sub_f32 v75, v47, v55
    v_add_f32 v83, v47, v55
    v_fmac_f32 v75, s34, v67
    v_add_f32 v83, v83, v67
    v_sub_f32 v76, v48, v56
    v_add_f32 v84, v48, v56
    v_fmac_f32 v76, s34, v68
    v_add_f32 v84, v84, v68
    v_sub_f32 v77, v49, v57
    v_add_f32 v85, v49, v57
    v_fmac_f32 v77, s34, v69
    v_add_f32 v85, v85, v69
    v_sub_f32 v78, v50, v58
    v_add_f32 v86, v50, v58
    v_fmac_f32 v78, s34, v70
    v_add_f32 v86, v86, v70
    v_sub_f32 v79, v51, v59
    v_add_f32 v87, v51, v59
    v_fmac_f32 v79, s34, v71
    v_add_f32 v87, v87, v71
    v_cndmask_b32 v60, 0, v80, vcc
    v_cndmask_b32 v61, 0, v72, vcc
    v_add_f32 v88, v88, v72
    v_add_f32 v92, v92, v60
    v_add_f32 v89, v89, v73
    v_add_f32 v93, v93, v81
    v_add_f32 v90, v90, v74
    v_add_f32 v94, v94, v82
    v_add_f32 v91, v91, v75
    v_add_f32 v95, v95, v83
    v_cvt_pk_bf16_f32 v128, v88, v89
    v_cvt_pk_bf16_f32 v129, v90, v91
    v_cvt_pk_bf16_f32 v130, v92, v93
    v_cvt_pk_bf16_f32 v131, v94, v95
    v_add_f32 v96, v96, v80
    v_add_f32 v100, v100, v61
    v_add_f32 v97, v97, v81
    v_add_f32 v101, v101, v73
    v_add_f32 v98, v98, v82
    v_add_f32 v102, v102, v74
    v_add_f32 v99, v99, v83
    v_add_f32 v103, v103, v75
    v_cvt_pk_bf16_f32 v132, v96, v97
    v_cvt_pk_bf16_f32 v133, v98, v99
    v_cvt_pk_bf16_f32 v134, v100, v101
    v_cvt_pk_bf16_f32 v135, v102, v103
    v_add_f32 v104, v104, v76
    v_add_f32 v108, v108, v84
    v_add_f32 v105, v105, v77
    v_add_f32 v109, v109, v85
    v_add_f32 v106, v106, v78
    v_add_f32 v110, v110, v86
    v_add_f32 v107, v107, v79
    v_add_f32 v111, v111, v87
    v_cvt_pk_bf16_f32 v136, v104, v105
    v_cvt_pk_bf16_f32 v137, v106, v107
    v_cvt_pk_bf16_f32 v138, v108, v109
    v_cvt_pk_bf16_f32 v139, v110, v111
    v_add_f32 v112, v112, v84
    v_add_f32 v116, v116, v76
    v_add_f32 v113, v113, v85
    v_add_f32 v117, v117, v77
    v_add_f32 v114, v114, v86
    v_add_f32 v118, v118, v78
    v_add_f32 v115, v115, v87
    v_add_f32 v119, v119, v79
    v_cvt_pk_bf16_f32 v140, v112, v113
    v_cvt_pk_bf16_f32 v141, v114, v115
    v_cvt_pk_bf16_f32 v142, v116, v117
    v_cvt_pk_bf16_f32 v143, v118, v119
    s_cmp_eq_u32 s24, 0
    s_cbranch_scc1 sf_kernel_q_reg
    s_cmp_lg_u32 s20, 0
    s_cbranch_scc1 sf_kernel_q_sd
    v_cmp_eq_u32 vcc, 0, v2
    s_mov_b64 exec, vcc
    buffer_store_dwordx4 v[128:131], v12, s[52:55], s29 offen offset:0 sc1
    buffer_store_dwordx4 v[136:139], v12, s[52:55], s29 offen offset:1024 sc1
    s_branch sf_kernel_q_sd
sf_kernel_q_reg:
    buffer_store_dwordx4 v[128:131], v12, s[52:55], s29 offen offset:0 sc1
    buffer_store_dwordx4 v[136:139], v12, s[52:55], s29 offen offset:1024 sc1
    s_mov_b64 exec, s[60:61]
    buffer_store_dwordx4 v[132:135], v12, s[52:55], s29 offen offset:64 sc1
    buffer_store_dwordx4 v[140:143], v12, s[52:55], s29 offen offset:1088 sc1
sf_kernel_q_sd:
    s_mov_b64 exec, -1
    s_lshl_b32 s33, s25, 3
    s_add_u32 s33, s33, s22
    s_lshl_b32 s33, s33, 6
    s_cmp_eq_u32 s24, 1
    s_cselect_b32 s33, 1024, s33
    s_lshl_b32 s34, s26, 2
    s_add_u32 s33, s33, s34
    s_waitcnt vmcnt(0)
    s_barrier
    s_cmp_lg_u32 s20, 0
    s_cbranch_scc1 sf_kernel_join
    v_mov_b32 v8, 1
    v_mov_b32 v9, 0
    s_mov_b64 exec, 1
    s_add_u32 s44, s4, 236718080
    s_addc_u32 s45, s5, 0
    s_mov_b32 s46, 8192
    s_mov_b32 s47, 0x20000
    buffer_store_dword v8, v9, s[44:47], s33 offen sc0 sc1
    s_mov_b64 exec, -1
    s_branch sf_kernel_join
sf_kernel_ns:
    s_cmp_lt_u32 s2, 160
    s_cbranch_scc1 sf_kernel_idle
    s_sub_u32 s50, s2, 160
    s_and_b32 s51, s50, 7
    s_lshr_b32 s50, s50, 3
    s_lshl_b32 s33, s51, 4
    s_add_u32 s33, s33, s50
    s_lshl_b32 s33, s33, 2
    s_mul_i32 s50, s50, 3
    s_mul_i32 s55, s51, 663552
    s_mul_i32 s26, s20, 2304
    s_add_u32 s8, s42, s55
    s_addc_u32 s9, s43, 0
    s_mov_b32 s10, 663552
    s_mov_b32 s11, 0x20000
    s_add_u32 s44, s4, 236722176
    s_addc_u32 s45, s5, 0
    s_mov_b32 s46, 8192
    s_mov_b32 s47, 0x20000
    v_mov_b32 v21, 0
    buffer_load_dword v22, v21, s[44:47], s33 offen
    s_and_b32 s51, s2, 7
    s_mul_i32 s54, s51, 1327104
    s_add_u32 s16, s4, 201326592
    s_addc_u32 s17, s5, 0
    s_add_u32 s16, s16, s54
    s_addc_u32 s17, s17, 0
    s_mov_b32 s18, 1327104
    s_mov_b32 s19, 0x20000
    s_add_u32 s52, s50, 0
    s_and_b32 s59, s52, 1
    s_lshl_b32 s59, s59, 9
    s_lshr_b32 s52, s52, 1
    s_mov_b32 s64, 3299123232
    s_mov_b32 s65, 110398552
    s_mov_b32 s62, 587438574
    s_mov_b32 s63, 0
    s_cmp_ge_u32 s52, 12
    s_cselect_b64 s[64:65], s[62:63], s[64:65]
    s_cselect_b32 s53, 12, 0
    s_sub_u32 s53, s52, s53
    s_mul_i32 s53, s53, 5
    s_lshr_b64 s[64:65], s[64:65], s53
    s_and_b32 s56, s64, 31
    s_add_u32 s52, s50, 1
    s_and_b32 s60, s52, 1
    s_lshl_b32 s60, s60, 9
    s_lshr_b32 s52, s52, 1
    s_mov_b32 s64, 3299123232
    s_mov_b32 s65, 110398552
    s_mov_b32 s62, 587438574
    s_mov_b32 s63, 0
    s_cmp_ge_u32 s52, 12
    s_cselect_b64 s[64:65], s[62:63], s[64:65]
    s_cselect_b32 s53, 12, 0
    s_sub_u32 s53, s52, s53
    s_mul_i32 s53, s53, 5
    s_lshr_b64 s[64:65], s[64:65], s53
    s_and_b32 s57, s64, 31
    s_add_u32 s52, s50, 2
    s_and_b32 s61, s52, 1
    s_lshl_b32 s61, s61, 9
    s_lshr_b32 s52, s52, 1
    s_mov_b32 s64, 3299123232
    s_mov_b32 s65, 110398552
    s_mov_b32 s62, 587438574
    s_mov_b32 s63, 0
    s_cmp_ge_u32 s52, 12
    s_cselect_b64 s[64:65], s[62:63], s[64:65]
    s_cselect_b32 s53, 12, 0
    s_sub_u32 s53, s52, s53
    s_mul_i32 s53, s53, 5
    s_lshr_b64 s[64:65], s[64:65], s53
    s_and_b32 s58, s64, 31
    s_mov_b32 s62, 0x05040100
    s_mov_b32 s63, 0x07060302
    v_add_u32 v20, 0, v0
    v_cmp_le_u32 vcc, 288, v20
    v_subrev_u32 v1, 288, v20
    v_mov_b32 v6, 0
    v_cndmask_b32 v1, v20, v1, vcc
    v_cndmask_b32 v2, v6, 1, vcc
    v_mul_u32_u24 v3, 4608, v2
    v_lshl_add_u32 v30, v1, 2, v3
    v_cmp_lt_u32 vcc, 144, v1
    v_cmp_eq_u32 s[64:65], 0, v1
    v_sub_u32 v4, 288, v1
    v_cndmask_b32 v4, v1, v4, vcc
    s_or_b64 s[64:65], s[64:65], vcc
    v_cmp_eq_u32 vcc, 144, v1
    s_nop 0
    v_cndmask_b32 v5, 0, 1, s[64:65]
    v_cndmask_b32 v4, v4, v6, vcc
    v_cmp_le_u32 vcc, 144, v1
    v_add_u32 v7, 144, v1
    v_sub_u32 v8, 431, v1
    v_cndmask_b32 v7, v7, v8, vcc
    v_cndmask_b32 v8, v6, 1, vcc
    v_lshrrev_b32 v9, 4, v4
    v_lshl_add_u32 v15, v9, 1, v5
    v_mul_u32_u24 v19, 57, v15
    v_lshrrev_b32 v19, 9, v19
    v_mul_u32_u24 v16, 9, v19
    v_sub_u32 v15, v15, v16
    v_and_b32 v16, 1, v19
    v_sub_u32 v15, v15, v16
    v_cmp_lt_u32 vcc, 1, v15
    v_add_u32 v16, 162, v15
    v_mov_b32 v12, 3072
    v_add_u32 v17, 214, v15
    v_mov_b32 v18, 4096
    v_cndmask_b32 v16, v16, v17, vcc
    v_cndmask_b32 v12, v12, v18, vcc
    v_cmp_lt_u32 vcc, 5, v15
    v_add_u32 v17, 282, v15
    v_mov_b32 v18, 2048
    v_cndmask_b32 v16, v16, v17, vcc
    v_cndmask_b32 v12, v12, v18, vcc
    v_cmp_lt_u32 vcc, 7, v15
    v_mov_b32 v17, 164
    v_mov_b32 v18, 3072
    v_cndmask_b32 v16, v16, v17, vcc
    v_cndmask_b32 v12, v12, v18, vcc
    v_mul_u32_u24 v19, 324, v19
    v_add_u32 v19, v19, v16
    v_lshlrev_b32 v10, 10, v19
    v_and_b32 v9, 15, v4
    v_lshl_add_u32 v10, v9, 4, v10
    v_lshl_add_u32 v10, v2, 8, v10
    v_lshrrev_b32 v9, 4, v7
    v_lshl_add_u32 v15, v9, 1, v8
    v_mul_u32_u24 v19, 57, v15
    v_lshrrev_b32 v19, 9, v19
    v_mul_u32_u24 v16, 9, v19
    v_sub_u32 v15, v15, v16
    v_and_b32 v16, 1, v19
    v_sub_u32 v15, v15, v16
    v_cmp_lt_u32 vcc, 1, v15
    v_add_u32 v16, 162, v15
    v_mov_b32 v13, 3072
    v_add_u32 v17, 214, v15
    v_mov_b32 v18, 4096
    v_cndmask_b32 v16, v16, v17, vcc
    v_cndmask_b32 v13, v13, v18, vcc
    v_cmp_lt_u32 vcc, 5, v15
    v_add_u32 v17, 282, v15
    v_mov_b32 v18, 2048
    v_cndmask_b32 v16, v16, v17, vcc
    v_cndmask_b32 v13, v13, v18, vcc
    v_cmp_lt_u32 vcc, 7, v15
    v_mov_b32 v17, 164
    v_mov_b32 v18, 3072
    v_cndmask_b32 v16, v16, v17, vcc
    v_cndmask_b32 v13, v13, v18, vcc
    v_mul_u32_u24 v19, 324, v19
    v_add_u32 v19, v19, v16
    v_lshlrev_b32 v11, 10, v19
    v_and_b32 v9, 15, v7
    v_lshl_add_u32 v11, v9, 4, v11
    v_lshl_add_u32 v11, v2, 8, v11
    v_mad_u32_u24 v24, v12, s56, v10
    v_mad_u32_u24 v25, v13, s56, v11
    v_mad_u32_u24 v26, v12, s57, v10
    v_mad_u32_u24 v27, v13, s57, v11
    v_mad_u32_u24 v28, v12, s58, v10
    v_mad_u32_u24 v29, v13, s58, v11
    v_add_u32 v20, 256, v0
    v_cmp_le_u32 vcc, 288, v20
    v_subrev_u32 v1, 288, v20
    v_mov_b32 v6, 0
    v_cndmask_b32 v1, v20, v1, vcc
    v_cndmask_b32 v2, v6, 1, vcc
    v_mul_u32_u24 v3, 4608, v2
    v_lshl_add_u32 v38, v1, 2, v3
    v_cmp_lt_u32 vcc, 144, v1
    v_cmp_eq_u32 s[64:65], 0, v1
    v_sub_u32 v4, 288, v1
    v_cndmask_b32 v4, v1, v4, vcc
    s_or_b64 s[64:65], s[64:65], vcc
    v_cmp_eq_u32 vcc, 144, v1
    s_nop 0
    v_cndmask_b32 v5, 0, 1, s[64:65]
    v_cndmask_b32 v4, v4, v6, vcc
    v_cmp_le_u32 vcc, 144, v1
    v_add_u32 v7, 144, v1
    v_sub_u32 v8, 431, v1
    v_cndmask_b32 v7, v7, v8, vcc
    v_cndmask_b32 v8, v6, 1, vcc
    v_lshrrev_b32 v9, 4, v4
    v_lshl_add_u32 v15, v9, 1, v5
    v_mul_u32_u24 v19, 57, v15
    v_lshrrev_b32 v19, 9, v19
    v_mul_u32_u24 v16, 9, v19
    v_sub_u32 v15, v15, v16
    v_and_b32 v16, 1, v19
    v_sub_u32 v15, v15, v16
    v_cmp_lt_u32 vcc, 1, v15
    v_add_u32 v16, 162, v15
    v_mov_b32 v12, 3072
    v_add_u32 v17, 214, v15
    v_mov_b32 v18, 4096
    v_cndmask_b32 v16, v16, v17, vcc
    v_cndmask_b32 v12, v12, v18, vcc
    v_cmp_lt_u32 vcc, 5, v15
    v_add_u32 v17, 282, v15
    v_mov_b32 v18, 2048
    v_cndmask_b32 v16, v16, v17, vcc
    v_cndmask_b32 v12, v12, v18, vcc
    v_cmp_lt_u32 vcc, 7, v15
    v_mov_b32 v17, 164
    v_mov_b32 v18, 3072
    v_cndmask_b32 v16, v16, v17, vcc
    v_cndmask_b32 v12, v12, v18, vcc
    v_mul_u32_u24 v19, 324, v19
    v_add_u32 v19, v19, v16
    v_lshlrev_b32 v10, 10, v19
    v_and_b32 v9, 15, v4
    v_lshl_add_u32 v10, v9, 4, v10
    v_lshl_add_u32 v10, v2, 8, v10
    v_lshrrev_b32 v9, 4, v7
    v_lshl_add_u32 v15, v9, 1, v8
    v_mul_u32_u24 v19, 57, v15
    v_lshrrev_b32 v19, 9, v19
    v_mul_u32_u24 v16, 9, v19
    v_sub_u32 v15, v15, v16
    v_and_b32 v16, 1, v19
    v_sub_u32 v15, v15, v16
    v_cmp_lt_u32 vcc, 1, v15
    v_add_u32 v16, 162, v15
    v_mov_b32 v13, 3072
    v_add_u32 v17, 214, v15
    v_mov_b32 v18, 4096
    v_cndmask_b32 v16, v16, v17, vcc
    v_cndmask_b32 v13, v13, v18, vcc
    v_cmp_lt_u32 vcc, 5, v15
    v_add_u32 v17, 282, v15
    v_mov_b32 v18, 2048
    v_cndmask_b32 v16, v16, v17, vcc
    v_cndmask_b32 v13, v13, v18, vcc
    v_cmp_lt_u32 vcc, 7, v15
    v_mov_b32 v17, 164
    v_mov_b32 v18, 3072
    v_cndmask_b32 v16, v16, v17, vcc
    v_cndmask_b32 v13, v13, v18, vcc
    v_mul_u32_u24 v19, 324, v19
    v_add_u32 v19, v19, v16
    v_lshlrev_b32 v11, 10, v19
    v_and_b32 v9, 15, v7
    v_lshl_add_u32 v11, v9, 4, v11
    v_lshl_add_u32 v11, v2, 8, v11
    v_mad_u32_u24 v32, v12, s56, v10
    v_mad_u32_u24 v33, v13, s56, v11
    v_mad_u32_u24 v34, v12, s57, v10
    v_mad_u32_u24 v35, v13, s57, v11
    v_mad_u32_u24 v36, v12, s58, v10
    v_mad_u32_u24 v37, v13, s58, v11
    v_add_u32 v20, 512, v0
    v_cmp_le_u32 vcc, 288, v20
    v_subrev_u32 v1, 288, v20
    v_mov_b32 v6, 0
    v_cndmask_b32 v1, v20, v1, vcc
    v_cndmask_b32 v2, v6, 1, vcc
    v_mul_u32_u24 v3, 4608, v2
    v_lshl_add_u32 v46, v1, 2, v3
    v_cmp_lt_u32 vcc, 144, v1
    v_cmp_eq_u32 s[64:65], 0, v1
    v_sub_u32 v4, 288, v1
    v_cndmask_b32 v4, v1, v4, vcc
    s_or_b64 s[64:65], s[64:65], vcc
    v_cmp_eq_u32 vcc, 144, v1
    s_nop 0
    v_cndmask_b32 v5, 0, 1, s[64:65]
    v_cndmask_b32 v4, v4, v6, vcc
    v_cmp_le_u32 vcc, 144, v1
    v_add_u32 v7, 144, v1
    v_sub_u32 v8, 431, v1
    v_cndmask_b32 v7, v7, v8, vcc
    v_cndmask_b32 v8, v6, 1, vcc
    v_lshrrev_b32 v9, 4, v4
    v_lshl_add_u32 v15, v9, 1, v5
    v_mul_u32_u24 v19, 57, v15
    v_lshrrev_b32 v19, 9, v19
    v_mul_u32_u24 v16, 9, v19
    v_sub_u32 v15, v15, v16
    v_and_b32 v16, 1, v19
    v_sub_u32 v15, v15, v16
    v_cmp_lt_u32 vcc, 1, v15
    v_add_u32 v16, 162, v15
    v_mov_b32 v12, 3072
    v_add_u32 v17, 214, v15
    v_mov_b32 v18, 4096
    v_cndmask_b32 v16, v16, v17, vcc
    v_cndmask_b32 v12, v12, v18, vcc
    v_cmp_lt_u32 vcc, 5, v15
    v_add_u32 v17, 282, v15
    v_mov_b32 v18, 2048
    v_cndmask_b32 v16, v16, v17, vcc
    v_cndmask_b32 v12, v12, v18, vcc
    v_cmp_lt_u32 vcc, 7, v15
    v_mov_b32 v17, 164
    v_mov_b32 v18, 3072
    v_cndmask_b32 v16, v16, v17, vcc
    v_cndmask_b32 v12, v12, v18, vcc
    v_mul_u32_u24 v19, 324, v19
    v_add_u32 v19, v19, v16
    v_lshlrev_b32 v10, 10, v19
    v_and_b32 v9, 15, v4
    v_lshl_add_u32 v10, v9, 4, v10
    v_lshl_add_u32 v10, v2, 8, v10
    v_lshrrev_b32 v9, 4, v7
    v_lshl_add_u32 v15, v9, 1, v8
    v_mul_u32_u24 v19, 57, v15
    v_lshrrev_b32 v19, 9, v19
    v_mul_u32_u24 v16, 9, v19
    v_sub_u32 v15, v15, v16
    v_and_b32 v16, 1, v19
    v_sub_u32 v15, v15, v16
    v_cmp_lt_u32 vcc, 1, v15
    v_add_u32 v16, 162, v15
    v_mov_b32 v13, 3072
    v_add_u32 v17, 214, v15
    v_mov_b32 v18, 4096
    v_cndmask_b32 v16, v16, v17, vcc
    v_cndmask_b32 v13, v13, v18, vcc
    v_cmp_lt_u32 vcc, 5, v15
    v_add_u32 v17, 282, v15
    v_mov_b32 v18, 2048
    v_cndmask_b32 v16, v16, v17, vcc
    v_cndmask_b32 v13, v13, v18, vcc
    v_cmp_lt_u32 vcc, 7, v15
    v_mov_b32 v17, 164
    v_mov_b32 v18, 3072
    v_cndmask_b32 v16, v16, v17, vcc
    v_cndmask_b32 v13, v13, v18, vcc
    v_mul_u32_u24 v19, 324, v19
    v_add_u32 v19, v19, v16
    v_lshlrev_b32 v11, 10, v19
    v_and_b32 v9, 15, v7
    v_lshl_add_u32 v11, v9, 4, v11
    v_lshl_add_u32 v11, v2, 8, v11
    v_mad_u32_u24 v40, v12, s56, v10
    v_mad_u32_u24 v41, v13, s56, v11
    v_mad_u32_u24 v42, v12, s57, v10
    v_mad_u32_u24 v43, v13, s57, v11
    v_mad_u32_u24 v44, v12, s58, v10
    v_mad_u32_u24 v45, v13, s58, v11
    s_waitcnt vmcnt(0)
    v_readfirstlane_b32 s52, v22
    s_cmp_eq_u32 s52, 1
    s_cbranch_scc1 sf_kernel_idle
    s_add_u32 s48, s50, 0
    s_lshr_b32 s49, s48, 1
    s_and_b32 s48, s48, 1
    s_mul_i32 s49, s49, 36864
    s_mul_i32 s48, s48, 9216
    s_add_u32 s49, s49, s48
    s_add_u32 s49, s49, s26
    s_add_u32 m0, s26, 0
    s_add_u32 s48, s49, 0
    buffer_load_dwordx4 v14, s[8:11], s48 offen lds
    buffer_load_dwordx4 v14, s[8:11], s48 offen offset:1024 lds
    s_mov_b64 exec, 0xffff
    buffer_load_dwordx4 v14, s[8:11], s48 offen offset:2048 lds
    s_mov_b64 exec, -1
    s_add_u32 m0, s26, 9216
    s_add_u32 s48, s49, 18432
    buffer_load_dwordx4 v14, s[8:11], s48 offen lds
    buffer_load_dwordx4 v14, s[8:11], s48 offen offset:1024 lds
    s_mov_b64 exec, 0xffff
    buffer_load_dwordx4 v14, s[8:11], s48 offen offset:2048 lds
    s_mov_b64 exec, -1
    s_add_u32 s48, s50, 1
    s_lshr_b32 s49, s48, 1
    s_and_b32 s48, s48, 1
    s_mul_i32 s49, s49, 36864
    s_mul_i32 s48, s48, 9216
    s_add_u32 s49, s49, s48
    s_add_u32 s49, s49, s26
    s_add_u32 m0, s26, 18432
    s_add_u32 s48, s49, 0
    buffer_load_dwordx4 v14, s[8:11], s48 offen lds
    buffer_load_dwordx4 v14, s[8:11], s48 offen offset:1024 lds
    s_mov_b64 exec, 0xffff
    buffer_load_dwordx4 v14, s[8:11], s48 offen offset:2048 lds
    s_mov_b64 exec, -1
    s_add_u32 m0, s26, 27648
    s_add_u32 s48, s49, 18432
    buffer_load_dwordx4 v14, s[8:11], s48 offen lds
    buffer_load_dwordx4 v14, s[8:11], s48 offen offset:1024 lds
    s_mov_b64 exec, 0xffff
    buffer_load_dwordx4 v14, s[8:11], s48 offen offset:2048 lds
    s_mov_b64 exec, -1
    s_add_u32 s48, s50, 2
    s_lshr_b32 s49, s48, 1
    s_and_b32 s48, s48, 1
    s_mul_i32 s49, s49, 36864
    s_mul_i32 s48, s48, 9216
    s_add_u32 s49, s49, s48
    s_add_u32 s49, s49, s26
    s_add_u32 m0, s26, 36864
    s_add_u32 s48, s49, 0
    buffer_load_dwordx4 v14, s[8:11], s48 offen lds
    buffer_load_dwordx4 v14, s[8:11], s48 offen offset:1024 lds
    s_mov_b64 exec, 0xffff
    buffer_load_dwordx4 v14, s[8:11], s48 offen offset:2048 lds
    s_mov_b64 exec, -1
    s_add_u32 m0, s26, 46080
    s_add_u32 s48, s49, 18432
    buffer_load_dwordx4 v14, s[8:11], s48 offen lds
    buffer_load_dwordx4 v14, s[8:11], s48 offen offset:1024 lds
    s_mov_b64 exec, 0xffff
    buffer_load_dwordx4 v14, s[8:11], s48 offen offset:2048 lds
    s_mov_b64 exec, -1
    s_waitcnt vmcnt(12)
    s_barrier
    ds_read_b32 v64, v30 offset:0
    ds_read_b32 v65, v30 offset:1152
    ds_read_b32 v66, v30 offset:2304
    ds_read_b32 v67, v30 offset:3456
    ds_read_b32 v68, v30 offset:9216
    ds_read_b32 v69, v30 offset:10368
    ds_read_b32 v70, v30 offset:11520
    ds_read_b32 v71, v30 offset:12672
    ds_read_b32 v72, v38 offset:0
    ds_read_b32 v73, v38 offset:1152
    ds_read_b32 v74, v38 offset:2304
    ds_read_b32 v75, v38 offset:3456
    ds_read_b32 v76, v38 offset:9216
    ds_read_b32 v77, v38 offset:10368
    ds_read_b32 v78, v38 offset:11520
    ds_read_b32 v79, v38 offset:12672
    s_cmp_lg_u32 s20, 0
    s_cbranch_scc1 sf_kernel_r0
    ds_read_b32 v80, v46 offset:0
    ds_read_b32 v81, v46 offset:1152
    ds_read_b32 v82, v46 offset:2304
    ds_read_b32 v83, v46 offset:3456
    ds_read_b32 v84, v46 offset:9216
    ds_read_b32 v85, v46 offset:10368
    ds_read_b32 v86, v46 offset:11520
    ds_read_b32 v87, v46 offset:12672
    s_waitcnt lgkmcnt(0)
    v_perm_b32 v144, v81, v80, s62
    v_perm_b32 v145, v83, v82, s62
    v_perm_b32 v146, v85, v84, s62
    v_perm_b32 v147, v87, v86, s62
    buffer_store_dwordx4 v[144:147], v40, s[16:19], s59 offen sc1
    v_perm_b32 v148, v81, v80, s63
    v_perm_b32 v149, v83, v82, s63
    v_perm_b32 v150, v85, v84, s63
    v_perm_b32 v151, v87, v86, s63
    buffer_store_dwordx4 v[148:151], v41, s[16:19], s59 offen sc1
sf_kernel_r0:
    s_waitcnt lgkmcnt(0)
    v_perm_b32 v128, v65, v64, s62
    v_perm_b32 v129, v67, v66, s62
    v_perm_b32 v130, v69, v68, s62
    v_perm_b32 v131, v71, v70, s62
    buffer_store_dwordx4 v[128:131], v24, s[16:19], s59 offen sc1
    v_perm_b32 v132, v65, v64, s63
    v_perm_b32 v133, v67, v66, s63
    v_perm_b32 v134, v69, v68, s63
    v_perm_b32 v135, v71, v70, s63
    buffer_store_dwordx4 v[132:135], v25, s[16:19], s59 offen sc1
    v_perm_b32 v136, v73, v72, s62
    v_perm_b32 v137, v75, v74, s62
    v_perm_b32 v138, v77, v76, s62
    v_perm_b32 v139, v79, v78, s62
    buffer_store_dwordx4 v[136:139], v32, s[16:19], s59 offen sc1
    v_perm_b32 v140, v73, v72, s63
    v_perm_b32 v141, v75, v74, s63
    v_perm_b32 v142, v77, v76, s63
    v_perm_b32 v143, v79, v78, s63
    buffer_store_dwordx4 v[140:143], v33, s[16:19], s59 offen sc1
    s_waitcnt vmcnt(10)
    s_barrier
    ds_read_b32 v64, v30 offset:18432
    ds_read_b32 v65, v30 offset:19584
    ds_read_b32 v66, v30 offset:20736
    ds_read_b32 v67, v30 offset:21888
    ds_read_b32 v68, v30 offset:27648
    ds_read_b32 v69, v30 offset:28800
    ds_read_b32 v70, v30 offset:29952
    ds_read_b32 v71, v30 offset:31104
    ds_read_b32 v72, v38 offset:18432
    ds_read_b32 v73, v38 offset:19584
    ds_read_b32 v74, v38 offset:20736
    ds_read_b32 v75, v38 offset:21888
    ds_read_b32 v76, v38 offset:27648
    ds_read_b32 v77, v38 offset:28800
    ds_read_b32 v78, v38 offset:29952
    ds_read_b32 v79, v38 offset:31104
    s_cmp_lg_u32 s20, 0
    s_cbranch_scc1 sf_kernel_r1
    ds_read_b32 v80, v46 offset:18432
    ds_read_b32 v81, v46 offset:19584
    ds_read_b32 v82, v46 offset:20736
    ds_read_b32 v83, v46 offset:21888
    ds_read_b32 v84, v46 offset:27648
    ds_read_b32 v85, v46 offset:28800
    ds_read_b32 v86, v46 offset:29952
    ds_read_b32 v87, v46 offset:31104
    s_waitcnt lgkmcnt(0)
    v_perm_b32 v168, v81, v80, s62
    v_perm_b32 v169, v83, v82, s62
    v_perm_b32 v170, v85, v84, s62
    v_perm_b32 v171, v87, v86, s62
    buffer_store_dwordx4 v[168:171], v42, s[16:19], s60 offen sc1
    v_perm_b32 v172, v81, v80, s63
    v_perm_b32 v173, v83, v82, s63
    v_perm_b32 v174, v85, v84, s63
    v_perm_b32 v175, v87, v86, s63
    buffer_store_dwordx4 v[172:175], v43, s[16:19], s60 offen sc1
sf_kernel_r1:
    s_waitcnt lgkmcnt(0)
    v_perm_b32 v152, v65, v64, s62
    v_perm_b32 v153, v67, v66, s62
    v_perm_b32 v154, v69, v68, s62
    v_perm_b32 v155, v71, v70, s62
    buffer_store_dwordx4 v[152:155], v26, s[16:19], s60 offen sc1
    v_perm_b32 v156, v65, v64, s63
    v_perm_b32 v157, v67, v66, s63
    v_perm_b32 v158, v69, v68, s63
    v_perm_b32 v159, v71, v70, s63
    buffer_store_dwordx4 v[156:159], v27, s[16:19], s60 offen sc1
    v_perm_b32 v160, v73, v72, s62
    v_perm_b32 v161, v75, v74, s62
    v_perm_b32 v162, v77, v76, s62
    v_perm_b32 v163, v79, v78, s62
    buffer_store_dwordx4 v[160:163], v34, s[16:19], s60 offen sc1
    v_perm_b32 v164, v73, v72, s63
    v_perm_b32 v165, v75, v74, s63
    v_perm_b32 v166, v77, v76, s63
    v_perm_b32 v167, v79, v78, s63
    buffer_store_dwordx4 v[164:167], v35, s[16:19], s60 offen sc1
    s_waitcnt vmcnt(8)
    s_barrier
    ds_read_b32 v64, v30 offset:36864
    ds_read_b32 v65, v30 offset:38016
    ds_read_b32 v66, v30 offset:39168
    ds_read_b32 v67, v30 offset:40320
    ds_read_b32 v68, v30 offset:46080
    ds_read_b32 v69, v30 offset:47232
    ds_read_b32 v70, v30 offset:48384
    ds_read_b32 v71, v30 offset:49536
    ds_read_b32 v72, v38 offset:36864
    ds_read_b32 v73, v38 offset:38016
    ds_read_b32 v74, v38 offset:39168
    ds_read_b32 v75, v38 offset:40320
    ds_read_b32 v76, v38 offset:46080
    ds_read_b32 v77, v38 offset:47232
    ds_read_b32 v78, v38 offset:48384
    ds_read_b32 v79, v38 offset:49536
    s_cmp_lg_u32 s20, 0
    s_cbranch_scc1 sf_kernel_r2
    ds_read_b32 v80, v46 offset:36864
    ds_read_b32 v81, v46 offset:38016
    ds_read_b32 v82, v46 offset:39168
    ds_read_b32 v83, v46 offset:40320
    ds_read_b32 v84, v46 offset:46080
    ds_read_b32 v85, v46 offset:47232
    ds_read_b32 v86, v46 offset:48384
    ds_read_b32 v87, v46 offset:49536
    s_waitcnt lgkmcnt(0)
    v_perm_b32 v192, v81, v80, s62
    v_perm_b32 v193, v83, v82, s62
    v_perm_b32 v194, v85, v84, s62
    v_perm_b32 v195, v87, v86, s62
    buffer_store_dwordx4 v[192:195], v44, s[16:19], s61 offen sc1
    v_perm_b32 v196, v81, v80, s63
    v_perm_b32 v197, v83, v82, s63
    v_perm_b32 v198, v85, v84, s63
    v_perm_b32 v199, v87, v86, s63
    buffer_store_dwordx4 v[196:199], v45, s[16:19], s61 offen sc1
sf_kernel_r2:
    s_waitcnt lgkmcnt(0)
    v_perm_b32 v176, v65, v64, s62
    v_perm_b32 v177, v67, v66, s62
    v_perm_b32 v178, v69, v68, s62
    v_perm_b32 v179, v71, v70, s62
    buffer_store_dwordx4 v[176:179], v28, s[16:19], s61 offen sc1
    v_perm_b32 v180, v65, v64, s63
    v_perm_b32 v181, v67, v66, s63
    v_perm_b32 v182, v69, v68, s63
    v_perm_b32 v183, v71, v70, s63
    buffer_store_dwordx4 v[180:183], v29, s[16:19], s61 offen sc1
    v_perm_b32 v184, v73, v72, s62
    v_perm_b32 v185, v75, v74, s62
    v_perm_b32 v186, v77, v76, s62
    v_perm_b32 v187, v79, v78, s62
    buffer_store_dwordx4 v[184:187], v36, s[16:19], s61 offen sc1
    v_perm_b32 v188, v73, v72, s63
    v_perm_b32 v189, v75, v74, s63
    v_perm_b32 v190, v77, v76, s63
    v_perm_b32 v191, v79, v78, s63
    buffer_store_dwordx4 v[188:191], v37, s[16:19], s61 offen sc1
    s_barrier
    s_mov_b32 s74, s33
    s_branch sf_kernel_pf
sf_kernel_idle:
    s_sleep 40
sf_kernel_pf:
    s_mov_b32 s73, 0
    buffer_load_dwordx4 a[0:3], v14, s[68:71], s73 offen offset:0
    buffer_load_dwordx4 a[4:7], v14, s[68:71], s73 offen offset:1024
    buffer_load_dwordx4 a[8:11], v14, s[68:71], s73 offen offset:2048
    buffer_load_dwordx4 a[12:15], v14, s[68:71], s73 offen offset:3072
    s_mov_b32 s73, 4096
    buffer_load_dwordx4 a[16:19], v14, s[68:71], s73 offen offset:0
    buffer_load_dwordx4 a[20:23], v14, s[68:71], s73 offen offset:1024
    buffer_load_dwordx4 a[24:27], v14, s[68:71], s73 offen offset:2048
    buffer_load_dwordx4 a[28:31], v14, s[68:71], s73 offen offset:3072
    s_mov_b32 s73, 8192
    buffer_load_dwordx4 a[32:35], v14, s[68:71], s73 offen offset:0
    buffer_load_dwordx4 a[36:39], v14, s[68:71], s73 offen offset:1024
    buffer_load_dwordx4 a[40:43], v14, s[68:71], s73 offen offset:2048
    buffer_load_dwordx4 a[44:47], v14, s[68:71], s73 offen offset:3072
    s_mov_b32 s73, 12288
    buffer_load_dwordx4 a[48:51], v14, s[68:71], s73 offen offset:0
    buffer_load_dwordx4 a[52:55], v14, s[68:71], s73 offen offset:1024
    buffer_load_dwordx4 a[56:59], v14, s[68:71], s73 offen offset:2048
    buffer_load_dwordx4 a[60:63], v14, s[68:71], s73 offen offset:3072
    s_mov_b32 s73, 16384
    buffer_load_dwordx4 a[64:67], v14, s[68:71], s73 offen offset:0
    buffer_load_dwordx4 a[68:71], v14, s[68:71], s73 offen offset:1024
    buffer_load_dwordx4 a[72:75], v14, s[68:71], s73 offen offset:2048
    buffer_load_dwordx4 a[76:79], v14, s[68:71], s73 offen offset:3072
    s_mov_b32 s73, 20480
    buffer_load_dwordx4 a[80:83], v14, s[68:71], s73 offen offset:0
    buffer_load_dwordx4 a[84:87], v14, s[68:71], s73 offen offset:1024
    buffer_load_dwordx4 a[88:91], v14, s[68:71], s73 offen offset:2048
    buffer_load_dwordx4 a[92:95], v14, s[68:71], s73 offen offset:3072
sf_kernel_join:
    s_load_dwordx2 s[4:5], s[0:1], 80
    v_lshrrev_b32 v2, 6, v0
    s_nop 0
    v_readfirstlane_b32 s20, v2
    s_and_b32 s6, s2, 7
    s_lshr_b32 s7, s2, 3
    s_and_b32 s8, s6, 1
    s_and_b32 s9, s7, 1
    s_andn2_b32 s6, s6, 1
    s_or_b32 s6, s6, s9
    s_lshr_b32 s7, s7, 1
    s_lshl_b32 s8, s8, 4
    s_add_u32 s7, s7, s8
    v_and_b32 v1, 63, v0
    v_lshlrev_b32 v1, 4, v1
    s_mul_i32 s25, s6, 1327104
    s_mul_i32 s26, s6, 2359296
    s_mul_i32 s23, s7, 73728
    s_mul_i32 s22, s20, 331776
    s_add_u32 s25, s25, s22
    s_mul_i32 s24, s20, 18432
    s_add_u32 s27, s23, s24
    v_add_u32 v2, 55296, v1
    v_add_u32 v3, 73728, v1
    v_add_u32 v4, 129024, v1
    s_mul_i32 s28, s20, 9
    s_lshr_b32 s28, s28, 1
    s_lshl_b32 s28, s28, 10
    s_and_b32 s29, s20, 1
    s_lshl_b32 s30, s29, 3
    s_add_u32 s30, s30, s28
    s_cmp_eq_u32 s29, 0
    s_cselect_b32 s31, 8, 1024
    s_add_u32 s31, s31, s28
    v_add_u32 v5, s30, v3
    v_add_u32 v6, s31, v3
    s_mul_i32 s28, s20, 9
    s_add_u32 s28, s28, 1
    s_lshr_b32 s28, s28, 1
    s_lshl_b32 s28, s28, 9
    s_add_u32 s32, s23, s28
    s_lshr_b32 s28, s20, 1
    s_lshl_b32 s30, s28, 12
    s_mul_i32 s28, s28, 4608
    s_add_u32 s28, s28, 2048
    s_mul_i32 s31, s29, 36864
    s_add_u32 s28, s28, s31
    s_add_u32 s36, s23, s28
    s_add_u32 s37, s36, 18432
    s_lshl_b32 s31, s29, 3
    s_add_u32 s31, s31, s30
    v_add_u32 v7, s31, v1
    s_lshl_b32 s31, s29, 11
    s_add_u32 s31, s31, s30
    v_add_u32 v216, s31, v1
    s_add_u32 s33, s32, 18432
    s_add_u32 s34, s32, 36864
    s_add_u32 s35, s32, 55296
    v_bfe_u32 v8, v1, 7, 1
    v_mul_u32_u24 v8, 9216, v8
    v_lshrrev_b32 v9, 8, v1
    v_lshl_add_u32 v8, v9, 7, v8
    v_and_b32 v9, 0x70, v1
    v_add_u32 v217, v8, v9
    s_waitcnt lgkmcnt(0)
    s_add_u32 s12, s4, 214302720
    s_addc_u32 s13, s5, 0
    s_mov_b32 s14, 2359296
    s_mov_b32 s15, 0x20000
    s_add_u32 s16, s4, 217843712
    s_addc_u32 s17, s5, 0
    s_add_u32 s16, s16, s26
    s_addc_u32 s17, s17, 0
    s_mov_b32 s18, 2359296
    s_mov_b32 s19, 0x20000
    s_add_u32 s44, s4, 236718080
    s_addc_u32 s45, s5, 0
    s_mov_b32 s46, 8192
    s_mov_b32 s47, 0x20000
    v_lshrrev_b32 v8, 2, v1
    v_and_b32 v9, 60, v8
    s_lshr_b32 s28, s7, 1
    s_lshl_b32 s28, s28, 6
    s_cmp_eq_u32 s7, 0
    s_cselect_b32 s29, 1024, s28
    v_mov_b32 v10, s28
    v_mov_b32 v11, s29
    v_cmp_le_u32 vcc, 64, v8
    s_lshl_b32 s28, s6, 6
    s_add_u32 s28, s28, 64
    v_cndmask_b32 v10, v10, v11, vcc
    v_add_u32 v228, s28, v9
    v_add_u32 v8, v9, v10
    s_mov_b32 s41, 0x100000
    v_cmp_eq_u32 vcc, 512, v1
    v_mov_b32 v10, 3072
    s_mov_b32 s41, 0x100000
    v_cndmask_b32 v8, v8, v10, vcc
    s_mov_b32 exec_lo, 0x1ff01ff
    s_mov_b32 exec_hi, 1
sf_kernel_xp:
    s_sleep 1
    buffer_load_dword v9, v8, s[44:47], 0 offen sc0 sc1
    s_waitcnt vmcnt(0)
    v_cmp_ne_u32 vcc, 1, v9
    s_sub_u32 s41, s41, 1
    s_cbranch_scc1 sf_kernel_xd
    s_cmp_eq_u32 vcc_lo, 0
    s_cbranch_scc0 sf_kernel_xp
sf_kernel_xd:
    s_mov_b32 s75, vcc_hi
    s_mov_b64 exec, -1
    s_mov_b32 s41, 0x100000
    s_add_u32 m0, s24, 0
    s_add_u32 s40, s27, 0
    buffer_load_dwordx4 v1, s[12:15], s40 offen  lds
    s_add_u32 m0, s24, 1024
    s_add_u32 s40, s27, 1024
    buffer_load_dwordx4 v1, s[12:15], s40 offen  lds
    s_add_u32 m0, s24, 2048
    s_add_u32 s40, s27, 2048
    buffer_load_dwordx4 v1, s[12:15], s40 offen  lds
    s_add_u32 m0, s24, 3072
    s_add_u32 s40, s27, 3072
    buffer_load_dwordx4 v1, s[12:15], s40 offen  lds
    s_add_u32 m0, s24, 4096
    s_add_u32 s40, s27, 4096
    buffer_load_dwordx4 v1, s[12:15], s40 offen  lds
    s_add_u32 m0, s24, 5120
    s_add_u32 s40, s27, 5120
    buffer_load_dwordx4 v1, s[12:15], s40 offen  lds
    s_add_u32 m0, s24, 6144
    s_add_u32 s40, s27, 6144
    buffer_load_dwordx4 v1, s[12:15], s40 offen  lds
    s_add_u32 m0, s24, 7168
    s_add_u32 s40, s27, 7168
    buffer_load_dwordx4 v1, s[12:15], s40 offen  lds
    s_add_u32 m0, s24, 8192
    s_add_u32 s40, s27, 8192
    buffer_load_dwordx4 v1, s[12:15], s40 offen  lds
    s_add_u32 m0, s24, 9216
    s_add_u32 s40, s27, 9216
    buffer_load_dwordx4 v1, s[12:15], s40 offen  lds
    s_add_u32 m0, s24, 10240
    s_add_u32 s40, s27, 10240
    buffer_load_dwordx4 v1, s[12:15], s40 offen  lds
    s_add_u32 m0, s24, 11264
    s_add_u32 s40, s27, 11264
    buffer_load_dwordx4 v1, s[12:15], s40 offen  lds
    s_add_u32 m0, s24, 12288
    s_add_u32 s40, s27, 12288
    buffer_load_dwordx4 v1, s[12:15], s40 offen  lds
    s_add_u32 m0, s24, 13312
    s_add_u32 s40, s27, 13312
    buffer_load_dwordx4 v1, s[12:15], s40 offen  lds
    s_add_u32 m0, s24, 14336
    s_add_u32 s40, s27, 14336
    buffer_load_dwordx4 v1, s[12:15], s40 offen  lds
    s_add_u32 m0, s24, 15360
    s_add_u32 s40, s27, 15360
    buffer_load_dwordx4 v1, s[12:15], s40 offen  lds
    s_add_u32 m0, s24, 16384
    s_add_u32 s40, s27, 16384
    buffer_load_dwordx4 v1, s[12:15], s40 offen  lds
    s_add_u32 m0, s24, 17408
    s_add_u32 s40, s27, 17408
    buffer_load_dwordx4 v1, s[12:15], s40 offen  lds
    s_waitcnt vmcnt(16)
    s_barrier
    s_cmp_lt_i32 s74, 0
    s_cbranch_scc1 sf_kernel_nf
    s_cmp_lg_u32 s20, 0
    s_cbranch_scc1 sf_kernel_nf
    v_mov_b32 v8, 1
    v_mov_b32 v9, 0
    s_add_u32 s74, s74, 4096
    s_mov_b64 exec, 1
    buffer_store_dword v8, v9, s[44:47], s74 offen sc0 sc1
    s_mov_b64 exec, -1
sf_kernel_nf:
    ds_read_b128 v[152:155], v1 offset:0
    ds_read_b128 v[156:159], v1 offset:18432
    ds_read_b128 v[160:163], v1 offset:36864
    ds_read_b128 v[164:167], v2 offset:0
    s_waitcnt lgkmcnt(0)
    v_mfma_f32_16x16x32_bf16 v[8:11], a[0:3], v[152:155], 0
    v_mfma_f32_16x16x32_bf16 v[12:15], a[0:3], v[156:159], 0
    ds_read_b128 v[168:171], v1 offset:1024
    v_mfma_f32_16x16x32_bf16 v[16:19], a[0:3], v[160:163], 0
    ds_read_b128 v[172:175], v1 offset:19456
    v_mfma_f32_16x16x32_bf16 v[20:23], a[0:3], v[164:167], 0
    s_mov_b32 s21, 24576
    buffer_load_dwordx4 a[0:3], v1, s[68:71], s21 offen offset:0
    v_mfma_f32_16x16x32_bf16 v[24:27], a[4:7], v[152:155], 0
    ds_read_b128 v[176:179], v1 offset:37888
    v_mfma_f32_16x16x32_bf16 v[28:31], a[4:7], v[156:159], 0
    ds_read_b128 v[180:183], v2 offset:1024
    v_mfma_f32_16x16x32_bf16 v[32:35], a[4:7], v[160:163], 0
    v_mfma_f32_16x16x32_bf16 v[36:39], a[4:7], v[164:167], 0
    buffer_load_dwordx4 a[4:7], v1, s[68:71], s21 offen offset:1024
    v_mfma_f32_16x16x32_bf16 v[40:43], a[8:11], v[152:155], 0
    v_mfma_f32_16x16x32_bf16 v[44:47], a[8:11], v[156:159], 0
    v_mfma_f32_16x16x32_bf16 v[48:51], a[8:11], v[160:163], 0
    v_mfma_f32_16x16x32_bf16 v[52:55], a[8:11], v[164:167], 0
    buffer_load_dwordx4 a[8:11], v1, s[68:71], s21 offen offset:2048
    v_mfma_f32_16x16x32_bf16 v[56:59], a[12:15], v[152:155], 0
    v_mfma_f32_16x16x32_bf16 v[60:63], a[12:15], v[156:159], 0
    v_mfma_f32_16x16x32_bf16 v[64:67], a[12:15], v[160:163], 0
    v_mfma_f32_16x16x32_bf16 v[68:71], a[12:15], v[164:167], 0
    buffer_load_dwordx4 a[12:15], v1, s[68:71], s21 offen offset:3072
    v_mfma_f32_16x16x32_bf16 v[72:75], a[16:19], v[152:155], 0
    v_mfma_f32_16x16x32_bf16 v[76:79], a[16:19], v[156:159], 0
    v_mfma_f32_16x16x32_bf16 v[80:83], a[16:19], v[160:163], 0
    v_mfma_f32_16x16x32_bf16 v[84:87], a[16:19], v[164:167], 0
    s_mov_b32 s21, 28672
    buffer_load_dwordx4 a[16:19], v1, s[68:71], s21 offen offset:0
    s_waitcnt vmcnt(17)
    s_barrier
    s_waitcnt lgkmcnt(0)
    v_mfma_f32_16x16x32_bf16 v[8:11], a[20:23], v[168:171], v[8:11]
    v_mfma_f32_16x16x32_bf16 v[12:15], a[20:23], v[172:175], v[12:15]
    ds_read_b128 v[152:155], v1 offset:2048
    v_mfma_f32_16x16x32_bf16 v[16:19], a[20:23], v[176:179], v[16:19]
    ds_read_b128 v[156:159], v1 offset:20480
    v_mfma_f32_16x16x32_bf16 v[20:23], a[20:23], v[180:183], v[20:23]
    buffer_load_dwordx4 a[20:23], v1, s[68:71], s21 offen offset:1024
    v_mfma_f32_16x16x32_bf16 v[24:27], a[24:27], v[168:171], v[24:27]
    ds_read_b128 v[160:163], v1 offset:38912
    v_mfma_f32_16x16x32_bf16 v[28:31], a[24:27], v[172:175], v[28:31]
    ds_read_b128 v[164:167], v2 offset:2048
    v_mfma_f32_16x16x32_bf16 v[32:35], a[24:27], v[176:179], v[32:35]
    v_mfma_f32_16x16x32_bf16 v[36:39], a[24:27], v[180:183], v[36:39]
    buffer_load_dwordx4 a[24:27], v1, s[68:71], s21 offen offset:2048
    v_mfma_f32_16x16x32_bf16 v[40:43], a[28:31], v[168:171], v[40:43]
    v_mfma_f32_16x16x32_bf16 v[44:47], a[28:31], v[172:175], v[44:47]
    v_mfma_f32_16x16x32_bf16 v[48:51], a[28:31], v[176:179], v[48:51]
    v_mfma_f32_16x16x32_bf16 v[52:55], a[28:31], v[180:183], v[52:55]
    buffer_load_dwordx4 a[28:31], v1, s[68:71], s21 offen offset:3072
    v_mfma_f32_16x16x32_bf16 v[56:59], a[32:35], v[168:171], v[56:59]
    v_mfma_f32_16x16x32_bf16 v[60:63], a[32:35], v[172:175], v[60:63]
    v_mfma_f32_16x16x32_bf16 v[64:67], a[32:35], v[176:179], v[64:67]
    v_mfma_f32_16x16x32_bf16 v[68:71], a[32:35], v[180:183], v[68:71]
    s_mov_b32 s21, 32768
    buffer_load_dwordx4 a[32:35], v1, s[68:71], s21 offen offset:0
    v_mfma_f32_16x16x32_bf16 v[72:75], a[36:39], v[168:171], v[72:75]
    v_mfma_f32_16x16x32_bf16 v[76:79], a[36:39], v[172:175], v[76:79]
    v_mfma_f32_16x16x32_bf16 v[80:83], a[36:39], v[176:179], v[80:83]
    v_mfma_f32_16x16x32_bf16 v[84:87], a[36:39], v[180:183], v[84:87]
    buffer_load_dwordx4 a[36:39], v1, s[68:71], s21 offen offset:1024
    s_waitcnt lgkmcnt(0)
    v_mfma_f32_16x16x32_bf16 v[8:11], a[40:43], v[152:155], v[8:11]
    v_mfma_f32_16x16x32_bf16 v[12:15], a[40:43], v[156:159], v[12:15]
    ds_read_b128 v[168:171], v1 offset:3072
    v_mfma_f32_16x16x32_bf16 v[16:19], a[40:43], v[160:163], v[16:19]
    ds_read_b128 v[172:175], v1 offset:21504
    v_mfma_f32_16x16x32_bf16 v[20:23], a[40:43], v[164:167], v[20:23]
    buffer_load_dwordx4 a[40:43], v1, s[68:71], s21 offen offset:2048
    v_mfma_f32_16x16x32_bf16 v[24:27], a[44:47], v[152:155], v[24:27]
    ds_read_b128 v[176:179], v1 offset:39936
    v_mfma_f32_16x16x32_bf16 v[28:31], a[44:47], v[156:159], v[28:31]
    ds_read_b128 v[180:183], v2 offset:3072
    v_mfma_f32_16x16x32_bf16 v[32:35], a[44:47], v[160:163], v[32:35]
    v_mfma_f32_16x16x32_bf16 v[36:39], a[44:47], v[164:167], v[36:39]
    buffer_load_dwordx4 a[44:47], v1, s[68:71], s21 offen offset:3072
    v_mfma_f32_16x16x32_bf16 v[40:43], a[48:51], v[152:155], v[40:43]
    v_mfma_f32_16x16x32_bf16 v[44:47], a[48:51], v[156:159], v[44:47]
    v_mfma_f32_16x16x32_bf16 v[48:51], a[48:51], v[160:163], v[48:51]
    v_mfma_f32_16x16x32_bf16 v[52:55], a[48:51], v[164:167], v[52:55]
    s_mov_b32 s21, 36864
    buffer_load_dwordx4 a[48:51], v1, s[68:71], s21 offen offset:0
    v_mfma_f32_16x16x32_bf16 v[56:59], a[52:55], v[152:155], v[56:59]
    v_mfma_f32_16x16x32_bf16 v[60:63], a[52:55], v[156:159], v[60:63]
    v_mfma_f32_16x16x32_bf16 v[64:67], a[52:55], v[160:163], v[64:67]
    v_mfma_f32_16x16x32_bf16 v[68:71], a[52:55], v[164:167], v[68:71]
    buffer_load_dwordx4 a[52:55], v1, s[68:71], s21 offen offset:1024
    v_mfma_f32_16x16x32_bf16 v[72:75], a[56:59], v[152:155], v[72:75]
    v_mfma_f32_16x16x32_bf16 v[76:79], a[56:59], v[156:159], v[76:79]
    v_mfma_f32_16x16x32_bf16 v[80:83], a[56:59], v[160:163], v[80:83]
    v_mfma_f32_16x16x32_bf16 v[84:87], a[56:59], v[164:167], v[84:87]
    buffer_load_dwordx4 a[56:59], v1, s[68:71], s21 offen offset:2048
    s_waitcnt lgkmcnt(0)
    v_mfma_f32_16x16x32_bf16 v[8:11], a[60:63], v[168:171], v[8:11]
    v_mfma_f32_16x16x32_bf16 v[12:15], a[60:63], v[172:175], v[12:15]
    ds_read_b128 v[152:155], v1 offset:4096
    v_mfma_f32_16x16x32_bf16 v[16:19], a[60:63], v[176:179], v[16:19]
    ds_read_b128 v[156:159], v1 offset:22528
    v_mfma_f32_16x16x32_bf16 v[20:23], a[60:63], v[180:183], v[20:23]
    buffer_load_dwordx4 a[60:63], v1, s[68:71], s21 offen offset:3072
    v_mfma_f32_16x16x32_bf16 v[24:27], a[64:67], v[168:171], v[24:27]
    ds_read_b128 v[160:163], v1 offset:40960
    v_mfma_f32_16x16x32_bf16 v[28:31], a[64:67], v[172:175], v[28:31]
    ds_read_b128 v[164:167], v2 offset:4096
    v_mfma_f32_16x16x32_bf16 v[32:35], a[64:67], v[176:179], v[32:35]
    v_mfma_f32_16x16x32_bf16 v[36:39], a[64:67], v[180:183], v[36:39]
    s_mov_b32 s21, 40960
    buffer_load_dwordx4 a[64:67], v1, s[68:71], s21 offen offset:0
    v_mfma_f32_16x16x32_bf16 v[40:43], a[68:71], v[168:171], v[40:43]
    v_mfma_f32_16x16x32_bf16 v[44:47], a[68:71], v[172:175], v[44:47]
    v_mfma_f32_16x16x32_bf16 v[48:51], a[68:71], v[176:179], v[48:51]
    v_mfma_f32_16x16x32_bf16 v[52:55], a[68:71], v[180:183], v[52:55]
    buffer_load_dwordx4 a[68:71], v1, s[68:71], s21 offen offset:1024
    v_mfma_f32_16x16x32_bf16 v[56:59], a[72:75], v[168:171], v[56:59]
    v_mfma_f32_16x16x32_bf16 v[60:63], a[72:75], v[172:175], v[60:63]
    v_mfma_f32_16x16x32_bf16 v[64:67], a[72:75], v[176:179], v[64:67]
    v_mfma_f32_16x16x32_bf16 v[68:71], a[72:75], v[180:183], v[68:71]
    buffer_load_dwordx4 a[72:75], v1, s[68:71], s21 offen offset:2048
    v_mfma_f32_16x16x32_bf16 v[72:75], a[76:79], v[168:171], v[72:75]
    v_mfma_f32_16x16x32_bf16 v[76:79], a[76:79], v[172:175], v[76:79]
    v_mfma_f32_16x16x32_bf16 v[80:83], a[76:79], v[176:179], v[80:83]
    v_mfma_f32_16x16x32_bf16 v[84:87], a[76:79], v[180:183], v[84:87]
    buffer_load_dwordx4 a[76:79], v1, s[68:71], s21 offen offset:3072
    s_waitcnt lgkmcnt(0)
    v_mfma_f32_16x16x32_bf16 v[8:11], a[80:83], v[152:155], v[8:11]
    v_mfma_f32_16x16x32_bf16 v[12:15], a[80:83], v[156:159], v[12:15]
    ds_read_b128 v[168:171], v1 offset:5120
    v_mfma_f32_16x16x32_bf16 v[16:19], a[80:83], v[160:163], v[16:19]
    ds_read_b128 v[172:175], v1 offset:23552
    v_mfma_f32_16x16x32_bf16 v[20:23], a[80:83], v[164:167], v[20:23]
    s_mov_b32 s21, 45056
    buffer_load_dwordx4 a[80:83], v1, s[68:71], s21 offen offset:0
    v_mfma_f32_16x16x32_bf16 v[24:27], a[84:87], v[152:155], v[24:27]
    ds_read_b128 v[176:179], v1 offset:41984
    v_mfma_f32_16x16x32_bf16 v[28:31], a[84:87], v[156:159], v[28:31]
    ds_read_b128 v[180:183], v2 offset:5120
    v_mfma_f32_16x16x32_bf16 v[32:35], a[84:87], v[160:163], v[32:35]
    v_mfma_f32_16x16x32_bf16 v[36:39], a[84:87], v[164:167], v[36:39]
    buffer_load_dwordx4 a[84:87], v1, s[68:71], s21 offen offset:1024
    v_mfma_f32_16x16x32_bf16 v[40:43], a[88:91], v[152:155], v[40:43]
    v_mfma_f32_16x16x32_bf16 v[44:47], a[88:91], v[156:159], v[44:47]
    v_mfma_f32_16x16x32_bf16 v[48:51], a[88:91], v[160:163], v[48:51]
    v_mfma_f32_16x16x32_bf16 v[52:55], a[88:91], v[164:167], v[52:55]
    buffer_load_dwordx4 a[88:91], v1, s[68:71], s21 offen offset:2048
    v_mfma_f32_16x16x32_bf16 v[56:59], a[92:95], v[152:155], v[56:59]
    v_mfma_f32_16x16x32_bf16 v[60:63], a[92:95], v[156:159], v[60:63]
    v_mfma_f32_16x16x32_bf16 v[64:67], a[92:95], v[160:163], v[64:67]
    v_mfma_f32_16x16x32_bf16 v[68:71], a[92:95], v[164:167], v[68:71]
    buffer_load_dwordx4 a[92:95], v1, s[68:71], s21 offen offset:3072
    s_waitcnt vmcnt(23)
    v_mfma_f32_16x16x32_bf16 v[72:75], a[0:3], v[152:155], v[72:75]
    v_mfma_f32_16x16x32_bf16 v[76:79], a[0:3], v[156:159], v[76:79]
    v_mfma_f32_16x16x32_bf16 v[80:83], a[0:3], v[160:163], v[80:83]
    v_mfma_f32_16x16x32_bf16 v[84:87], a[0:3], v[164:167], v[84:87]
    s_mov_b32 s21, 49152
    buffer_load_dwordx4 a[0:3], v1, s[68:71], s21 offen offset:0
    s_barrier
    s_waitcnt lgkmcnt(0)
    s_waitcnt vmcnt(23)
    v_mfma_f32_16x16x32_bf16 v[8:11], a[4:7], v[168:171], v[8:11]
    v_mfma_f32_16x16x32_bf16 v[12:15], a[4:7], v[172:175], v[12:15]
    ds_read_b128 v[152:155], v1 offset:6144
    v_mfma_f32_16x16x32_bf16 v[16:19], a[4:7], v[176:179], v[16:19]
    ds_read_b128 v[156:159], v1 offset:24576
    v_mfma_f32_16x16x32_bf16 v[20:23], a[4:7], v[180:183], v[20:23]
    buffer_load_dwordx4 a[4:7], v1, s[68:71], s21 offen offset:1024
    s_waitcnt vmcnt(23)
    v_mfma_f32_16x16x32_bf16 v[24:27], a[8:11], v[168:171], v[24:27]
    ds_read_b128 v[160:163], v1 offset:43008
    v_mfma_f32_16x16x32_bf16 v[28:31], a[8:11], v[172:175], v[28:31]
    ds_read_b128 v[164:167], v2 offset:6144
    v_mfma_f32_16x16x32_bf16 v[32:35], a[8:11], v[176:179], v[32:35]
    v_mfma_f32_16x16x32_bf16 v[36:39], a[8:11], v[180:183], v[36:39]
    buffer_load_dwordx4 a[8:11], v1, s[68:71], s21 offen offset:2048
    s_waitcnt vmcnt(23)
    v_mfma_f32_16x16x32_bf16 v[40:43], a[12:15], v[168:171], v[40:43]
    v_mfma_f32_16x16x32_bf16 v[44:47], a[12:15], v[172:175], v[44:47]
    v_mfma_f32_16x16x32_bf16 v[48:51], a[12:15], v[176:179], v[48:51]
    v_mfma_f32_16x16x32_bf16 v[52:55], a[12:15], v[180:183], v[52:55]
    buffer_load_dwordx4 a[12:15], v1, s[68:71], s21 offen offset:3072
    s_waitcnt vmcnt(23)
    v_mfma_f32_16x16x32_bf16 v[56:59], a[16:19], v[168:171], v[56:59]
    v_mfma_f32_16x16x32_bf16 v[60:63], a[16:19], v[172:175], v[60:63]
    v_mfma_f32_16x16x32_bf16 v[64:67], a[16:19], v[176:179], v[64:67]
    v_mfma_f32_16x16x32_bf16 v[68:71], a[16:19], v[180:183], v[68:71]
    s_mov_b32 s21, 53248
    buffer_load_dwordx4 a[16:19], v1, s[68:71], s21 offen offset:0
    s_waitcnt vmcnt(23)
    v_mfma_f32_16x16x32_bf16 v[72:75], a[20:23], v[168:171], v[72:75]
    v_mfma_f32_16x16x32_bf16 v[76:79], a[20:23], v[172:175], v[76:79]
    v_mfma_f32_16x16x32_bf16 v[80:83], a[20:23], v[176:179], v[80:83]
    v_mfma_f32_16x16x32_bf16 v[84:87], a[20:23], v[180:183], v[84:87]
    buffer_load_dwordx4 a[20:23], v1, s[68:71], s21 offen offset:1024
    s_waitcnt lgkmcnt(0)
    s_waitcnt vmcnt(23)
    v_mfma_f32_16x16x32_bf16 v[8:11], a[24:27], v[152:155], v[8:11]
    v_mfma_f32_16x16x32_bf16 v[12:15], a[24:27], v[156:159], v[12:15]
    ds_read_b128 v[168:171], v1 offset:7168
    v_mfma_f32_16x16x32_bf16 v[16:19], a[24:27], v[160:163], v[16:19]
    ds_read_b128 v[172:175], v1 offset:25600
    v_mfma_f32_16x16x32_bf16 v[20:23], a[24:27], v[164:167], v[20:23]
    buffer_load_dwordx4 a[24:27], v1, s[68:71], s21 offen offset:2048
    s_waitcnt vmcnt(23)
    v_mfma_f32_16x16x32_bf16 v[24:27], a[28:31], v[152:155], v[24:27]
    ds_read_b128 v[176:179], v1 offset:44032
    v_mfma_f32_16x16x32_bf16 v[28:31], a[28:31], v[156:159], v[28:31]
    ds_read_b128 v[180:183], v2 offset:7168
    v_mfma_f32_16x16x32_bf16 v[32:35], a[28:31], v[160:163], v[32:35]
    v_mfma_f32_16x16x32_bf16 v[36:39], a[28:31], v[164:167], v[36:39]
    buffer_load_dwordx4 a[28:31], v1, s[68:71], s21 offen offset:3072
    s_waitcnt vmcnt(23)
    v_mfma_f32_16x16x32_bf16 v[40:43], a[32:35], v[152:155], v[40:43]
    v_mfma_f32_16x16x32_bf16 v[44:47], a[32:35], v[156:159], v[44:47]
    v_mfma_f32_16x16x32_bf16 v[48:51], a[32:35], v[160:163], v[48:51]
    v_mfma_f32_16x16x32_bf16 v[52:55], a[32:35], v[164:167], v[52:55]
    s_mov_b32 s21, 57344
    buffer_load_dwordx4 a[32:35], v1, s[68:71], s21 offen offset:0
    s_waitcnt vmcnt(23)
    v_mfma_f32_16x16x32_bf16 v[56:59], a[36:39], v[152:155], v[56:59]
    v_mfma_f32_16x16x32_bf16 v[60:63], a[36:39], v[156:159], v[60:63]
    v_mfma_f32_16x16x32_bf16 v[64:67], a[36:39], v[160:163], v[64:67]
    v_mfma_f32_16x16x32_bf16 v[68:71], a[36:39], v[164:167], v[68:71]
    buffer_load_dwordx4 a[36:39], v1, s[68:71], s21 offen offset:1024
    s_waitcnt vmcnt(23)
    v_mfma_f32_16x16x32_bf16 v[72:75], a[40:43], v[152:155], v[72:75]
    v_mfma_f32_16x16x32_bf16 v[76:79], a[40:43], v[156:159], v[76:79]
    v_mfma_f32_16x16x32_bf16 v[80:83], a[40:43], v[160:163], v[80:83]
    v_mfma_f32_16x16x32_bf16 v[84:87], a[40:43], v[164:167], v[84:87]
    buffer_load_dwordx4 a[40:43], v1, s[68:71], s21 offen offset:2048
    s_waitcnt lgkmcnt(0)
    s_waitcnt vmcnt(23)
    v_mfma_f32_16x16x32_bf16 v[8:11], a[44:47], v[168:171], v[8:11]
    v_mfma_f32_16x16x32_bf16 v[12:15], a[44:47], v[172:175], v[12:15]
    ds_read_b128 v[152:155], v1 offset:8192
    v_mfma_f32_16x16x32_bf16 v[16:19], a[44:47], v[176:179], v[16:19]
    ds_read_b128 v[156:159], v1 offset:26624
    v_mfma_f32_16x16x32_bf16 v[20:23], a[44:47], v[180:183], v[20:23]
    buffer_load_dwordx4 a[44:47], v1, s[68:71], s21 offen offset:3072
    s_waitcnt vmcnt(23)
    v_mfma_f32_16x16x32_bf16 v[24:27], a[48:51], v[168:171], v[24:27]
    ds_read_b128 v[160:163], v1 offset:45056
    v_mfma_f32_16x16x32_bf16 v[28:31], a[48:51], v[172:175], v[28:31]
    ds_read_b128 v[164:167], v2 offset:8192
    v_mfma_f32_16x16x32_bf16 v[32:35], a[48:51], v[176:179], v[32:35]
    v_mfma_f32_16x16x32_bf16 v[36:39], a[48:51], v[180:183], v[36:39]
    s_mov_b32 s21, 61440
    buffer_load_dwordx4 a[48:51], v1, s[68:71], s21 offen offset:0
    s_waitcnt vmcnt(23)
    v_mfma_f32_16x16x32_bf16 v[40:43], a[52:55], v[168:171], v[40:43]
    v_mfma_f32_16x16x32_bf16 v[44:47], a[52:55], v[172:175], v[44:47]
    v_mfma_f32_16x16x32_bf16 v[48:51], a[52:55], v[176:179], v[48:51]
    v_mfma_f32_16x16x32_bf16 v[52:55], a[52:55], v[180:183], v[52:55]
    buffer_load_dwordx4 a[52:55], v1, s[68:71], s21 offen offset:1024
    s_waitcnt vmcnt(23)
    v_mfma_f32_16x16x32_bf16 v[56:59], a[56:59], v[168:171], v[56:59]
    v_mfma_f32_16x16x32_bf16 v[60:63], a[56:59], v[172:175], v[60:63]
    v_mfma_f32_16x16x32_bf16 v[64:67], a[56:59], v[176:179], v[64:67]
    v_mfma_f32_16x16x32_bf16 v[68:71], a[56:59], v[180:183], v[68:71]
    buffer_load_dwordx4 a[56:59], v1, s[68:71], s21 offen offset:2048
    s_waitcnt vmcnt(23)
    v_mfma_f32_16x16x32_bf16 v[72:75], a[60:63], v[168:171], v[72:75]
    v_mfma_f32_16x16x32_bf16 v[76:79], a[60:63], v[172:175], v[76:79]
    v_mfma_f32_16x16x32_bf16 v[80:83], a[60:63], v[176:179], v[80:83]
    v_mfma_f32_16x16x32_bf16 v[84:87], a[60:63], v[180:183], v[84:87]
    buffer_load_dwordx4 a[60:63], v1, s[68:71], s21 offen offset:3072
    s_waitcnt lgkmcnt(0)
    s_waitcnt vmcnt(23)
    v_mfma_f32_16x16x32_bf16 v[8:11], a[64:67], v[152:155], v[8:11]
    v_mfma_f32_16x16x32_bf16 v[12:15], a[64:67], v[156:159], v[12:15]
    ds_read_b128 v[168:171], v1 offset:9216
    v_mfma_f32_16x16x32_bf16 v[16:19], a[64:67], v[160:163], v[16:19]
    ds_read_b128 v[172:175], v1 offset:27648
    v_mfma_f32_16x16x32_bf16 v[20:23], a[64:67], v[164:167], v[20:23]
    s_mov_b32 s21, 65536
    buffer_load_dwordx4 a[64:67], v1, s[68:71], s21 offen offset:0
    s_waitcnt vmcnt(23)
    v_mfma_f32_16x16x32_bf16 v[24:27], a[68:71], v[152:155], v[24:27]
    ds_read_b128 v[176:179], v1 offset:46080
    v_mfma_f32_16x16x32_bf16 v[28:31], a[68:71], v[156:159], v[28:31]
    ds_read_b128 v[180:183], v2 offset:9216
    v_mfma_f32_16x16x32_bf16 v[32:35], a[68:71], v[160:163], v[32:35]
    v_mfma_f32_16x16x32_bf16 v[36:39], a[68:71], v[164:167], v[36:39]
    buffer_load_dwordx4 a[68:71], v1, s[68:71], s21 offen offset:1024
    s_waitcnt vmcnt(23)
    v_mfma_f32_16x16x32_bf16 v[40:43], a[72:75], v[152:155], v[40:43]
    v_mfma_f32_16x16x32_bf16 v[44:47], a[72:75], v[156:159], v[44:47]
    v_mfma_f32_16x16x32_bf16 v[48:51], a[72:75], v[160:163], v[48:51]
    v_mfma_f32_16x16x32_bf16 v[52:55], a[72:75], v[164:167], v[52:55]
    buffer_load_dwordx4 a[72:75], v1, s[68:71], s21 offen offset:2048
    s_waitcnt vmcnt(23)
    v_mfma_f32_16x16x32_bf16 v[56:59], a[76:79], v[152:155], v[56:59]
    v_mfma_f32_16x16x32_bf16 v[60:63], a[76:79], v[156:159], v[60:63]
    v_mfma_f32_16x16x32_bf16 v[64:67], a[76:79], v[160:163], v[64:67]
    v_mfma_f32_16x16x32_bf16 v[68:71], a[76:79], v[164:167], v[68:71]
    buffer_load_dwordx4 a[76:79], v1, s[68:71], s21 offen offset:3072
    s_waitcnt vmcnt(23)
    v_mfma_f32_16x16x32_bf16 v[72:75], a[80:83], v[152:155], v[72:75]
    v_mfma_f32_16x16x32_bf16 v[76:79], a[80:83], v[156:159], v[76:79]
    v_mfma_f32_16x16x32_bf16 v[80:83], a[80:83], v[160:163], v[80:83]
    v_mfma_f32_16x16x32_bf16 v[84:87], a[80:83], v[164:167], v[84:87]
    s_mov_b32 s21, 69632
    buffer_load_dwordx4 a[80:83], v1, s[68:71], s21 offen offset:0
    s_waitcnt lgkmcnt(0)
    s_waitcnt vmcnt(23)
    v_mfma_f32_16x16x32_bf16 v[8:11], a[84:87], v[168:171], v[8:11]
    v_mfma_f32_16x16x32_bf16 v[12:15], a[84:87], v[172:175], v[12:15]
    ds_read_b128 v[152:155], v1 offset:10240
    v_mfma_f32_16x16x32_bf16 v[16:19], a[84:87], v[176:179], v[16:19]
    ds_read_b128 v[156:159], v1 offset:28672
    v_mfma_f32_16x16x32_bf16 v[20:23], a[84:87], v[180:183], v[20:23]
    buffer_load_dwordx4 a[84:87], v1, s[68:71], s21 offen offset:1024
    s_waitcnt vmcnt(23)
    v_mfma_f32_16x16x32_bf16 v[24:27], a[88:91], v[168:171], v[24:27]
    ds_read_b128 v[160:163], v1 offset:47104
    v_mfma_f32_16x16x32_bf16 v[28:31], a[88:91], v[172:175], v[28:31]
    ds_read_b128 v[164:167], v2 offset:10240
    v_mfma_f32_16x16x32_bf16 v[32:35], a[88:91], v[176:179], v[32:35]
    v_mfma_f32_16x16x32_bf16 v[36:39], a[88:91], v[180:183], v[36:39]
    buffer_load_dwordx4 a[88:91], v1, s[68:71], s21 offen offset:2048
    s_waitcnt vmcnt(23)
    v_mfma_f32_16x16x32_bf16 v[40:43], a[92:95], v[168:171], v[40:43]
    v_mfma_f32_16x16x32_bf16 v[44:47], a[92:95], v[172:175], v[44:47]
    v_mfma_f32_16x16x32_bf16 v[48:51], a[92:95], v[176:179], v[48:51]
    v_mfma_f32_16x16x32_bf16 v[52:55], a[92:95], v[180:183], v[52:55]
    buffer_load_dwordx4 a[92:95], v1, s[68:71], s21 offen offset:3072
    s_waitcnt vmcnt(23)
    v_mfma_f32_16x16x32_bf16 v[56:59], a[0:3], v[168:171], v[56:59]
    v_mfma_f32_16x16x32_bf16 v[60:63], a[0:3], v[172:175], v[60:63]
    v_mfma_f32_16x16x32_bf16 v[64:67], a[0:3], v[176:179], v[64:67]
    v_mfma_f32_16x16x32_bf16 v[68:71], a[0:3], v[180:183], v[68:71]
    s_mov_b32 s21, 73728
    buffer_load_dwordx4 a[0:3], v1, s[68:71], s21 offen offset:0
    s_waitcnt vmcnt(23)
    v_mfma_f32_16x16x32_bf16 v[72:75], a[4:7], v[168:171], v[72:75]
    v_mfma_f32_16x16x32_bf16 v[76:79], a[4:7], v[172:175], v[76:79]
    v_mfma_f32_16x16x32_bf16 v[80:83], a[4:7], v[176:179], v[80:83]
    v_mfma_f32_16x16x32_bf16 v[84:87], a[4:7], v[180:183], v[84:87]
    buffer_load_dwordx4 a[4:7], v1, s[68:71], s21 offen offset:1024
    s_waitcnt lgkmcnt(0)
    s_waitcnt vmcnt(23)
    v_mfma_f32_16x16x32_bf16 v[8:11], a[8:11], v[152:155], v[8:11]
    v_mfma_f32_16x16x32_bf16 v[12:15], a[8:11], v[156:159], v[12:15]
    ds_read_b128 v[168:171], v1 offset:11264
    v_mfma_f32_16x16x32_bf16 v[16:19], a[8:11], v[160:163], v[16:19]
    ds_read_b128 v[172:175], v1 offset:29696
    v_mfma_f32_16x16x32_bf16 v[20:23], a[8:11], v[164:167], v[20:23]
    buffer_load_dwordx4 a[8:11], v1, s[68:71], s21 offen offset:2048
    s_waitcnt vmcnt(23)
    v_mfma_f32_16x16x32_bf16 v[24:27], a[12:15], v[152:155], v[24:27]
    ds_read_b128 v[176:179], v1 offset:48128
    v_mfma_f32_16x16x32_bf16 v[28:31], a[12:15], v[156:159], v[28:31]
    ds_read_b128 v[180:183], v2 offset:11264
    v_mfma_f32_16x16x32_bf16 v[32:35], a[12:15], v[160:163], v[32:35]
    v_mfma_f32_16x16x32_bf16 v[36:39], a[12:15], v[164:167], v[36:39]
    buffer_load_dwordx4 a[12:15], v1, s[68:71], s21 offen offset:3072
    s_waitcnt vmcnt(23)
    v_mfma_f32_16x16x32_bf16 v[40:43], a[16:19], v[152:155], v[40:43]
    v_mfma_f32_16x16x32_bf16 v[44:47], a[16:19], v[156:159], v[44:47]
    v_mfma_f32_16x16x32_bf16 v[48:51], a[16:19], v[160:163], v[48:51]
    v_mfma_f32_16x16x32_bf16 v[52:55], a[16:19], v[164:167], v[52:55]
    s_mov_b32 s21, 77824
    buffer_load_dwordx4 a[16:19], v1, s[68:71], s21 offen offset:0
    s_waitcnt vmcnt(23)
    v_mfma_f32_16x16x32_bf16 v[56:59], a[20:23], v[152:155], v[56:59]
    v_mfma_f32_16x16x32_bf16 v[60:63], a[20:23], v[156:159], v[60:63]
    v_mfma_f32_16x16x32_bf16 v[64:67], a[20:23], v[160:163], v[64:67]
    v_mfma_f32_16x16x32_bf16 v[68:71], a[20:23], v[164:167], v[68:71]
    buffer_load_dwordx4 a[20:23], v1, s[68:71], s21 offen offset:1024
    s_waitcnt vmcnt(23)
    v_mfma_f32_16x16x32_bf16 v[72:75], a[24:27], v[152:155], v[72:75]
    v_mfma_f32_16x16x32_bf16 v[76:79], a[24:27], v[156:159], v[76:79]
    v_mfma_f32_16x16x32_bf16 v[80:83], a[24:27], v[160:163], v[80:83]
    v_mfma_f32_16x16x32_bf16 v[84:87], a[24:27], v[164:167], v[84:87]
    buffer_load_dwordx4 a[24:27], v1, s[68:71], s21 offen offset:2048
    s_barrier
    s_waitcnt lgkmcnt(0)
    s_waitcnt vmcnt(23)
    v_mfma_f32_16x16x32_bf16 v[8:11], a[28:31], v[168:171], v[8:11]
    v_mfma_f32_16x16x32_bf16 v[12:15], a[28:31], v[172:175], v[12:15]
    ds_read_b128 v[152:155], v1 offset:12288
    v_mfma_f32_16x16x32_bf16 v[16:19], a[28:31], v[176:179], v[16:19]
    ds_read_b128 v[156:159], v1 offset:30720
    v_mfma_f32_16x16x32_bf16 v[20:23], a[28:31], v[180:183], v[20:23]
    buffer_load_dwordx4 a[28:31], v1, s[68:71], s21 offen offset:3072
    s_waitcnt vmcnt(23)
    v_mfma_f32_16x16x32_bf16 v[24:27], a[32:35], v[168:171], v[24:27]
    ds_read_b128 v[160:163], v1 offset:49152
    v_mfma_f32_16x16x32_bf16 v[28:31], a[32:35], v[172:175], v[28:31]
    ds_read_b128 v[164:167], v2 offset:12288
    v_mfma_f32_16x16x32_bf16 v[32:35], a[32:35], v[176:179], v[32:35]
    v_mfma_f32_16x16x32_bf16 v[36:39], a[32:35], v[180:183], v[36:39]
    s_mov_b32 s21, 81920
    buffer_load_dwordx4 a[32:35], v1, s[68:71], s21 offen offset:0
    s_waitcnt vmcnt(23)
    v_mfma_f32_16x16x32_bf16 v[40:43], a[36:39], v[168:171], v[40:43]
    v_mfma_f32_16x16x32_bf16 v[44:47], a[36:39], v[172:175], v[44:47]
    v_mfma_f32_16x16x32_bf16 v[48:51], a[36:39], v[176:179], v[48:51]
    v_mfma_f32_16x16x32_bf16 v[52:55], a[36:39], v[180:183], v[52:55]
    buffer_load_dwordx4 a[36:39], v1, s[68:71], s21 offen offset:1024
    s_waitcnt vmcnt(23)
    v_mfma_f32_16x16x32_bf16 v[56:59], a[40:43], v[168:171], v[56:59]
    v_mfma_f32_16x16x32_bf16 v[60:63], a[40:43], v[172:175], v[60:63]
    v_mfma_f32_16x16x32_bf16 v[64:67], a[40:43], v[176:179], v[64:67]
    v_mfma_f32_16x16x32_bf16 v[68:71], a[40:43], v[180:183], v[68:71]
    buffer_load_dwordx4 a[40:43], v1, s[68:71], s21 offen offset:2048
    s_waitcnt vmcnt(23)
    v_mfma_f32_16x16x32_bf16 v[72:75], a[44:47], v[168:171], v[72:75]
    v_mfma_f32_16x16x32_bf16 v[76:79], a[44:47], v[172:175], v[76:79]
    v_mfma_f32_16x16x32_bf16 v[80:83], a[44:47], v[176:179], v[80:83]
    v_mfma_f32_16x16x32_bf16 v[84:87], a[44:47], v[180:183], v[84:87]
    buffer_load_dwordx4 a[44:47], v1, s[68:71], s21 offen offset:3072
    s_waitcnt lgkmcnt(0)
    s_waitcnt vmcnt(23)
    v_mfma_f32_16x16x32_bf16 v[8:11], a[48:51], v[152:155], v[8:11]
    v_mfma_f32_16x16x32_bf16 v[12:15], a[48:51], v[156:159], v[12:15]
    ds_read_b128 v[168:171], v1 offset:13312
    v_mfma_f32_16x16x32_bf16 v[16:19], a[48:51], v[160:163], v[16:19]
    ds_read_b128 v[172:175], v1 offset:31744
    v_mfma_f32_16x16x32_bf16 v[20:23], a[48:51], v[164:167], v[20:23]
    s_mov_b32 s21, 86016
    buffer_load_dwordx4 a[48:51], v1, s[68:71], s21 offen offset:0
    s_waitcnt vmcnt(23)
    v_mfma_f32_16x16x32_bf16 v[24:27], a[52:55], v[152:155], v[24:27]
    ds_read_b128 v[176:179], v1 offset:50176
    v_mfma_f32_16x16x32_bf16 v[28:31], a[52:55], v[156:159], v[28:31]
    ds_read_b128 v[180:183], v2 offset:13312
    v_mfma_f32_16x16x32_bf16 v[32:35], a[52:55], v[160:163], v[32:35]
    v_mfma_f32_16x16x32_bf16 v[36:39], a[52:55], v[164:167], v[36:39]
    buffer_load_dwordx4 a[52:55], v1, s[68:71], s21 offen offset:1024
    s_waitcnt vmcnt(23)
    v_mfma_f32_16x16x32_bf16 v[40:43], a[56:59], v[152:155], v[40:43]
    v_mfma_f32_16x16x32_bf16 v[44:47], a[56:59], v[156:159], v[44:47]
    v_mfma_f32_16x16x32_bf16 v[48:51], a[56:59], v[160:163], v[48:51]
    v_mfma_f32_16x16x32_bf16 v[52:55], a[56:59], v[164:167], v[52:55]
    buffer_load_dwordx4 a[56:59], v1, s[68:71], s21 offen offset:2048
    s_waitcnt vmcnt(23)
    v_mfma_f32_16x16x32_bf16 v[56:59], a[60:63], v[152:155], v[56:59]
    v_mfma_f32_16x16x32_bf16 v[60:63], a[60:63], v[156:159], v[60:63]
    v_mfma_f32_16x16x32_bf16 v[64:67], a[60:63], v[160:163], v[64:67]
    v_mfma_f32_16x16x32_bf16 v[68:71], a[60:63], v[164:167], v[68:71]
    buffer_load_dwordx4 a[60:63], v1, s[68:71], s21 offen offset:3072
    s_waitcnt vmcnt(23)
    v_mfma_f32_16x16x32_bf16 v[72:75], a[64:67], v[152:155], v[72:75]
    v_mfma_f32_16x16x32_bf16 v[76:79], a[64:67], v[156:159], v[76:79]
    v_mfma_f32_16x16x32_bf16 v[80:83], a[64:67], v[160:163], v[80:83]
    v_mfma_f32_16x16x32_bf16 v[84:87], a[64:67], v[164:167], v[84:87]
    s_mov_b32 s21, 90112
    buffer_load_dwordx4 a[64:67], v1, s[68:71], s21 offen offset:0
    s_waitcnt lgkmcnt(0)
    s_waitcnt vmcnt(23)
    v_mfma_f32_16x16x32_bf16 v[8:11], a[68:71], v[168:171], v[8:11]
    v_mfma_f32_16x16x32_bf16 v[12:15], a[68:71], v[172:175], v[12:15]
    ds_read_b128 v[152:155], v1 offset:14336
    v_mfma_f32_16x16x32_bf16 v[16:19], a[68:71], v[176:179], v[16:19]
    ds_read_b128 v[156:159], v1 offset:32768
    v_mfma_f32_16x16x32_bf16 v[20:23], a[68:71], v[180:183], v[20:23]
    buffer_load_dwordx4 a[68:71], v1, s[68:71], s21 offen offset:1024
    s_waitcnt vmcnt(23)
    v_mfma_f32_16x16x32_bf16 v[24:27], a[72:75], v[168:171], v[24:27]
    ds_read_b128 v[160:163], v1 offset:51200
    v_mfma_f32_16x16x32_bf16 v[28:31], a[72:75], v[172:175], v[28:31]
    ds_read_b128 v[164:167], v2 offset:14336
    v_mfma_f32_16x16x32_bf16 v[32:35], a[72:75], v[176:179], v[32:35]
    v_mfma_f32_16x16x32_bf16 v[36:39], a[72:75], v[180:183], v[36:39]
    buffer_load_dwordx4 a[72:75], v1, s[68:71], s21 offen offset:2048
    s_waitcnt vmcnt(23)
    v_mfma_f32_16x16x32_bf16 v[40:43], a[76:79], v[168:171], v[40:43]
    v_mfma_f32_16x16x32_bf16 v[44:47], a[76:79], v[172:175], v[44:47]
    v_mfma_f32_16x16x32_bf16 v[48:51], a[76:79], v[176:179], v[48:51]
    v_mfma_f32_16x16x32_bf16 v[52:55], a[76:79], v[180:183], v[52:55]
    buffer_load_dwordx4 a[76:79], v1, s[68:71], s21 offen offset:3072
    s_waitcnt vmcnt(23)
    v_mfma_f32_16x16x32_bf16 v[56:59], a[80:83], v[168:171], v[56:59]
    v_mfma_f32_16x16x32_bf16 v[60:63], a[80:83], v[172:175], v[60:63]
    v_mfma_f32_16x16x32_bf16 v[64:67], a[80:83], v[176:179], v[64:67]
    v_mfma_f32_16x16x32_bf16 v[68:71], a[80:83], v[180:183], v[68:71]
    s_mov_b32 s21, 94208
    buffer_load_dwordx4 a[80:83], v1, s[68:71], s21 offen offset:0
    s_waitcnt vmcnt(23)
    v_mfma_f32_16x16x32_bf16 v[72:75], a[84:87], v[168:171], v[72:75]
    v_mfma_f32_16x16x32_bf16 v[76:79], a[84:87], v[172:175], v[76:79]
    v_mfma_f32_16x16x32_bf16 v[80:83], a[84:87], v[176:179], v[80:83]
    v_mfma_f32_16x16x32_bf16 v[84:87], a[84:87], v[180:183], v[84:87]
    buffer_load_dwordx4 a[84:87], v1, s[68:71], s21 offen offset:1024
    s_waitcnt lgkmcnt(0)
    s_waitcnt vmcnt(23)
    v_mfma_f32_16x16x32_bf16 v[8:11], a[88:91], v[152:155], v[8:11]
    v_mfma_f32_16x16x32_bf16 v[12:15], a[88:91], v[156:159], v[12:15]
    ds_read_b128 v[168:171], v1 offset:15360
    v_mfma_f32_16x16x32_bf16 v[16:19], a[88:91], v[160:163], v[16:19]
    ds_read_b128 v[172:175], v1 offset:33792
    v_mfma_f32_16x16x32_bf16 v[20:23], a[88:91], v[164:167], v[20:23]
    buffer_load_dwordx4 a[88:91], v1, s[68:71], s21 offen offset:2048
    s_waitcnt vmcnt(23)
    v_mfma_f32_16x16x32_bf16 v[24:27], a[92:95], v[152:155], v[24:27]
    ds_read_b128 v[176:179], v1 offset:52224
    v_mfma_f32_16x16x32_bf16 v[28:31], a[92:95], v[156:159], v[28:31]
    ds_read_b128 v[180:183], v2 offset:15360
    v_mfma_f32_16x16x32_bf16 v[32:35], a[92:95], v[160:163], v[32:35]
    v_mfma_f32_16x16x32_bf16 v[36:39], a[92:95], v[164:167], v[36:39]
    buffer_load_dwordx4 a[92:95], v1, s[68:71], s21 offen offset:3072
    s_waitcnt vmcnt(23)
    v_mfma_f32_16x16x32_bf16 v[40:43], a[0:3], v[152:155], v[40:43]
    v_mfma_f32_16x16x32_bf16 v[44:47], a[0:3], v[156:159], v[44:47]
    v_mfma_f32_16x16x32_bf16 v[48:51], a[0:3], v[160:163], v[48:51]
    v_mfma_f32_16x16x32_bf16 v[52:55], a[0:3], v[164:167], v[52:55]
    s_mov_b32 s21, 98304
    buffer_load_dwordx4 a[0:3], v1, s[68:71], s21 offen offset:0
    s_waitcnt vmcnt(23)
    v_mfma_f32_16x16x32_bf16 v[56:59], a[4:7], v[152:155], v[56:59]
    v_mfma_f32_16x16x32_bf16 v[60:63], a[4:7], v[156:159], v[60:63]
    v_mfma_f32_16x16x32_bf16 v[64:67], a[4:7], v[160:163], v[64:67]
    v_mfma_f32_16x16x32_bf16 v[68:71], a[4:7], v[164:167], v[68:71]
    buffer_load_dwordx4 a[4:7], v1, s[68:71], s21 offen offset:1024
    s_waitcnt vmcnt(23)
    v_mfma_f32_16x16x32_bf16 v[72:75], a[8:11], v[152:155], v[72:75]
    v_mfma_f32_16x16x32_bf16 v[76:79], a[8:11], v[156:159], v[76:79]
    v_mfma_f32_16x16x32_bf16 v[80:83], a[8:11], v[160:163], v[80:83]
    v_mfma_f32_16x16x32_bf16 v[84:87], a[8:11], v[164:167], v[84:87]
    buffer_load_dwordx4 a[8:11], v1, s[68:71], s21 offen offset:2048
    s_waitcnt lgkmcnt(0)
    s_waitcnt vmcnt(23)
    v_mfma_f32_16x16x32_bf16 v[8:11], a[12:15], v[168:171], v[8:11]
    v_mfma_f32_16x16x32_bf16 v[12:15], a[12:15], v[172:175], v[12:15]
    ds_read_b128 v[152:155], v1 offset:16384
    v_mfma_f32_16x16x32_bf16 v[16:19], a[12:15], v[176:179], v[16:19]
    ds_read_b128 v[156:159], v1 offset:34816
    v_mfma_f32_16x16x32_bf16 v[20:23], a[12:15], v[180:183], v[20:23]
    buffer_load_dwordx4 a[12:15], v1, s[68:71], s21 offen offset:3072
    s_waitcnt vmcnt(23)
    v_mfma_f32_16x16x32_bf16 v[24:27], a[16:19], v[168:171], v[24:27]
    ds_read_b128 v[160:163], v1 offset:53248
    v_mfma_f32_16x16x32_bf16 v[28:31], a[16:19], v[172:175], v[28:31]
    ds_read_b128 v[164:167], v2 offset:16384
    v_mfma_f32_16x16x32_bf16 v[32:35], a[16:19], v[176:179], v[32:35]
    v_mfma_f32_16x16x32_bf16 v[36:39], a[16:19], v[180:183], v[36:39]
    s_mov_b32 s21, 102400
    buffer_load_dwordx4 a[16:19], v1, s[68:71], s21 offen offset:0
    s_waitcnt vmcnt(23)
    v_mfma_f32_16x16x32_bf16 v[40:43], a[20:23], v[168:171], v[40:43]
    v_mfma_f32_16x16x32_bf16 v[44:47], a[20:23], v[172:175], v[44:47]
    v_mfma_f32_16x16x32_bf16 v[48:51], a[20:23], v[176:179], v[48:51]
    v_mfma_f32_16x16x32_bf16 v[52:55], a[20:23], v[180:183], v[52:55]
    buffer_load_dwordx4 a[20:23], v1, s[68:71], s21 offen offset:1024
    s_waitcnt vmcnt(23)
    v_mfma_f32_16x16x32_bf16 v[56:59], a[24:27], v[168:171], v[56:59]
    v_mfma_f32_16x16x32_bf16 v[60:63], a[24:27], v[172:175], v[60:63]
    v_mfma_f32_16x16x32_bf16 v[64:67], a[24:27], v[176:179], v[64:67]
    v_mfma_f32_16x16x32_bf16 v[68:71], a[24:27], v[180:183], v[68:71]
    buffer_load_dwordx4 a[24:27], v1, s[68:71], s21 offen offset:2048
    s_waitcnt vmcnt(23)
    v_mfma_f32_16x16x32_bf16 v[72:75], a[28:31], v[168:171], v[72:75]
    v_mfma_f32_16x16x32_bf16 v[76:79], a[28:31], v[172:175], v[76:79]
    v_mfma_f32_16x16x32_bf16 v[80:83], a[28:31], v[176:179], v[80:83]
    v_mfma_f32_16x16x32_bf16 v[84:87], a[28:31], v[180:183], v[84:87]
    buffer_load_dwordx4 a[28:31], v1, s[68:71], s21 offen offset:3072
    s_waitcnt lgkmcnt(0)
    s_waitcnt vmcnt(23)
    v_mfma_f32_16x16x32_bf16 v[8:11], a[32:35], v[152:155], v[8:11]
    v_mfma_f32_16x16x32_bf16 v[12:15], a[32:35], v[156:159], v[12:15]
    ds_read_b128 v[168:171], v1 offset:17408
    v_mfma_f32_16x16x32_bf16 v[16:19], a[32:35], v[160:163], v[16:19]
    ds_read_b128 v[172:175], v1 offset:35840
    v_mfma_f32_16x16x32_bf16 v[20:23], a[32:35], v[164:167], v[20:23]
    s_mov_b32 s21, 106496
    buffer_load_dwordx4 a[32:35], v1, s[68:71], s21 offen offset:0
    s_waitcnt vmcnt(23)
    v_mfma_f32_16x16x32_bf16 v[24:27], a[36:39], v[152:155], v[24:27]
    ds_read_b128 v[176:179], v1 offset:54272
    v_mfma_f32_16x16x32_bf16 v[28:31], a[36:39], v[156:159], v[28:31]
    ds_read_b128 v[180:183], v2 offset:17408
    v_mfma_f32_16x16x32_bf16 v[32:35], a[36:39], v[160:163], v[32:35]
    v_mfma_f32_16x16x32_bf16 v[36:39], a[36:39], v[164:167], v[36:39]
    buffer_load_dwordx4 a[36:39], v1, s[68:71], s21 offen offset:1024
    s_waitcnt vmcnt(23)
    v_mfma_f32_16x16x32_bf16 v[40:43], a[40:43], v[152:155], v[40:43]
    v_mfma_f32_16x16x32_bf16 v[44:47], a[40:43], v[156:159], v[44:47]
    v_mfma_f32_16x16x32_bf16 v[48:51], a[40:43], v[160:163], v[48:51]
    v_mfma_f32_16x16x32_bf16 v[52:55], a[40:43], v[164:167], v[52:55]
    buffer_load_dwordx4 a[40:43], v1, s[68:71], s21 offen offset:2048
    s_waitcnt vmcnt(23)
    v_mfma_f32_16x16x32_bf16 v[56:59], a[44:47], v[152:155], v[56:59]
    v_mfma_f32_16x16x32_bf16 v[60:63], a[44:47], v[156:159], v[60:63]
    v_mfma_f32_16x16x32_bf16 v[64:67], a[44:47], v[160:163], v[64:67]
    v_mfma_f32_16x16x32_bf16 v[68:71], a[44:47], v[164:167], v[68:71]
    buffer_load_dwordx4 a[44:47], v1, s[68:71], s21 offen offset:3072
    s_waitcnt vmcnt(23)
    v_mfma_f32_16x16x32_bf16 v[72:75], a[48:51], v[152:155], v[72:75]
    v_mfma_f32_16x16x32_bf16 v[76:79], a[48:51], v[156:159], v[76:79]
    v_mfma_f32_16x16x32_bf16 v[80:83], a[48:51], v[160:163], v[80:83]
    v_mfma_f32_16x16x32_bf16 v[84:87], a[48:51], v[164:167], v[84:87]
    s_mov_b32 s21, 110592
    buffer_load_dwordx4 a[48:51], v1, s[68:71], s21 offen offset:0
    s_waitcnt lgkmcnt(0)
    s_waitcnt vmcnt(23)
    v_mfma_f32_16x16x32_bf16 v[8:11], a[52:55], v[168:171], v[8:11]
    v_mfma_f32_16x16x32_bf16 v[12:15], a[52:55], v[172:175], v[12:15]
    ds_read_b128 v[152:155], v1 offset:0
    v_mfma_f32_16x16x32_bf16 v[16:19], a[52:55], v[176:179], v[16:19]
    ds_read_b128 v[156:159], v1 offset:18432
    v_mfma_f32_16x16x32_bf16 v[20:23], a[52:55], v[180:183], v[20:23]
    buffer_load_dwordx4 a[52:55], v1, s[68:71], s21 offen offset:1024
    s_waitcnt vmcnt(23)
    v_mfma_f32_16x16x32_bf16 v[24:27], a[56:59], v[168:171], v[24:27]
    ds_read_b128 v[160:163], v1 offset:36864
    v_mfma_f32_16x16x32_bf16 v[28:31], a[56:59], v[172:175], v[28:31]
    ds_read_b128 v[164:167], v2 offset:0
    v_mfma_f32_16x16x32_bf16 v[32:35], a[56:59], v[176:179], v[32:35]
    v_mfma_f32_16x16x32_bf16 v[36:39], a[56:59], v[180:183], v[36:39]
    buffer_load_dwordx4 a[56:59], v1, s[68:71], s21 offen offset:2048
    s_waitcnt vmcnt(23)
    v_mfma_f32_16x16x32_bf16 v[40:43], a[60:63], v[168:171], v[40:43]
    v_mfma_f32_16x16x32_bf16 v[44:47], a[60:63], v[172:175], v[44:47]
    v_mfma_f32_16x16x32_bf16 v[48:51], a[60:63], v[176:179], v[48:51]
    v_mfma_f32_16x16x32_bf16 v[52:55], a[60:63], v[180:183], v[52:55]
    buffer_load_dwordx4 a[60:63], v1, s[68:71], s21 offen offset:3072
    s_waitcnt vmcnt(23)
    v_mfma_f32_16x16x32_bf16 v[56:59], a[64:67], v[168:171], v[56:59]
    v_mfma_f32_16x16x32_bf16 v[60:63], a[64:67], v[172:175], v[60:63]
    v_mfma_f32_16x16x32_bf16 v[64:67], a[64:67], v[176:179], v[64:67]
    v_mfma_f32_16x16x32_bf16 v[68:71], a[64:67], v[180:183], v[68:71]
    s_mov_b32 s21, 114688
    buffer_load_dwordx4 a[64:67], v1, s[68:71], s21 offen offset:0
    s_waitcnt vmcnt(23)
    v_mfma_f32_16x16x32_bf16 v[72:75], a[68:71], v[168:171], v[72:75]
    v_mfma_f32_16x16x32_bf16 v[76:79], a[68:71], v[172:175], v[76:79]
    v_mfma_f32_16x16x32_bf16 v[80:83], a[68:71], v[176:179], v[80:83]
    v_mfma_f32_16x16x32_bf16 v[84:87], a[68:71], v[180:183], v[84:87]
    buffer_load_dwordx4 a[68:71], v1, s[68:71], s21 offen offset:1024
    s_waitcnt lgkmcnt(0)
    s_waitcnt vmcnt(23)
    v_mfma_f32_16x16x32_bf16 v[88:91], a[72:75], v[152:155], 0
    v_mfma_f32_16x16x32_bf16 v[92:95], a[72:75], v[156:159], 0
    ds_read_b128 v[168:171], v1 offset:1024
    v_mfma_f32_16x16x32_bf16 v[96:99], a[72:75], v[160:163], 0
    ds_read_b128 v[172:175], v1 offset:19456
    v_mfma_f32_16x16x32_bf16 v[100:103], a[72:75], v[164:167], 0
    buffer_load_dwordx4 a[72:75], v1, s[68:71], s21 offen offset:2048
    s_waitcnt vmcnt(23)
    v_mfma_f32_16x16x32_bf16 v[104:107], a[76:79], v[152:155], 0
    ds_read_b128 v[176:179], v1 offset:37888
    v_mfma_f32_16x16x32_bf16 v[108:111], a[76:79], v[156:159], 0
    ds_read_b128 v[180:183], v2 offset:1024
    v_mfma_f32_16x16x32_bf16 v[112:115], a[76:79], v[160:163], 0
    v_cvt_pk_bf16_f32 v184, v8, v9
    v_mfma_f32_16x16x32_bf16 v[116:119], a[76:79], v[164:167], 0
    buffer_load_dwordx4 a[76:79], v1, s[68:71], s21 offen offset:3072
    s_waitcnt vmcnt(23)
    v_mfma_f32_16x16x32_bf16 v[120:123], a[80:83], v[152:155], 0
    v_cvt_pk_bf16_f32 v185, v10, v11
    v_mfma_f32_16x16x32_bf16 v[124:127], a[80:83], v[156:159], 0
    v_pk_max_i16 v184, v184, 0
    v_mfma_f32_16x16x32_bf16 v[128:131], a[80:83], v[160:163], 0
    v_pk_max_i16 v185, v185, 0
    v_mfma_f32_16x16x32_bf16 v[132:135], a[80:83], v[164:167], 0
    s_mov_b32 s21, 118784
    buffer_load_dwordx4 a[80:83], v1, s[68:71], s21 offen offset:0
    s_waitcnt vmcnt(23)
    v_mfma_f32_16x16x32_bf16 v[136:139], a[84:87], v[152:155], 0
    ds_write_b64 v5, v[184:185] offset:0
    v_mfma_f32_16x16x32_bf16 v[140:143], a[84:87], v[156:159], 0
    v_cvt_pk_bf16_f32 v186, v12, v13
    v_mfma_f32_16x16x32_bf16 v[144:147], a[84:87], v[160:163], 0
    v_cvt_pk_bf16_f32 v187, v14, v15
    v_mfma_f32_16x16x32_bf16 v[148:151], a[84:87], v[164:167], 0
    buffer_load_dwordx4 a[84:87], v1, s[68:71], s21 offen offset:1024
    s_waitcnt lgkmcnt(1)
    s_waitcnt vmcnt(23)
    v_mfma_f32_16x16x32_bf16 v[88:91], a[88:91], v[168:171], v[88:91]
    v_pk_max_i16 v186, v186, 0
    v_mfma_f32_16x16x32_bf16 v[92:95], a[88:91], v[172:175], v[92:95]
    ds_read_b128 v[152:155], v1 offset:2048
    v_mfma_f32_16x16x32_bf16 v[96:99], a[88:91], v[176:179], v[96:99]
    ds_read_b128 v[156:159], v1 offset:20480
    v_mfma_f32_16x16x32_bf16 v[100:103], a[88:91], v[180:183], v[100:103]
    buffer_load_dwordx4 a[88:91], v1, s[68:71], s21 offen offset:2048
    s_waitcnt vmcnt(23)
    v_mfma_f32_16x16x32_bf16 v[104:107], a[92:95], v[168:171], v[104:107]
    ds_read_b128 v[160:163], v1 offset:38912
    v_mfma_f32_16x16x32_bf16 v[108:111], a[92:95], v[172:175], v[108:111]
    ds_read_b128 v[164:167], v2 offset:2048
    v_mfma_f32_16x16x32_bf16 v[112:115], a[92:95], v[176:179], v[112:115]
    v_pk_max_i16 v187, v187, 0
    v_mfma_f32_16x16x32_bf16 v[116:119], a[92:95], v[180:183], v[116:119]
    buffer_load_dwordx4 a[92:95], v1, s[68:71], s21 offen offset:3072
    s_waitcnt vmcnt(23)
    v_mfma_f32_16x16x32_bf16 v[120:123], a[0:3], v[168:171], v[120:123]
    ds_write_b64 v5, v[186:187] offset:18432
    v_mfma_f32_16x16x32_bf16 v[124:127], a[0:3], v[172:175], v[124:127]
    v_cvt_pk_bf16_f32 v188, v16, v17
    v_mfma_f32_16x16x32_bf16 v[128:131], a[0:3], v[176:179], v[128:131]
    v_cvt_pk_bf16_f32 v189, v18, v19
    v_mfma_f32_16x16x32_bf16 v[132:135], a[0:3], v[180:183], v[132:135]
    s_mov_b32 s21, 122880
    buffer_load_dwordx4 a[0:3], v1, s[68:71], s21 offen offset:0
    s_waitcnt vmcnt(23)
    v_mfma_f32_16x16x32_bf16 v[136:139], a[4:7], v[168:171], v[136:139]
    v_pk_max_i16 v188, v188, 0
    v_mfma_f32_16x16x32_bf16 v[140:143], a[4:7], v[172:175], v[140:143]
    v_pk_max_i16 v189, v189, 0
    v_mfma_f32_16x16x32_bf16 v[144:147], a[4:7], v[176:179], v[144:147]
    ds_write_b64 v5, v[188:189] offset:36864
    v_mfma_f32_16x16x32_bf16 v[148:151], a[4:7], v[180:183], v[148:151]
    buffer_load_dwordx4 a[4:7], v1, s[68:71], s21 offen offset:1024
    s_waitcnt lgkmcnt(2)
    s_waitcnt vmcnt(23)
    v_mfma_f32_16x16x32_bf16 v[88:91], a[8:11], v[152:155], v[88:91]
    v_cvt_pk_bf16_f32 v190, v20, v21
    v_mfma_f32_16x16x32_bf16 v[92:95], a[8:11], v[156:159], v[92:95]
    ds_read_b128 v[168:171], v1 offset:3072
    v_mfma_f32_16x16x32_bf16 v[96:99], a[8:11], v[160:163], v[96:99]
    ds_read_b128 v[172:175], v1 offset:21504
    v_mfma_f32_16x16x32_bf16 v[100:103], a[8:11], v[164:167], v[100:103]
    buffer_load_dwordx4 a[8:11], v1, s[68:71], s21 offen offset:2048
    s_waitcnt vmcnt(23)
    v_mfma_f32_16x16x32_bf16 v[104:107], a[12:15], v[152:155], v[104:107]
    ds_read_b128 v[176:179], v1 offset:39936
    v_mfma_f32_16x16x32_bf16 v[108:111], a[12:15], v[156:159], v[108:111]
    ds_read_b128 v[180:183], v2 offset:3072
    v_mfma_f32_16x16x32_bf16 v[112:115], a[12:15], v[160:163], v[112:115]
    v_cvt_pk_bf16_f32 v191, v22, v23
    v_mfma_f32_16x16x32_bf16 v[116:119], a[12:15], v[164:167], v[116:119]
    buffer_load_dwordx4 a[12:15], v1, s[68:71], s21 offen offset:3072
    s_waitcnt vmcnt(23)
    v_mfma_f32_16x16x32_bf16 v[120:123], a[16:19], v[152:155], v[120:123]
    v_pk_max_i16 v190, v190, 0
    v_mfma_f32_16x16x32_bf16 v[124:127], a[16:19], v[156:159], v[124:127]
    v_pk_max_i16 v191, v191, 0
    v_mfma_f32_16x16x32_bf16 v[128:131], a[16:19], v[160:163], v[128:131]
    ds_write_b64 v5, v[190:191] offset:55296
    v_mfma_f32_16x16x32_bf16 v[132:135], a[16:19], v[164:167], v[132:135]
    buffer_load_dword v229, v228, s[44:47], 0 offen offset:4032 sc0 sc1
    s_mov_b32 s21, 126976
    buffer_load_dwordx4 a[16:19], v1, s[68:71], s21 offen offset:0
    s_waitcnt vmcnt(24)
    v_mfma_f32_16x16x32_bf16 v[136:139], a[20:23], v[152:155], v[136:139]
    v_cvt_pk_bf16_f32 v192, v24, v25
    v_mfma_f32_16x16x32_bf16 v[140:143], a[20:23], v[156:159], v[140:143]
    v_cvt_pk_bf16_f32 v193, v26, v27
    v_mfma_f32_16x16x32_bf16 v[144:147], a[20:23], v[160:163], v[144:147]
    v_pk_max_i16 v192, v192, 0
    v_mfma_f32_16x16x32_bf16 v[148:151], a[20:23], v[164:167], v[148:151]
    buffer_load_dwordx4 a[20:23], v1, s[68:71], s21 offen offset:1024
    s_waitcnt lgkmcnt(1)
    s_waitcnt vmcnt(24)
    v_mfma_f32_16x16x32_bf16 v[88:91], a[24:27], v[168:171], v[88:91]
    v_pk_max_i16 v193, v193, 0
    v_mfma_f32_16x16x32_bf16 v[92:95], a[24:27], v[172:175], v[92:95]
    ds_read_b128 v[152:155], v1 offset:4096
    v_mfma_f32_16x16x32_bf16 v[96:99], a[24:27], v[176:179], v[96:99]
    ds_read_b128 v[156:159], v1 offset:22528
    v_mfma_f32_16x16x32_bf16 v[100:103], a[24:27], v[180:183], v[100:103]
    buffer_load_dwordx4 a[24:27], v1, s[68:71], s21 offen offset:2048
    s_waitcnt vmcnt(24)
    v_mfma_f32_16x16x32_bf16 v[104:107], a[28:31], v[168:171], v[104:107]
    ds_read_b128 v[160:163], v1 offset:40960
    v_mfma_f32_16x16x32_bf16 v[108:111], a[28:31], v[172:175], v[108:111]
    ds_read_b128 v[164:167], v2 offset:4096
    v_mfma_f32_16x16x32_bf16 v[112:115], a[28:31], v[176:179], v[112:115]
    ds_write_b64 v6, v[192:193] offset:0
    v_mfma_f32_16x16x32_bf16 v[116:119], a[28:31], v[180:183], v[116:119]
    buffer_load_dwordx4 a[28:31], v1, s[68:71], s21 offen offset:3072
    s_waitcnt vmcnt(24)
    v_mfma_f32_16x16x32_bf16 v[120:123], a[32:35], v[168:171], v[120:123]
    v_cvt_pk_bf16_f32 v194, v28, v29
    v_mfma_f32_16x16x32_bf16 v[124:127], a[32:35], v[172:175], v[124:127]
    v_cvt_pk_bf16_f32 v195, v30, v31
    v_mfma_f32_16x16x32_bf16 v[128:131], a[32:35], v[176:179], v[128:131]
    v_pk_max_i16 v194, v194, 0
    v_mfma_f32_16x16x32_bf16 v[132:135], a[32:35], v[180:183], v[132:135]
    s_mov_b32 s21, 131072
    buffer_load_dwordx4 a[32:35], v1, s[68:71], s21 offen offset:0
    s_waitcnt vmcnt(24)
    v_mfma_f32_16x16x32_bf16 v[136:139], a[36:39], v[168:171], v[136:139]
    v_pk_max_i16 v195, v195, 0
    v_mfma_f32_16x16x32_bf16 v[140:143], a[36:39], v[172:175], v[140:143]
    ds_write_b64 v6, v[194:195] offset:18432
    v_mfma_f32_16x16x32_bf16 v[144:147], a[36:39], v[176:179], v[144:147]
    v_cvt_pk_bf16_f32 v196, v32, v33
    v_mfma_f32_16x16x32_bf16 v[148:151], a[36:39], v[180:183], v[148:151]
    buffer_load_dwordx4 a[36:39], v1, s[68:71], s21 offen offset:1024
    s_waitcnt lgkmcnt(2)
    s_waitcnt vmcnt(24)
    v_mfma_f32_16x16x32_bf16 v[88:91], a[40:43], v[152:155], v[88:91]
    v_cvt_pk_bf16_f32 v197, v34, v35
    v_mfma_f32_16x16x32_bf16 v[92:95], a[40:43], v[156:159], v[92:95]
    ds_read_b128 v[168:171], v1 offset:5120
    v_mfma_f32_16x16x32_bf16 v[96:99], a[40:43], v[160:163], v[96:99]
    ds_read_b128 v[172:175], v1 offset:23552
    v_mfma_f32_16x16x32_bf16 v[100:103], a[40:43], v[164:167], v[100:103]
    buffer_load_dwordx4 a[40:43], v1, s[68:71], s21 offen offset:2048
    s_waitcnt vmcnt(24)
    v_mfma_f32_16x16x32_bf16 v[104:107], a[44:47], v[152:155], v[104:107]
    ds_read_b128 v[176:179], v1 offset:41984
    v_mfma_f32_16x16x32_bf16 v[108:111], a[44:47], v[156:159], v[108:111]
    ds_read_b128 v[180:183], v2 offset:5120
    v_mfma_f32_16x16x32_bf16 v[112:115], a[44:47], v[160:163], v[112:115]
    v_pk_max_i16 v196, v196, 0
    v_mfma_f32_16x16x32_bf16 v[116:119], a[44:47], v[164:167], v[116:119]
    buffer_load_dwordx4 a[44:47], v1, s[68:71], s21 offen offset:3072
    s_waitcnt vmcnt(24)
    v_mfma_f32_16x16x32_bf16 v[120:123], a[48:51], v[152:155], v[120:123]
    v_pk_max_i16 v197, v197, 0
    v_mfma_f32_16x16x32_bf16 v[124:127], a[48:51], v[156:159], v[124:127]
    ds_write_b64 v6, v[196:197] offset:36864
    v_mfma_f32_16x16x32_bf16 v[128:131], a[48:51], v[160:163], v[128:131]
    v_cvt_pk_bf16_f32 v198, v36, v37
    v_mfma_f32_16x16x32_bf16 v[132:135], a[48:51], v[164:167], v[132:135]
    s_mov_b32 s21, 135168
    buffer_load_dwordx4 a[48:51], v1, s[68:71], s21 offen offset:0
    s_waitcnt vmcnt(24)
    v_mfma_f32_16x16x32_bf16 v[136:139], a[52:55], v[152:155], v[136:139]
    v_cvt_pk_bf16_f32 v199, v38, v39
    v_mfma_f32_16x16x32_bf16 v[140:143], a[52:55], v[156:159], v[140:143]
    v_pk_max_i16 v198, v198, 0
    v_mfma_f32_16x16x32_bf16 v[144:147], a[52:55], v[160:163], v[144:147]
    v_pk_max_i16 v199, v199, 0
    v_mfma_f32_16x16x32_bf16 v[148:151], a[52:55], v[164:167], v[148:151]
    buffer_load_dwordx4 a[52:55], v1, s[68:71], s21 offen offset:1024
    s_waitcnt lgkmcnt(1)
    s_waitcnt vmcnt(24)
    v_mfma_f32_16x16x32_bf16 v[88:91], a[56:59], v[168:171], v[88:91]
    ds_write_b64 v6, v[198:199] offset:55296
    v_mfma_f32_16x16x32_bf16 v[92:95], a[56:59], v[172:175], v[92:95]
    ds_read_b128 v[152:155], v1 offset:6144
    v_mfma_f32_16x16x32_bf16 v[96:99], a[56:59], v[176:179], v[96:99]
    ds_read_b128 v[156:159], v1 offset:24576
    v_mfma_f32_16x16x32_bf16 v[100:103], a[56:59], v[180:183], v[100:103]
    buffer_load_dwordx4 a[56:59], v1, s[68:71], s21 offen offset:2048
    s_waitcnt vmcnt(24)
    v_mfma_f32_16x16x32_bf16 v[104:107], a[60:63], v[168:171], v[104:107]
    ds_read_b128 v[160:163], v1 offset:43008
    v_mfma_f32_16x16x32_bf16 v[108:111], a[60:63], v[172:175], v[108:111]
    ds_read_b128 v[164:167], v2 offset:6144
    v_mfma_f32_16x16x32_bf16 v[112:115], a[60:63], v[176:179], v[112:115]
    v_cvt_pk_bf16_f32 v184, v40, v41
    v_mfma_f32_16x16x32_bf16 v[116:119], a[60:63], v[180:183], v[116:119]
    buffer_load_dwordx4 a[60:63], v1, s[68:71], s21 offen offset:3072
    s_waitcnt vmcnt(24)
    v_mfma_f32_16x16x32_bf16 v[120:123], a[64:67], v[168:171], v[120:123]
    v_cvt_pk_bf16_f32 v185, v42, v43
    v_mfma_f32_16x16x32_bf16 v[124:127], a[64:67], v[172:175], v[124:127]
    v_pk_max_i16 v184, v184, 0
    v_mfma_f32_16x16x32_bf16 v[128:131], a[64:67], v[176:179], v[128:131]
    v_pk_max_i16 v185, v185, 0
    v_mfma_f32_16x16x32_bf16 v[132:135], a[64:67], v[180:183], v[132:135]
    s_mov_b32 s21, 139264
    buffer_load_dwordx4 a[64:67], v1, s[68:71], s21 offen offset:0
    s_waitcnt vmcnt(24)
    v_mfma_f32_16x16x32_bf16 v[136:139], a[68:71], v[168:171], v[136:139]
    ds_write_b64 v5, v[184:185] offset:1024
    v_mfma_f32_16x16x32_bf16 v[140:143], a[68:71], v[172:175], v[140:143]
    v_cvt_pk_bf16_f32 v186, v44, v45
    v_mfma_f32_16x16x32_bf16 v[144:147], a[68:71], v[176:179], v[144:147]
    v_cvt_pk_bf16_f32 v187, v46, v47
    v_mfma_f32_16x16x32_bf16 v[148:151], a[68:71], v[180:183], v[148:151]
    buffer_load_dwordx4 a[68:71], v1, s[68:71], s21 offen offset:1024
    s_waitcnt lgkmcnt(1)
    s_waitcnt vmcnt(24)
    v_mfma_f32_16x16x32_bf16 v[88:91], a[72:75], v[152:155], v[88:91]
    v_pk_max_i16 v186, v186, 0
    v_mfma_f32_16x16x32_bf16 v[92:95], a[72:75], v[156:159], v[92:95]
    ds_read_b128 v[168:171], v1 offset:7168
    v_mfma_f32_16x16x32_bf16 v[96:99], a[72:75], v[160:163], v[96:99]
    ds_read_b128 v[172:175], v1 offset:25600
    v_mfma_f32_16x16x32_bf16 v[100:103], a[72:75], v[164:167], v[100:103]
    buffer_load_dwordx4 a[72:75], v1, s[68:71], s21 offen offset:2048
    s_waitcnt vmcnt(24)
    v_mfma_f32_16x16x32_bf16 v[104:107], a[76:79], v[152:155], v[104:107]
    ds_read_b128 v[176:179], v1 offset:44032
    v_mfma_f32_16x16x32_bf16 v[108:111], a[76:79], v[156:159], v[108:111]
    ds_read_b128 v[180:183], v2 offset:7168
    v_mfma_f32_16x16x32_bf16 v[112:115], a[76:79], v[160:163], v[112:115]
    v_pk_max_i16 v187, v187, 0
    v_mfma_f32_16x16x32_bf16 v[116:119], a[76:79], v[164:167], v[116:119]
    buffer_load_dwordx4 a[76:79], v1, s[68:71], s21 offen offset:3072
    s_waitcnt vmcnt(24)
    v_mfma_f32_16x16x32_bf16 v[120:123], a[80:83], v[152:155], v[120:123]
    ds_write_b64 v5, v[186:187] offset:19456
    v_mfma_f32_16x16x32_bf16 v[124:127], a[80:83], v[156:159], v[124:127]
    v_cvt_pk_bf16_f32 v188, v48, v49
    v_mfma_f32_16x16x32_bf16 v[128:131], a[80:83], v[160:163], v[128:131]
    v_cvt_pk_bf16_f32 v189, v50, v51
    v_mfma_f32_16x16x32_bf16 v[132:135], a[80:83], v[164:167], v[132:135]
    s_mov_b32 s21, 143360
    buffer_load_dwordx4 a[80:83], v1, s[68:71], s21 offen offset:0
    s_waitcnt vmcnt(24)
    v_mfma_f32_16x16x32_bf16 v[136:139], a[84:87], v[152:155], v[136:139]
    v_pk_max_i16 v188, v188, 0
    v_mfma_f32_16x16x32_bf16 v[140:143], a[84:87], v[156:159], v[140:143]
    v_pk_max_i16 v189, v189, 0
    v_mfma_f32_16x16x32_bf16 v[144:147], a[84:87], v[160:163], v[144:147]
    ds_write_b64 v5, v[188:189] offset:37888
    v_mfma_f32_16x16x32_bf16 v[148:151], a[84:87], v[164:167], v[148:151]
    buffer_load_dwordx4 a[84:87], v1, s[68:71], s21 offen offset:1024
    s_waitcnt lgkmcnt(2)
    s_waitcnt vmcnt(24)
    v_mfma_f32_16x16x32_bf16 v[88:91], a[88:91], v[168:171], v[88:91]
    v_cvt_pk_bf16_f32 v190, v52, v53
    v_mfma_f32_16x16x32_bf16 v[92:95], a[88:91], v[172:175], v[92:95]
    ds_read_b128 v[152:155], v1 offset:8192
    v_mfma_f32_16x16x32_bf16 v[96:99], a[88:91], v[176:179], v[96:99]
    ds_read_b128 v[156:159], v1 offset:26624
    v_mfma_f32_16x16x32_bf16 v[100:103], a[88:91], v[180:183], v[100:103]
    buffer_load_dwordx4 a[88:91], v1, s[68:71], s21 offen offset:2048
    s_waitcnt vmcnt(24)
    v_mfma_f32_16x16x32_bf16 v[104:107], a[92:95], v[168:171], v[104:107]
    ds_read_b128 v[160:163], v1 offset:45056
    v_mfma_f32_16x16x32_bf16 v[108:111], a[92:95], v[172:175], v[108:111]
    ds_read_b128 v[164:167], v2 offset:8192
    v_mfma_f32_16x16x32_bf16 v[112:115], a[92:95], v[176:179], v[112:115]
    v_cvt_pk_bf16_f32 v191, v54, v55
    v_mfma_f32_16x16x32_bf16 v[116:119], a[92:95], v[180:183], v[116:119]
    buffer_load_dwordx4 a[92:95], v1, s[68:71], s21 offen offset:3072
    s_waitcnt vmcnt(24)
    v_mfma_f32_16x16x32_bf16 v[120:123], a[0:3], v[168:171], v[120:123]
    v_pk_max_i16 v190, v190, 0
    v_mfma_f32_16x16x32_bf16 v[124:127], a[0:3], v[172:175], v[124:127]
    v_pk_max_i16 v191, v191, 0
    v_mfma_f32_16x16x32_bf16 v[128:131], a[0:3], v[176:179], v[128:131]
    ds_write_b64 v5, v[190:191] offset:56320
    v_mfma_f32_16x16x32_bf16 v[132:135], a[0:3], v[180:183], v[132:135]
    s_mov_b32 s21, 147456
    buffer_load_dwordx4 a[0:3], v1, s[68:71], s21 offen offset:0
    s_waitcnt vmcnt(24)
    v_mfma_f32_16x16x32_bf16 v[136:139], a[4:7], v[168:171], v[136:139]
    v_cvt_pk_bf16_f32 v192, v56, v57
    v_mfma_f32_16x16x32_bf16 v[140:143], a[4:7], v[172:175], v[140:143]
    v_cvt_pk_bf16_f32 v193, v58, v59
    v_mfma_f32_16x16x32_bf16 v[144:147], a[4:7], v[176:179], v[144:147]
    v_pk_max_i16 v192, v192, 0
    v_mfma_f32_16x16x32_bf16 v[148:151], a[4:7], v[180:183], v[148:151]
    buffer_load_dwordx4 a[4:7], v1, s[68:71], s21 offen offset:1024
    s_waitcnt lgkmcnt(1)
    s_waitcnt vmcnt(24)
    v_mfma_f32_16x16x32_bf16 v[88:91], a[8:11], v[152:155], v[88:91]
    v_pk_max_i16 v193, v193, 0
    v_mfma_f32_16x16x32_bf16 v[92:95], a[8:11], v[156:159], v[92:95]
    ds_read_b128 v[168:171], v1 offset:9216
    v_mfma_f32_16x16x32_bf16 v[96:99], a[8:11], v[160:163], v[96:99]
    ds_read_b128 v[172:175], v1 offset:27648
    v_mfma_f32_16x16x32_bf16 v[100:103], a[8:11], v[164:167], v[100:103]
    buffer_load_dwordx4 a[8:11], v1, s[68:71], s21 offen offset:2048
    s_waitcnt vmcnt(24)
    v_mfma_f32_16x16x32_bf16 v[104:107], a[12:15], v[152:155], v[104:107]
    ds_read_b128 v[176:179], v1 offset:46080
    v_mfma_f32_16x16x32_bf16 v[108:111], a[12:15], v[156:159], v[108:111]
    ds_read_b128 v[180:183], v2 offset:9216
    v_mfma_f32_16x16x32_bf16 v[112:115], a[12:15], v[160:163], v[112:115]
    ds_write_b64 v6, v[192:193] offset:1024
    v_mfma_f32_16x16x32_bf16 v[116:119], a[12:15], v[164:167], v[116:119]
    buffer_load_dwordx4 a[12:15], v1, s[68:71], s21 offen offset:3072
    s_waitcnt vmcnt(23)
    v_mfma_f32_16x16x32_bf16 v[120:123], a[16:19], v[152:155], v[120:123]
    v_cvt_pk_bf16_f32 v194, v60, v61
    v_mfma_f32_16x16x32_bf16 v[124:127], a[16:19], v[156:159], v[124:127]
    v_cvt_pk_bf16_f32 v195, v62, v63
    v_mfma_f32_16x16x32_bf16 v[128:131], a[16:19], v[160:163], v[128:131]
    v_pk_max_i16 v194, v194, 0
    v_mfma_f32_16x16x32_bf16 v[132:135], a[16:19], v[164:167], v[132:135]
    s_mov_b32 s21, 151552
    buffer_load_dwordx4 a[16:19], v1, s[68:71], s21 offen offset:0
    s_waitcnt vmcnt(23)
    v_mfma_f32_16x16x32_bf16 v[136:139], a[20:23], v[152:155], v[136:139]
    v_pk_max_i16 v195, v195, 0
    v_mfma_f32_16x16x32_bf16 v[140:143], a[20:23], v[156:159], v[140:143]
    ds_write_b64 v6, v[194:195] offset:19456
    v_mfma_f32_16x16x32_bf16 v[144:147], a[20:23], v[160:163], v[144:147]
    v_cvt_pk_bf16_f32 v196, v64, v65
    v_mfma_f32_16x16x32_bf16 v[148:151], a[20:23], v[164:167], v[148:151]
    buffer_load_dwordx4 a[20:23], v1, s[68:71], s21 offen offset:1024
    s_waitcnt lgkmcnt(2)
    s_waitcnt vmcnt(23)
    v_mfma_f32_16x16x32_bf16 v[88:91], a[24:27], v[168:171], v[88:91]
    v_cvt_pk_bf16_f32 v197, v66, v67
    v_mfma_f32_16x16x32_bf16 v[92:95], a[24:27], v[172:175], v[92:95]
    ds_read_b128 v[152:155], v1 offset:10240
    v_mfma_f32_16x16x32_bf16 v[96:99], a[24:27], v[176:179], v[96:99]
    ds_read_b128 v[156:159], v1 offset:28672
    v_mfma_f32_16x16x32_bf16 v[100:103], a[24:27], v[180:183], v[100:103]
    buffer_load_dwordx4 a[24:27], v1, s[68:71], s21 offen offset:2048
    s_waitcnt vmcnt(23)
    v_mfma_f32_16x16x32_bf16 v[104:107], a[28:31], v[168:171], v[104:107]
    ds_read_b128 v[160:163], v1 offset:47104
    v_mfma_f32_16x16x32_bf16 v[108:111], a[28:31], v[172:175], v[108:111]
    ds_read_b128 v[164:167], v2 offset:10240
    v_mfma_f32_16x16x32_bf16 v[112:115], a[28:31], v[176:179], v[112:115]
    v_pk_max_i16 v196, v196, 0
    v_mfma_f32_16x16x32_bf16 v[116:119], a[28:31], v[180:183], v[116:119]
    buffer_load_dwordx4 a[28:31], v1, s[68:71], s21 offen offset:3072
    s_waitcnt vmcnt(23)
    v_mfma_f32_16x16x32_bf16 v[120:123], a[32:35], v[168:171], v[120:123]
    v_pk_max_i16 v197, v197, 0
    v_mfma_f32_16x16x32_bf16 v[124:127], a[32:35], v[172:175], v[124:127]
    ds_write_b64 v6, v[196:197] offset:37888
    v_mfma_f32_16x16x32_bf16 v[128:131], a[32:35], v[176:179], v[128:131]
    v_cvt_pk_bf16_f32 v198, v68, v69
    v_mfma_f32_16x16x32_bf16 v[132:135], a[32:35], v[180:183], v[132:135]
    s_mov_b32 s21, 155648
    buffer_load_dwordx4 a[32:35], v1, s[68:71], s21 offen offset:0
    s_waitcnt vmcnt(23)
    v_mfma_f32_16x16x32_bf16 v[136:139], a[36:39], v[168:171], v[136:139]
    v_cvt_pk_bf16_f32 v199, v70, v71
    v_mfma_f32_16x16x32_bf16 v[140:143], a[36:39], v[172:175], v[140:143]
    v_pk_max_i16 v198, v198, 0
    v_mfma_f32_16x16x32_bf16 v[144:147], a[36:39], v[176:179], v[144:147]
    v_pk_max_i16 v199, v199, 0
    v_mfma_f32_16x16x32_bf16 v[148:151], a[36:39], v[180:183], v[148:151]
    buffer_load_dwordx4 a[36:39], v1, s[68:71], s21 offen offset:1024
    s_waitcnt lgkmcnt(1)
    s_waitcnt vmcnt(23)
    v_mfma_f32_16x16x32_bf16 v[88:91], a[40:43], v[152:155], v[88:91]
    ds_write_b64 v6, v[198:199] offset:56320
    v_mfma_f32_16x16x32_bf16 v[92:95], a[40:43], v[156:159], v[92:95]
    ds_read_b128 v[168:171], v1 offset:11264
    v_mfma_f32_16x16x32_bf16 v[96:99], a[40:43], v[160:163], v[96:99]
    ds_read_b128 v[172:175], v1 offset:29696
    v_mfma_f32_16x16x32_bf16 v[100:103], a[40:43], v[164:167], v[100:103]
    buffer_load_dwordx4 a[40:43], v1, s[68:71], s21 offen offset:2048
    s_waitcnt vmcnt(23)
    v_mfma_f32_16x16x32_bf16 v[104:107], a[44:47], v[152:155], v[104:107]
    ds_read_b128 v[176:179], v1 offset:48128
    v_mfma_f32_16x16x32_bf16 v[108:111], a[44:47], v[156:159], v[108:111]
    ds_read_b128 v[180:183], v2 offset:11264
    v_mfma_f32_16x16x32_bf16 v[112:115], a[44:47], v[160:163], v[112:115]
    v_cvt_pk_bf16_f32 v184, v72, v73
    v_mfma_f32_16x16x32_bf16 v[116:119], a[44:47], v[164:167], v[116:119]
    buffer_load_dwordx4 a[44:47], v1, s[68:71], s21 offen offset:3072
    s_waitcnt vmcnt(23)
    v_mfma_f32_16x16x32_bf16 v[120:123], a[48:51], v[152:155], v[120:123]
    v_cvt_pk_bf16_f32 v185, v74, v75
    v_mfma_f32_16x16x32_bf16 v[124:127], a[48:51], v[156:159], v[124:127]
    v_pk_max_i16 v184, v184, 0
    v_mfma_f32_16x16x32_bf16 v[128:131], a[48:51], v[160:163], v[128:131]
    v_pk_max_i16 v185, v185, 0
    v_mfma_f32_16x16x32_bf16 v[132:135], a[48:51], v[164:167], v[132:135]
    s_mov_b32 s21, 159744
    buffer_load_dwordx4 a[48:51], v1, s[68:71], s21 offen offset:0
    s_waitcnt vmcnt(23)
    v_mfma_f32_16x16x32_bf16 v[136:139], a[52:55], v[152:155], v[136:139]
    ds_write_b64 v5, v[184:185] offset:2048
    v_mfma_f32_16x16x32_bf16 v[140:143], a[52:55], v[156:159], v[140:143]
    v_cvt_pk_bf16_f32 v186, v76, v77
    v_mfma_f32_16x16x32_bf16 v[144:147], a[52:55], v[160:163], v[144:147]
    v_cvt_pk_bf16_f32 v187, v78, v79
    v_mfma_f32_16x16x32_bf16 v[148:151], a[52:55], v[164:167], v[148:151]
    buffer_load_dwordx4 a[52:55], v1, s[68:71], s21 offen offset:1024
    s_waitcnt lgkmcnt(1)
    s_waitcnt vmcnt(23)
    v_mfma_f32_16x16x32_bf16 v[88:91], a[56:59], v[168:171], v[88:91]
    v_pk_max_i16 v186, v186, 0
    v_mfma_f32_16x16x32_bf16 v[92:95], a[56:59], v[172:175], v[92:95]
    ds_read_b128 v[152:155], v1 offset:12288
    v_mfma_f32_16x16x32_bf16 v[96:99], a[56:59], v[176:179], v[96:99]
    ds_read_b128 v[156:159], v1 offset:30720
    v_mfma_f32_16x16x32_bf16 v[100:103], a[56:59], v[180:183], v[100:103]
    buffer_load_dwordx4 a[56:59], v1, s[68:71], s21 offen offset:2048
    s_waitcnt vmcnt(23)
    v_mfma_f32_16x16x32_bf16 v[104:107], a[60:63], v[168:171], v[104:107]
    ds_read_b128 v[160:163], v1 offset:49152
    v_mfma_f32_16x16x32_bf16 v[108:111], a[60:63], v[172:175], v[108:111]
    ds_read_b128 v[164:167], v2 offset:12288
    v_mfma_f32_16x16x32_bf16 v[112:115], a[60:63], v[176:179], v[112:115]
    v_pk_max_i16 v187, v187, 0
    v_mfma_f32_16x16x32_bf16 v[116:119], a[60:63], v[180:183], v[116:119]
    buffer_load_dwordx4 a[60:63], v1, s[68:71], s21 offen offset:3072
    s_waitcnt vmcnt(23)
    v_mfma_f32_16x16x32_bf16 v[120:123], a[64:67], v[168:171], v[120:123]
    ds_write_b64 v5, v[186:187] offset:20480
    v_mfma_f32_16x16x32_bf16 v[124:127], a[64:67], v[172:175], v[124:127]
    v_cvt_pk_bf16_f32 v188, v80, v81
    v_mfma_f32_16x16x32_bf16 v[128:131], a[64:67], v[176:179], v[128:131]
    v_cvt_pk_bf16_f32 v189, v82, v83
    v_mfma_f32_16x16x32_bf16 v[132:135], a[64:67], v[180:183], v[132:135]
    s_mov_b32 s21, 163840
    buffer_load_dwordx4 a[64:67], v1, s[68:71], s21 offen offset:0
    s_waitcnt vmcnt(23)
    v_mfma_f32_16x16x32_bf16 v[136:139], a[68:71], v[168:171], v[136:139]
    v_pk_max_i16 v188, v188, 0
    v_mfma_f32_16x16x32_bf16 v[140:143], a[68:71], v[172:175], v[140:143]
    v_pk_max_i16 v189, v189, 0
    v_mfma_f32_16x16x32_bf16 v[144:147], a[68:71], v[176:179], v[144:147]
    ds_write_b64 v5, v[188:189] offset:38912
    v_mfma_f32_16x16x32_bf16 v[148:151], a[68:71], v[180:183], v[148:151]
    buffer_load_dwordx4 a[68:71], v1, s[68:71], s21 offen offset:1024
    s_waitcnt lgkmcnt(2)
    s_waitcnt vmcnt(23)
    v_mfma_f32_16x16x32_bf16 v[88:91], a[72:75], v[152:155], v[88:91]
    v_cvt_pk_bf16_f32 v190, v84, v85
    v_mfma_f32_16x16x32_bf16 v[92:95], a[72:75], v[156:159], v[92:95]
    ds_read_b128 v[168:171], v1 offset:13312
    v_mfma_f32_16x16x32_bf16 v[96:99], a[72:75], v[160:163], v[96:99]
    ds_read_b128 v[172:175], v1 offset:31744
    v_mfma_f32_16x16x32_bf16 v[100:103], a[72:75], v[164:167], v[100:103]
    s_mov_b64 exec, 0xfff
sf_kernel_wp:
    v_cmp_ne_u32 vcc, 1, v229
    s_sub_u32 s41, s41, 1
    s_cbranch_scc1 sf_kernel_wd
    s_cmp_eq_u64 vcc, 0
    s_cbranch_scc1 sf_kernel_wd
    s_sleep 2
    buffer_load_dword v229, v228, s[44:47], 0 offen offset:4032 sc0 sc1
    s_waitcnt vmcnt(0)
    s_branch sf_kernel_wp
sf_kernel_wd:
    s_mov_b64 exec, -1
    buffer_load_dwordx4 a[72:75], v1, s[68:71], s21 offen offset:2048
    s_waitcnt vmcnt(23)
    v_mfma_f32_16x16x32_bf16 v[104:107], a[76:79], v[152:155], v[104:107]
    ds_read_b128 v[176:179], v1 offset:50176
    v_mfma_f32_16x16x32_bf16 v[108:111], a[76:79], v[156:159], v[108:111]
    ds_read_b128 v[180:183], v2 offset:13312
    v_mfma_f32_16x16x32_bf16 v[112:115], a[76:79], v[160:163], v[112:115]
    v_cvt_pk_bf16_f32 v191, v86, v87
    v_mfma_f32_16x16x32_bf16 v[116:119], a[76:79], v[164:167], v[116:119]
    buffer_load_dwordx4 a[76:79], v1, s[68:71], s21 offen offset:3072
    s_waitcnt vmcnt(23)
    v_mfma_f32_16x16x32_bf16 v[120:123], a[80:83], v[152:155], v[120:123]
    v_pk_max_i16 v190, v190, 0
    v_mfma_f32_16x16x32_bf16 v[124:127], a[80:83], v[156:159], v[124:127]
    v_pk_max_i16 v191, v191, 0
    v_mfma_f32_16x16x32_bf16 v[128:131], a[80:83], v[160:163], v[128:131]
    ds_write_b64 v5, v[190:191] offset:57344
    v_mfma_f32_16x16x32_bf16 v[132:135], a[80:83], v[164:167], v[132:135]
    s_mov_b32 s21, 167936
    buffer_load_dwordx4 a[80:83], v1, s[68:71], s21 offen offset:0
    s_waitcnt vmcnt(23)
    v_mfma_f32_16x16x32_bf16 v[136:139], a[84:87], v[152:155], v[136:139]
    v_mfma_f32_16x16x32_bf16 v[140:143], a[84:87], v[156:159], v[140:143]
    v_mfma_f32_16x16x32_bf16 v[144:147], a[84:87], v[160:163], v[144:147]
    v_mfma_f32_16x16x32_bf16 v[148:151], a[84:87], v[164:167], v[148:151]
    buffer_load_dwordx4 a[84:87], v1, s[68:71], s21 offen offset:1024
    s_waitcnt lgkmcnt(1)
    s_waitcnt vmcnt(23)
    v_mfma_f32_16x16x32_bf16 v[88:91], a[88:91], v[168:171], v[88:91]
    v_mfma_f32_16x16x32_bf16 v[92:95], a[88:91], v[172:175], v[92:95]
    ds_read_b128 v[152:155], v1 offset:14336
    v_mfma_f32_16x16x32_bf16 v[96:99], a[88:91], v[176:179], v[96:99]
    ds_read_b128 v[156:159], v1 offset:32768
    v_mfma_f32_16x16x32_bf16 v[100:103], a[88:91], v[180:183], v[100:103]
    buffer_load_dwordx4 a[88:91], v1, s[68:71], s21 offen offset:2048
    s_waitcnt vmcnt(23)
    v_mfma_f32_16x16x32_bf16 v[104:107], a[92:95], v[168:171], v[104:107]
    ds_read_b128 v[160:163], v1 offset:51200
    v_mfma_f32_16x16x32_bf16 v[108:111], a[92:95], v[172:175], v[108:111]
    ds_read_b128 v[164:167], v2 offset:14336
    v_mfma_f32_16x16x32_bf16 v[112:115], a[92:95], v[176:179], v[112:115]
    v_mfma_f32_16x16x32_bf16 v[116:119], a[92:95], v[180:183], v[116:119]
    buffer_load_dwordx4 a[92:95], v1, s[68:71], s21 offen offset:3072
    s_waitcnt vmcnt(23)
    v_mfma_f32_16x16x32_bf16 v[120:123], a[0:3], v[168:171], v[120:123]
    v_mfma_f32_16x16x32_bf16 v[124:127], a[0:3], v[172:175], v[124:127]
    v_mfma_f32_16x16x32_bf16 v[128:131], a[0:3], v[176:179], v[128:131]
    v_mfma_f32_16x16x32_bf16 v[132:135], a[0:3], v[180:183], v[132:135]
    s_mov_b32 s21, 172032
    buffer_load_dwordx4 a[0:3], v1, s[68:71], s21 offen offset:0
    s_waitcnt vmcnt(23)
    v_mfma_f32_16x16x32_bf16 v[136:139], a[4:7], v[168:171], v[136:139]
    v_mfma_f32_16x16x32_bf16 v[140:143], a[4:7], v[172:175], v[140:143]
    v_mfma_f32_16x16x32_bf16 v[144:147], a[4:7], v[176:179], v[144:147]
    v_mfma_f32_16x16x32_bf16 v[148:151], a[4:7], v[180:183], v[148:151]
    buffer_load_dwordx4 a[4:7], v1, s[68:71], s21 offen offset:1024
    s_waitcnt lgkmcnt(0)
    s_waitcnt vmcnt(23)
    v_mfma_f32_16x16x32_bf16 v[88:91], a[8:11], v[152:155], v[88:91]
    v_mfma_f32_16x16x32_bf16 v[92:95], a[8:11], v[156:159], v[92:95]
    ds_read_b128 v[168:171], v1 offset:15360
    v_mfma_f32_16x16x32_bf16 v[96:99], a[8:11], v[160:163], v[96:99]
    ds_read_b128 v[172:175], v1 offset:33792
    v_mfma_f32_16x16x32_bf16 v[100:103], a[8:11], v[164:167], v[100:103]
    buffer_load_dwordx4 a[8:11], v1, s[68:71], s21 offen offset:2048
    s_waitcnt vmcnt(23)
    v_mfma_f32_16x16x32_bf16 v[104:107], a[12:15], v[152:155], v[104:107]
    ds_read_b128 v[176:179], v1 offset:52224
    v_mfma_f32_16x16x32_bf16 v[108:111], a[12:15], v[156:159], v[108:111]
    ds_read_b128 v[180:183], v2 offset:15360
    v_mfma_f32_16x16x32_bf16 v[112:115], a[12:15], v[160:163], v[112:115]
    v_mfma_f32_16x16x32_bf16 v[116:119], a[12:15], v[164:167], v[116:119]
    buffer_load_dwordx4 a[12:15], v1, s[68:71], s21 offen offset:3072
    s_waitcnt vmcnt(23)
    v_mfma_f32_16x16x32_bf16 v[120:123], a[16:19], v[152:155], v[120:123]
    v_mfma_f32_16x16x32_bf16 v[124:127], a[16:19], v[156:159], v[124:127]
    v_mfma_f32_16x16x32_bf16 v[128:131], a[16:19], v[160:163], v[128:131]
    v_mfma_f32_16x16x32_bf16 v[132:135], a[16:19], v[164:167], v[132:135]
    s_mov_b32 s21, 176128
    buffer_load_dwordx4 a[16:19], v1, s[68:71], s21 offen offset:0
    s_waitcnt vmcnt(23)
    v_mfma_f32_16x16x32_bf16 v[136:139], a[20:23], v[152:155], v[136:139]
    v_mfma_f32_16x16x32_bf16 v[140:143], a[20:23], v[156:159], v[140:143]
    v_mfma_f32_16x16x32_bf16 v[144:147], a[20:23], v[160:163], v[144:147]
    v_mfma_f32_16x16x32_bf16 v[148:151], a[20:23], v[164:167], v[148:151]
    buffer_load_dwordx4 a[20:23], v1, s[68:71], s21 offen offset:1024
    s_waitcnt lgkmcnt(0)
    s_waitcnt vmcnt(23)
    v_mfma_f32_16x16x32_bf16 v[88:91], a[24:27], v[168:171], v[88:91]
    v_mfma_f32_16x16x32_bf16 v[92:95], a[24:27], v[172:175], v[92:95]
    ds_read_b128 v[152:155], v1 offset:16384
    v_mfma_f32_16x16x32_bf16 v[96:99], a[24:27], v[176:179], v[96:99]
    ds_read_b128 v[156:159], v1 offset:34816
    v_mfma_f32_16x16x32_bf16 v[100:103], a[24:27], v[180:183], v[100:103]
    buffer_load_dwordx4 a[24:27], v1, s[68:71], s21 offen offset:2048
    s_waitcnt vmcnt(23)
    v_mfma_f32_16x16x32_bf16 v[104:107], a[28:31], v[168:171], v[104:107]
    ds_read_b128 v[160:163], v1 offset:53248
    v_mfma_f32_16x16x32_bf16 v[108:111], a[28:31], v[172:175], v[108:111]
    ds_read_b128 v[164:167], v2 offset:16384
    v_mfma_f32_16x16x32_bf16 v[112:115], a[28:31], v[176:179], v[112:115]
    v_mfma_f32_16x16x32_bf16 v[116:119], a[28:31], v[180:183], v[116:119]
    buffer_load_dwordx4 a[28:31], v1, s[68:71], s21 offen offset:3072
    s_waitcnt vmcnt(23)
    v_mfma_f32_16x16x32_bf16 v[120:123], a[32:35], v[168:171], v[120:123]
    v_mfma_f32_16x16x32_bf16 v[124:127], a[32:35], v[172:175], v[124:127]
    v_mfma_f32_16x16x32_bf16 v[128:131], a[32:35], v[176:179], v[128:131]
    v_mfma_f32_16x16x32_bf16 v[132:135], a[32:35], v[180:183], v[132:135]
    s_mov_b32 s21, 180224
    buffer_load_dwordx4 a[32:35], v1, s[68:71], s21 offen offset:0
    s_waitcnt vmcnt(23)
    v_mfma_f32_16x16x32_bf16 v[136:139], a[36:39], v[168:171], v[136:139]
    v_mfma_f32_16x16x32_bf16 v[140:143], a[36:39], v[172:175], v[140:143]
    v_mfma_f32_16x16x32_bf16 v[144:147], a[36:39], v[176:179], v[144:147]
    v_mfma_f32_16x16x32_bf16 v[148:151], a[36:39], v[180:183], v[148:151]
    buffer_load_dwordx4 a[36:39], v1, s[68:71], s21 offen offset:1024
    s_waitcnt lgkmcnt(0)
    s_waitcnt vmcnt(23)
    v_mfma_f32_16x16x32_bf16 v[88:91], a[40:43], v[152:155], v[88:91]
    v_mfma_f32_16x16x32_bf16 v[92:95], a[40:43], v[156:159], v[92:95]
    ds_read_b128 v[168:171], v1 offset:17408
    v_mfma_f32_16x16x32_bf16 v[96:99], a[40:43], v[160:163], v[96:99]
    ds_read_b128 v[172:175], v1 offset:35840
    v_mfma_f32_16x16x32_bf16 v[100:103], a[40:43], v[164:167], v[100:103]
    buffer_load_dwordx4 a[40:43], v1, s[68:71], s21 offen offset:2048
    s_waitcnt vmcnt(23)
    v_mfma_f32_16x16x32_bf16 v[104:107], a[44:47], v[152:155], v[104:107]
    ds_read_b128 v[176:179], v1 offset:54272
    v_mfma_f32_16x16x32_bf16 v[108:111], a[44:47], v[156:159], v[108:111]
    ds_read_b128 v[180:183], v2 offset:17408
    v_mfma_f32_16x16x32_bf16 v[112:115], a[44:47], v[160:163], v[112:115]
    v_mfma_f32_16x16x32_bf16 v[116:119], a[44:47], v[164:167], v[116:119]
    buffer_load_dwordx4 a[44:47], v1, s[68:71], s21 offen offset:3072
    s_waitcnt vmcnt(23)
    v_mfma_f32_16x16x32_bf16 v[120:123], a[48:51], v[152:155], v[120:123]
    v_mfma_f32_16x16x32_bf16 v[124:127], a[48:51], v[156:159], v[124:127]
    v_mfma_f32_16x16x32_bf16 v[128:131], a[48:51], v[160:163], v[128:131]
    v_mfma_f32_16x16x32_bf16 v[132:135], a[48:51], v[164:167], v[132:135]
    s_mov_b32 s21, 184320
    buffer_load_dwordx4 a[48:51], v1, s[68:71], s21 offen offset:0
    s_waitcnt vmcnt(23)
    v_mfma_f32_16x16x32_bf16 v[136:139], a[52:55], v[152:155], v[136:139]
    v_mfma_f32_16x16x32_bf16 v[140:143], a[52:55], v[156:159], v[140:143]
    v_mfma_f32_16x16x32_bf16 v[144:147], a[52:55], v[160:163], v[144:147]
    v_mfma_f32_16x16x32_bf16 v[148:151], a[52:55], v[164:167], v[148:151]
    buffer_load_dwordx4 a[52:55], v1, s[68:71], s21 offen offset:1024
    s_waitcnt lgkmcnt(0)
    s_barrier
    s_waitcnt lgkmcnt(0)
    s_waitcnt vmcnt(23)
    v_mfma_f32_16x16x32_bf16 v[88:91], a[56:59], v[168:171], v[88:91]
    v_mfma_f32_16x16x32_bf16 v[92:95], a[56:59], v[172:175], v[92:95]
    ds_read_b128 v[152:155], v3 offset:0
    v_mfma_f32_16x16x32_bf16 v[96:99], a[56:59], v[176:179], v[96:99]
    ds_read_b128 v[156:159], v3 offset:18432
    v_mfma_f32_16x16x32_bf16 v[100:103], a[56:59], v[180:183], v[100:103]
    buffer_load_dwordx4 a[56:59], v1, s[68:71], s21 offen offset:2048
    s_waitcnt vmcnt(23)
    v_mfma_f32_16x16x32_bf16 v[104:107], a[60:63], v[168:171], v[104:107]
    ds_read_b128 v[160:163], v3 offset:36864
    v_mfma_f32_16x16x32_bf16 v[108:111], a[60:63], v[172:175], v[108:111]
    ds_read_b128 v[164:167], v4 offset:0
    v_mfma_f32_16x16x32_bf16 v[112:115], a[60:63], v[176:179], v[112:115]
    v_mfma_f32_16x16x32_bf16 v[116:119], a[60:63], v[180:183], v[116:119]
    buffer_load_dwordx4 a[60:63], v1, s[68:71], s21 offen offset:3072
    s_waitcnt vmcnt(23)
    v_mfma_f32_16x16x32_bf16 v[120:123], a[64:67], v[168:171], v[120:123]
    v_mfma_f32_16x16x32_bf16 v[124:127], a[64:67], v[172:175], v[124:127]
    v_mfma_f32_16x16x32_bf16 v[128:131], a[64:67], v[176:179], v[128:131]
    v_mfma_f32_16x16x32_bf16 v[132:135], a[64:67], v[180:183], v[132:135]
    s_mov_b32 s21, 188416
    buffer_load_dwordx4 a[64:67], v1, s[68:71], s21 offen offset:0
    s_waitcnt vmcnt(23)
    v_mfma_f32_16x16x32_bf16 v[136:139], a[68:71], v[168:171], v[136:139]
    v_mfma_f32_16x16x32_bf16 v[140:143], a[68:71], v[172:175], v[140:143]
    v_mfma_f32_16x16x32_bf16 v[144:147], a[68:71], v[176:179], v[144:147]
    v_mfma_f32_16x16x32_bf16 v[148:151], a[68:71], v[180:183], v[148:151]
    buffer_load_dwordx4 a[68:71], v1, s[68:71], s21 offen offset:1024
    s_waitcnt lgkmcnt(0)
    s_waitcnt vmcnt(23)
    v_mfma_f32_16x16x32_bf16 v[8:11], a[72:75], v[152:155], 0
    v_mfma_f32_16x16x32_bf16 v[12:15], a[72:75], v[156:159], 0
    ds_read_b128 v[168:171], v3 offset:1024
    v_mfma_f32_16x16x32_bf16 v[16:19], a[72:75], v[160:163], 0
    ds_read_b128 v[172:175], v3 offset:19456
    v_mfma_f32_16x16x32_bf16 v[20:23], a[72:75], v[164:167], 0
    buffer_load_dwordx4 a[72:75], v1, s[68:71], s21 offen offset:2048
    s_waitcnt vmcnt(23)
    v_mfma_f32_16x16x32_bf16 v[24:27], a[76:79], v[152:155], 0
    ds_read_b128 v[176:179], v3 offset:37888
    v_cvt_pk_bf16_f32 v192, v88, v89
    v_mfma_f32_16x16x32_bf16 v[28:31], a[76:79], v[156:159], 0
    ds_read_b128 v[180:183], v4 offset:1024
    v_cvt_pk_bf16_f32 v193, v90, v91
    v_mfma_f32_16x16x32_bf16 v[32:35], a[76:79], v[160:163], 0
    v_pk_max_i16 v192, v192, 0
    v_pk_max_i16 v193, v193, 0
    v_mfma_f32_16x16x32_bf16 v[36:39], a[76:79], v[164:167], 0
    buffer_load_dwordx4 a[76:79], v1, s[68:71], s21 offen offset:3072
    ds_write_b64 v6, v[192:193] offset:2048
    v_cvt_pk_bf16_f32 v194, v92, v93
    s_waitcnt vmcnt(23)
    v_mfma_f32_16x16x32_bf16 v[40:43], a[80:83], v[152:155], 0
    v_cvt_pk_bf16_f32 v195, v94, v95
    v_pk_max_i16 v194, v194, 0
    v_mfma_f32_16x16x32_bf16 v[44:47], a[80:83], v[156:159], 0
    v_pk_max_i16 v195, v195, 0
    ds_write_b64 v6, v[194:195] offset:20480
    v_mfma_f32_16x16x32_bf16 v[48:51], a[80:83], v[160:163], 0
    v_cvt_pk_bf16_f32 v196, v96, v97
    v_cvt_pk_bf16_f32 v197, v98, v99
    v_mfma_f32_16x16x32_bf16 v[52:55], a[80:83], v[164:167], 0
    s_mov_b32 s21, 192512
    buffer_load_dwordx4 a[80:83], v1, s[68:71], s21 offen offset:0
    v_pk_max_i16 v196, v196, 0
    v_pk_max_i16 v197, v197, 0
    s_waitcnt lgkmcnt(2)
    s_waitcnt vmcnt(23)
    v_mfma_f32_16x16x32_bf16 v[8:11], a[84:87], v[168:171], v[8:11]
    ds_write_b64 v6, v[196:197] offset:38912
    v_cvt_pk_bf16_f32 v198, v100, v101
    v_mfma_f32_16x16x32_bf16 v[12:15], a[84:87], v[172:175], v[12:15]
    ds_read_b128 v[152:155], v3 offset:5120
    v_cvt_pk_bf16_f32 v199, v102, v103
    v_mfma_f32_16x16x32_bf16 v[16:19], a[84:87], v[176:179], v[16:19]
    ds_read_b128 v[156:159], v3 offset:23552
    v_pk_max_i16 v198, v198, 0
    v_mfma_f32_16x16x32_bf16 v[20:23], a[84:87], v[180:183], v[20:23]
    buffer_load_dwordx4 a[84:87], v1, s[68:71], s21 offen offset:1024
    v_pk_max_i16 v199, v199, 0
    ds_write_b64 v6, v[198:199] offset:57344
    s_waitcnt vmcnt(23)
    v_mfma_f32_16x16x32_bf16 v[24:27], a[88:91], v[168:171], v[24:27]
    ds_read_b128 v[160:163], v3 offset:41984
    v_cvt_pk_bf16_f32 v184, v104, v105
    v_mfma_f32_16x16x32_bf16 v[28:31], a[88:91], v[172:175], v[28:31]
    ds_read_b128 v[164:167], v4 offset:5120
    v_cvt_pk_bf16_f32 v185, v106, v107
    v_mfma_f32_16x16x32_bf16 v[32:35], a[88:91], v[176:179], v[32:35]
    v_pk_max_i16 v184, v184, 0
    v_pk_max_i16 v185, v185, 0
    v_mfma_f32_16x16x32_bf16 v[36:39], a[88:91], v[180:183], v[36:39]
    buffer_load_dwordx4 a[88:91], v1, s[68:71], s21 offen offset:2048
    ds_write_b64 v5, v[184:185] offset:3072
    v_cvt_pk_bf16_f32 v186, v108, v109
    s_waitcnt vmcnt(23)
    v_mfma_f32_16x16x32_bf16 v[40:43], a[92:95], v[168:171], v[40:43]
    v_cvt_pk_bf16_f32 v187, v110, v111
    v_pk_max_i16 v186, v186, 0
    v_mfma_f32_16x16x32_bf16 v[44:47], a[92:95], v[172:175], v[44:47]
    v_pk_max_i16 v187, v187, 0
    ds_write_b64 v5, v[186:187] offset:21504
    v_mfma_f32_16x16x32_bf16 v[48:51], a[92:95], v[176:179], v[48:51]
    v_cvt_pk_bf16_f32 v188, v112, v113
    v_cvt_pk_bf16_f32 v189, v114, v115
    v_mfma_f32_16x16x32_bf16 v[52:55], a[92:95], v[180:183], v[52:55]
    buffer_load_dwordx4 a[92:95], v1, s[68:71], s21 offen offset:3072
    v_pk_max_i16 v188, v188, 0
    v_pk_max_i16 v189, v189, 0
    s_waitcnt lgkmcnt(2)
    s_waitcnt vmcnt(23)
    v_mfma_f32_16x16x32_bf16 v[8:11], a[0:3], v[152:155], v[8:11]
    ds_write_b64 v5, v[188:189] offset:39936
    v_cvt_pk_bf16_f32 v190, v116, v117
    v_mfma_f32_16x16x32_bf16 v[12:15], a[0:3], v[156:159], v[12:15]
    ds_read_b128 v[168:171], v3 offset:6144
    v_cvt_pk_bf16_f32 v191, v118, v119
    v_mfma_f32_16x16x32_bf16 v[16:19], a[0:3], v[160:163], v[16:19]
    ds_read_b128 v[172:175], v3 offset:24576
    v_pk_max_i16 v190, v190, 0
    v_mfma_f32_16x16x32_bf16 v[20:23], a[0:3], v[164:167], v[20:23]
    s_mov_b32 s21, 196608
    buffer_load_dwordx4 a[0:3], v1, s[68:71], s21 offen offset:0
    v_pk_max_i16 v191, v191, 0
    ds_write_b64 v5, v[190:191] offset:58368
    s_waitcnt vmcnt(23)
    v_mfma_f32_16x16x32_bf16 v[24:27], a[4:7], v[152:155], v[24:27]
    ds_read_b128 v[176:179], v3 offset:43008
    v_cvt_pk_bf16_f32 v192, v120, v121
    v_mfma_f32_16x16x32_bf16 v[28:31], a[4:7], v[156:159], v[28:31]
    ds_read_b128 v[180:183], v4 offset:6144
    v_cvt_pk_bf16_f32 v193, v122, v123
    v_mfma_f32_16x16x32_bf16 v[32:35], a[4:7], v[160:163], v[32:35]
    v_pk_max_i16 v192, v192, 0
    v_pk_max_i16 v193, v193, 0
    v_mfma_f32_16x16x32_bf16 v[36:39], a[4:7], v[164:167], v[36:39]
    buffer_load_dwordx4 a[4:7], v1, s[68:71], s21 offen offset:1024
    ds_write_b64 v6, v[192:193] offset:3072
    v_cvt_pk_bf16_f32 v194, v124, v125
    s_waitcnt vmcnt(23)
    v_mfma_f32_16x16x32_bf16 v[40:43], a[8:11], v[152:155], v[40:43]
    v_cvt_pk_bf16_f32 v195, v126, v127
    v_pk_max_i16 v194, v194, 0
    v_mfma_f32_16x16x32_bf16 v[44:47], a[8:11], v[156:159], v[44:47]
    v_pk_max_i16 v195, v195, 0
    ds_write_b64 v6, v[194:195] offset:21504
    v_mfma_f32_16x16x32_bf16 v[48:51], a[8:11], v[160:163], v[48:51]
    v_cvt_pk_bf16_f32 v196, v128, v129
    v_cvt_pk_bf16_f32 v197, v130, v131
    v_mfma_f32_16x16x32_bf16 v[52:55], a[8:11], v[164:167], v[52:55]
    buffer_load_dwordx4 a[8:11], v1, s[68:71], s21 offen offset:2048
    v_pk_max_i16 v196, v196, 0
    v_pk_max_i16 v197, v197, 0
    s_waitcnt lgkmcnt(2)
    s_waitcnt vmcnt(23)
    v_mfma_f32_16x16x32_bf16 v[8:11], a[12:15], v[168:171], v[8:11]
    ds_write_b64 v6, v[196:197] offset:39936
    v_cvt_pk_bf16_f32 v198, v132, v133
    v_mfma_f32_16x16x32_bf16 v[12:15], a[12:15], v[172:175], v[12:15]
    ds_read_b128 v[152:155], v3 offset:9216
    v_cvt_pk_bf16_f32 v199, v134, v135
    v_mfma_f32_16x16x32_bf16 v[16:19], a[12:15], v[176:179], v[16:19]
    ds_read_b128 v[156:159], v3 offset:27648
    v_pk_max_i16 v198, v198, 0
    v_mfma_f32_16x16x32_bf16 v[20:23], a[12:15], v[180:183], v[20:23]
    buffer_load_dwordx4 a[12:15], v1, s[68:71], s21 offen offset:3072
    v_pk_max_i16 v199, v199, 0
    ds_write_b64 v6, v[198:199] offset:58368
    s_waitcnt vmcnt(23)
    v_mfma_f32_16x16x32_bf16 v[24:27], a[16:19], v[168:171], v[24:27]
    ds_read_b128 v[160:163], v3 offset:46080
    v_cvt_pk_bf16_f32 v184, v136, v137
    v_mfma_f32_16x16x32_bf16 v[28:31], a[16:19], v[172:175], v[28:31]
    ds_read_b128 v[164:167], v4 offset:9216
    v_cvt_pk_bf16_f32 v185, v138, v139
    v_mfma_f32_16x16x32_bf16 v[32:35], a[16:19], v[176:179], v[32:35]
    v_pk_max_i16 v184, v184, 0
    v_pk_max_i16 v185, v185, 0
    v_mfma_f32_16x16x32_bf16 v[36:39], a[16:19], v[180:183], v[36:39]
    s_mov_b32 s21, 200704
    buffer_load_dwordx4 a[16:19], v1, s[68:71], s21 offen offset:0
    ds_write_b64 v5, v[184:185] offset:4096
    v_cvt_pk_bf16_f32 v186, v140, v141
    s_waitcnt vmcnt(23)
    v_mfma_f32_16x16x32_bf16 v[40:43], a[20:23], v[168:171], v[40:43]
    v_cvt_pk_bf16_f32 v187, v142, v143
    v_pk_max_i16 v186, v186, 0
    v_mfma_f32_16x16x32_bf16 v[44:47], a[20:23], v[172:175], v[44:47]
    v_pk_max_i16 v187, v187, 0
    ds_write_b64 v5, v[186:187] offset:22528
    v_mfma_f32_16x16x32_bf16 v[48:51], a[20:23], v[176:179], v[48:51]
    v_cvt_pk_bf16_f32 v188, v144, v145
    v_cvt_pk_bf16_f32 v189, v146, v147
    v_mfma_f32_16x16x32_bf16 v[52:55], a[20:23], v[180:183], v[52:55]
    buffer_load_dwordx4 a[20:23], v1, s[68:71], s21 offen offset:1024
    v_pk_max_i16 v188, v188, 0
    v_pk_max_i16 v189, v189, 0
    s_waitcnt lgkmcnt(2)
    s_waitcnt vmcnt(23)
    v_mfma_f32_16x16x32_bf16 v[8:11], a[24:27], v[152:155], v[8:11]
    ds_write_b64 v5, v[188:189] offset:40960
    v_cvt_pk_bf16_f32 v190, v148, v149
    v_mfma_f32_16x16x32_bf16 v[12:15], a[24:27], v[156:159], v[12:15]
    ds_read_b128 v[168:171], v3 offset:10240
    v_cvt_pk_bf16_f32 v191, v150, v151
    v_mfma_f32_16x16x32_bf16 v[16:19], a[24:27], v[160:163], v[16:19]
    ds_read_b128 v[172:175], v3 offset:28672
    v_pk_max_i16 v190, v190, 0
    v_mfma_f32_16x16x32_bf16 v[20:23], a[24:27], v[164:167], v[20:23]
    buffer_load_dwordx4 a[24:27], v1, s[68:71], s21 offen offset:2048
    v_pk_max_i16 v191, v191, 0
    ds_write_b64 v5, v[190:191] offset:59392
    s_waitcnt vmcnt(23)
    v_mfma_f32_16x16x32_bf16 v[24:27], a[28:31], v[152:155], v[24:27]
    ds_read_b128 v[176:179], v3 offset:47104
    v_mfma_f32_16x16x32_bf16 v[28:31], a[28:31], v[156:159], v[28:31]
    ds_read_b128 v[180:183], v4 offset:10240
    v_mfma_f32_16x16x32_bf16 v[32:35], a[28:31], v[160:163], v[32:35]
    v_mfma_f32_16x16x32_bf16 v[36:39], a[28:31], v[164:167], v[36:39]
    buffer_load_dwordx4 a[28:31], v1, s[68:71], s21 offen offset:3072
    s_waitcnt vmcnt(23)
    v_mfma_f32_16x16x32_bf16 v[40:43], a[32:35], v[152:155], v[40:43]
    v_mfma_f32_16x16x32_bf16 v[44:47], a[32:35], v[156:159], v[44:47]
    v_mfma_f32_16x16x32_bf16 v[48:51], a[32:35], v[160:163], v[48:51]
    v_mfma_f32_16x16x32_bf16 v[52:55], a[32:35], v[164:167], v[52:55]
    s_mov_b32 s21, 204800
    buffer_load_dwordx4 a[32:35], v1, s[68:71], s21 offen offset:0
    s_waitcnt lgkmcnt(0)
    s_waitcnt vmcnt(23)
    v_mfma_f32_16x16x32_bf16 v[8:11], a[36:39], v[168:171], v[8:11]
    v_mfma_f32_16x16x32_bf16 v[12:15], a[36:39], v[172:175], v[12:15]
    ds_read_b128 v[152:155], v3 offset:14336
    v_mfma_f32_16x16x32_bf16 v[16:19], a[36:39], v[176:179], v[16:19]
    ds_read_b128 v[156:159], v3 offset:32768
    v_mfma_f32_16x16x32_bf16 v[20:23], a[36:39], v[180:183], v[20:23]
    buffer_load_dwordx4 a[36:39], v1, s[68:71], s21 offen offset:1024
    s_waitcnt vmcnt(23)
    v_mfma_f32_16x16x32_bf16 v[24:27], a[40:43], v[168:171], v[24:27]
    ds_read_b128 v[160:163], v3 offset:51200
    v_mfma_f32_16x16x32_bf16 v[28:31], a[40:43], v[172:175], v[28:31]
    ds_read_b128 v[164:167], v4 offset:14336
    v_mfma_f32_16x16x32_bf16 v[32:35], a[40:43], v[176:179], v[32:35]
    v_mfma_f32_16x16x32_bf16 v[36:39], a[40:43], v[180:183], v[36:39]
    buffer_load_dwordx4 a[40:43], v1, s[68:71], s21 offen offset:2048
    s_waitcnt vmcnt(23)
    v_mfma_f32_16x16x32_bf16 v[40:43], a[44:47], v[168:171], v[40:43]
    v_mfma_f32_16x16x32_bf16 v[44:47], a[44:47], v[172:175], v[44:47]
    v_mfma_f32_16x16x32_bf16 v[48:51], a[44:47], v[176:179], v[48:51]
    v_mfma_f32_16x16x32_bf16 v[52:55], a[44:47], v[180:183], v[52:55]
    buffer_load_dwordx4 a[44:47], v1, s[68:71], s21 offen offset:3072
    s_waitcnt lgkmcnt(0)
    s_waitcnt vmcnt(23)
    v_mfma_f32_16x16x32_bf16 v[8:11], a[48:51], v[152:155], v[8:11]
    v_mfma_f32_16x16x32_bf16 v[12:15], a[48:51], v[156:159], v[12:15]
    ds_read_b128 v[168:171], v3 offset:15360
    v_mfma_f32_16x16x32_bf16 v[16:19], a[48:51], v[160:163], v[16:19]
    ds_read_b128 v[172:175], v3 offset:33792
    v_mfma_f32_16x16x32_bf16 v[20:23], a[48:51], v[164:167], v[20:23]
    s_mov_b32 s21, 208896
    buffer_load_dwordx4 a[48:51], v1, s[68:71], s21 offen offset:0
    s_waitcnt vmcnt(23)
    v_mfma_f32_16x16x32_bf16 v[24:27], a[52:55], v[152:155], v[24:27]
    ds_read_b128 v[176:179], v3 offset:52224
    v_mfma_f32_16x16x32_bf16 v[28:31], a[52:55], v[156:159], v[28:31]
    ds_read_b128 v[180:183], v4 offset:15360
    v_mfma_f32_16x16x32_bf16 v[32:35], a[52:55], v[160:163], v[32:35]
    v_mfma_f32_16x16x32_bf16 v[36:39], a[52:55], v[164:167], v[36:39]
    buffer_load_dwordx4 a[52:55], v1, s[68:71], s21 offen offset:1024
    s_waitcnt vmcnt(23)
    v_mfma_f32_16x16x32_bf16 v[40:43], a[56:59], v[152:155], v[40:43]
    v_mfma_f32_16x16x32_bf16 v[44:47], a[56:59], v[156:159], v[44:47]
    v_mfma_f32_16x16x32_bf16 v[48:51], a[56:59], v[160:163], v[48:51]
    v_mfma_f32_16x16x32_bf16 v[52:55], a[56:59], v[164:167], v[52:55]
    buffer_load_dwordx4 a[56:59], v1, s[68:71], s21 offen offset:2048
    s_waitcnt lgkmcnt(0)
    s_barrier
    s_waitcnt lgkmcnt(0)
    s_waitcnt vmcnt(23)
    v_mfma_f32_16x16x32_bf16 v[8:11], a[60:63], v[168:171], v[8:11]
    v_mfma_f32_16x16x32_bf16 v[12:15], a[60:63], v[172:175], v[12:15]
    ds_read_b128 v[152:155], v3 offset:2048
    v_mfma_f32_16x16x32_bf16 v[16:19], a[60:63], v[176:179], v[16:19]
    ds_read_b128 v[156:159], v3 offset:20480
    v_mfma_f32_16x16x32_bf16 v[20:23], a[60:63], v[180:183], v[20:23]
    buffer_load_dwordx4 a[60:63], v1, s[68:71], s21 offen offset:3072
    s_waitcnt vmcnt(23)
    v_mfma_f32_16x16x32_bf16 v[24:27], a[64:67], v[168:171], v[24:27]
    ds_read_b128 v[160:163], v3 offset:38912
    v_mfma_f32_16x16x32_bf16 v[28:31], a[64:67], v[172:175], v[28:31]
    ds_read_b128 v[164:167], v4 offset:2048
    v_mfma_f32_16x16x32_bf16 v[32:35], a[64:67], v[176:179], v[32:35]
    v_mfma_f32_16x16x32_bf16 v[36:39], a[64:67], v[180:183], v[36:39]
    s_mov_b32 s21, 212992
    buffer_load_dwordx4 a[64:67], v1, s[68:71], s21 offen offset:0
    s_waitcnt vmcnt(23)
    v_mfma_f32_16x16x32_bf16 v[40:43], a[68:71], v[168:171], v[40:43]
    v_mfma_f32_16x16x32_bf16 v[44:47], a[68:71], v[172:175], v[44:47]
    v_mfma_f32_16x16x32_bf16 v[48:51], a[68:71], v[176:179], v[48:51]
    v_mfma_f32_16x16x32_bf16 v[52:55], a[68:71], v[180:183], v[52:55]
    buffer_load_dwordx4 a[68:71], v1, s[68:71], s21 offen offset:1024
    s_waitcnt lgkmcnt(0)
    s_waitcnt vmcnt(23)
    v_mfma_f32_16x16x32_bf16 v[8:11], a[72:75], v[152:155], v[8:11]
    v_mfma_f32_16x16x32_bf16 v[12:15], a[72:75], v[156:159], v[12:15]
    ds_read_b128 v[168:171], v3 offset:3072
    v_mfma_f32_16x16x32_bf16 v[16:19], a[72:75], v[160:163], v[16:19]
    ds_read_b128 v[172:175], v3 offset:21504
    v_mfma_f32_16x16x32_bf16 v[20:23], a[72:75], v[164:167], v[20:23]
    buffer_load_dwordx4 a[72:75], v1, s[68:71], s21 offen offset:2048
    s_waitcnt vmcnt(23)
    v_mfma_f32_16x16x32_bf16 v[24:27], a[76:79], v[152:155], v[24:27]
    ds_read_b128 v[176:179], v3 offset:39936
    v_mfma_f32_16x16x32_bf16 v[28:31], a[76:79], v[156:159], v[28:31]
    ds_read_b128 v[180:183], v4 offset:3072
    v_mfma_f32_16x16x32_bf16 v[32:35], a[76:79], v[160:163], v[32:35]
    v_mfma_f32_16x16x32_bf16 v[36:39], a[76:79], v[164:167], v[36:39]
    buffer_load_dwordx4 a[76:79], v1, s[68:71], s21 offen offset:3072
    s_waitcnt vmcnt(23)
    v_mfma_f32_16x16x32_bf16 v[40:43], a[80:83], v[152:155], v[40:43]
    v_mfma_f32_16x16x32_bf16 v[44:47], a[80:83], v[156:159], v[44:47]
    v_mfma_f32_16x16x32_bf16 v[48:51], a[80:83], v[160:163], v[48:51]
    v_mfma_f32_16x16x32_bf16 v[52:55], a[80:83], v[164:167], v[52:55]
    s_mov_b32 s21, 217088
    buffer_load_dwordx4 a[80:83], v1, s[68:71], s21 offen offset:0
    s_waitcnt lgkmcnt(0)
    s_waitcnt vmcnt(23)
    v_mfma_f32_16x16x32_bf16 v[8:11], a[84:87], v[168:171], v[8:11]
    v_mfma_f32_16x16x32_bf16 v[12:15], a[84:87], v[172:175], v[12:15]
    ds_read_b128 v[152:155], v3 offset:4096
    v_mfma_f32_16x16x32_bf16 v[16:19], a[84:87], v[176:179], v[16:19]
    ds_read_b128 v[156:159], v3 offset:22528
    v_mfma_f32_16x16x32_bf16 v[20:23], a[84:87], v[180:183], v[20:23]
    buffer_load_dwordx4 a[84:87], v1, s[68:71], s21 offen offset:1024
    s_waitcnt vmcnt(23)
    v_mfma_f32_16x16x32_bf16 v[24:27], a[88:91], v[168:171], v[24:27]
    ds_read_b128 v[160:163], v3 offset:40960
    v_mfma_f32_16x16x32_bf16 v[28:31], a[88:91], v[172:175], v[28:31]
    ds_read_b128 v[164:167], v4 offset:4096
    v_mfma_f32_16x16x32_bf16 v[32:35], a[88:91], v[176:179], v[32:35]
    v_mfma_f32_16x16x32_bf16 v[36:39], a[88:91], v[180:183], v[36:39]
    buffer_load_dwordx4 a[88:91], v1, s[68:71], s21 offen offset:2048
    s_waitcnt vmcnt(23)
    v_mfma_f32_16x16x32_bf16 v[40:43], a[92:95], v[168:171], v[40:43]
    v_mfma_f32_16x16x32_bf16 v[44:47], a[92:95], v[172:175], v[44:47]
    v_mfma_f32_16x16x32_bf16 v[48:51], a[92:95], v[176:179], v[48:51]
    v_mfma_f32_16x16x32_bf16 v[52:55], a[92:95], v[180:183], v[52:55]
    buffer_load_dwordx4 a[92:95], v1, s[68:71], s21 offen offset:3072
    s_waitcnt lgkmcnt(0)
    s_waitcnt vmcnt(23)
    v_mfma_f32_16x16x32_bf16 v[8:11], a[0:3], v[152:155], v[8:11]
    v_mfma_f32_16x16x32_bf16 v[12:15], a[0:3], v[156:159], v[12:15]
    ds_read_b128 v[168:171], v3 offset:7168
    v_mfma_f32_16x16x32_bf16 v[16:19], a[0:3], v[160:163], v[16:19]
    ds_read_b128 v[172:175], v3 offset:25600
    v_mfma_f32_16x16x32_bf16 v[20:23], a[0:3], v[164:167], v[20:23]
    s_mov_b32 s21, 221184
    buffer_load_dwordx4 a[0:3], v1, s[68:71], s21 offen offset:0
    s_waitcnt vmcnt(23)
    v_mfma_f32_16x16x32_bf16 v[24:27], a[4:7], v[152:155], v[24:27]
    ds_read_b128 v[176:179], v3 offset:44032
    v_mfma_f32_16x16x32_bf16 v[28:31], a[4:7], v[156:159], v[28:31]
    ds_read_b128 v[180:183], v4 offset:7168
    v_mfma_f32_16x16x32_bf16 v[32:35], a[4:7], v[160:163], v[32:35]
    v_mfma_f32_16x16x32_bf16 v[36:39], a[4:7], v[164:167], v[36:39]
    buffer_load_dwordx4 a[4:7], v1, s[68:71], s21 offen offset:1024
    s_waitcnt vmcnt(23)
    v_mfma_f32_16x16x32_bf16 v[40:43], a[8:11], v[152:155], v[40:43]
    v_mfma_f32_16x16x32_bf16 v[44:47], a[8:11], v[156:159], v[44:47]
    v_mfma_f32_16x16x32_bf16 v[48:51], a[8:11], v[160:163], v[48:51]
    v_mfma_f32_16x16x32_bf16 v[52:55], a[8:11], v[164:167], v[52:55]
    buffer_load_dwordx4 a[8:11], v1, s[68:71], s21 offen offset:2048
    s_waitcnt lgkmcnt(0)
    s_waitcnt vmcnt(23)
    v_mfma_f32_16x16x32_bf16 v[8:11], a[12:15], v[168:171], v[8:11]
    v_mfma_f32_16x16x32_bf16 v[12:15], a[12:15], v[172:175], v[12:15]
    ds_read_b128 v[152:155], v3 offset:8192
    v_mfma_f32_16x16x32_bf16 v[16:19], a[12:15], v[176:179], v[16:19]
    ds_read_b128 v[156:159], v3 offset:26624
    v_mfma_f32_16x16x32_bf16 v[20:23], a[12:15], v[180:183], v[20:23]
    buffer_load_dwordx4 a[12:15], v1, s[68:71], s21 offen offset:3072
    s_waitcnt vmcnt(23)
    v_mfma_f32_16x16x32_bf16 v[24:27], a[16:19], v[168:171], v[24:27]
    ds_read_b128 v[160:163], v3 offset:45056
    v_mfma_f32_16x16x32_bf16 v[28:31], a[16:19], v[172:175], v[28:31]
    ds_read_b128 v[164:167], v4 offset:8192
    v_mfma_f32_16x16x32_bf16 v[32:35], a[16:19], v[176:179], v[32:35]
    v_mfma_f32_16x16x32_bf16 v[36:39], a[16:19], v[180:183], v[36:39]
    s_mov_b32 s21, 225280
    buffer_load_dwordx4 a[16:19], v1, s[68:71], s21 offen offset:0
    s_waitcnt vmcnt(23)
    v_mfma_f32_16x16x32_bf16 v[40:43], a[20:23], v[168:171], v[40:43]
    v_mfma_f32_16x16x32_bf16 v[44:47], a[20:23], v[172:175], v[44:47]
    v_mfma_f32_16x16x32_bf16 v[48:51], a[20:23], v[176:179], v[48:51]
    v_mfma_f32_16x16x32_bf16 v[52:55], a[20:23], v[180:183], v[52:55]
    buffer_load_dwordx4 a[20:23], v1, s[68:71], s21 offen offset:1024
    s_waitcnt lgkmcnt(0)
    s_waitcnt vmcnt(23)
    v_mfma_f32_16x16x32_bf16 v[8:11], a[24:27], v[152:155], v[8:11]
    v_mfma_f32_16x16x32_bf16 v[12:15], a[24:27], v[156:159], v[12:15]
    ds_read_b128 v[168:171], v3 offset:11264
    v_mfma_f32_16x16x32_bf16 v[16:19], a[24:27], v[160:163], v[16:19]
    ds_read_b128 v[172:175], v3 offset:29696
    v_mfma_f32_16x16x32_bf16 v[20:23], a[24:27], v[164:167], v[20:23]
    buffer_load_dwordx4 a[24:27], v1, s[68:71], s21 offen offset:2048
    s_waitcnt vmcnt(23)
    v_mfma_f32_16x16x32_bf16 v[24:27], a[28:31], v[152:155], v[24:27]
    ds_read_b128 v[176:179], v3 offset:48128
    v_mfma_f32_16x16x32_bf16 v[28:31], a[28:31], v[156:159], v[28:31]
    ds_read_b128 v[180:183], v4 offset:11264
    v_mfma_f32_16x16x32_bf16 v[32:35], a[28:31], v[160:163], v[32:35]
    v_mfma_f32_16x16x32_bf16 v[36:39], a[28:31], v[164:167], v[36:39]
    buffer_load_dwordx4 a[28:31], v1, s[68:71], s21 offen offset:3072
    s_waitcnt vmcnt(23)
    v_mfma_f32_16x16x32_bf16 v[40:43], a[32:35], v[152:155], v[40:43]
    v_mfma_f32_16x16x32_bf16 v[44:47], a[32:35], v[156:159], v[44:47]
    v_mfma_f32_16x16x32_bf16 v[48:51], a[32:35], v[160:163], v[48:51]
    v_mfma_f32_16x16x32_bf16 v[52:55], a[32:35], v[164:167], v[52:55]
    s_mov_b32 s21, 229376
    buffer_load_dwordx4 a[32:35], v1, s[68:71], s21 offen offset:0
    s_waitcnt lgkmcnt(0)
    s_waitcnt vmcnt(23)
    v_mfma_f32_16x16x32_bf16 v[8:11], a[36:39], v[168:171], v[8:11]
    v_mfma_f32_16x16x32_bf16 v[12:15], a[36:39], v[172:175], v[12:15]
    ds_read_b128 v[152:155], v3 offset:12288
    v_mfma_f32_16x16x32_bf16 v[16:19], a[36:39], v[176:179], v[16:19]
    ds_read_b128 v[156:159], v3 offset:30720
    v_mfma_f32_16x16x32_bf16 v[20:23], a[36:39], v[180:183], v[20:23]
    buffer_load_dwordx4 a[36:39], v1, s[68:71], s21 offen offset:1024
    s_waitcnt vmcnt(23)
    v_mfma_f32_16x16x32_bf16 v[24:27], a[40:43], v[168:171], v[24:27]
    ds_read_b128 v[160:163], v3 offset:49152
    v_mfma_f32_16x16x32_bf16 v[28:31], a[40:43], v[172:175], v[28:31]
    ds_read_b128 v[164:167], v4 offset:12288
    v_mfma_f32_16x16x32_bf16 v[32:35], a[40:43], v[176:179], v[32:35]
    v_mfma_f32_16x16x32_bf16 v[36:39], a[40:43], v[180:183], v[36:39]
    buffer_load_dwordx4 a[40:43], v1, s[68:71], s21 offen offset:2048
    s_waitcnt vmcnt(23)
    v_mfma_f32_16x16x32_bf16 v[40:43], a[44:47], v[168:171], v[40:43]
    v_mfma_f32_16x16x32_bf16 v[44:47], a[44:47], v[172:175], v[44:47]
    v_mfma_f32_16x16x32_bf16 v[48:51], a[44:47], v[176:179], v[48:51]
    v_mfma_f32_16x16x32_bf16 v[52:55], a[44:47], v[180:183], v[52:55]
    buffer_load_dwordx4 a[44:47], v1, s[68:71], s21 offen offset:3072
    s_waitcnt lgkmcnt(0)
    s_waitcnt vmcnt(23)
    v_mfma_f32_16x16x32_bf16 v[8:11], a[48:51], v[152:155], v[8:11]
    v_mfma_f32_16x16x32_bf16 v[12:15], a[48:51], v[156:159], v[12:15]
    ds_read_b128 v[168:171], v3 offset:13312
    v_mfma_f32_16x16x32_bf16 v[16:19], a[48:51], v[160:163], v[16:19]
    ds_read_b128 v[172:175], v3 offset:31744
    v_mfma_f32_16x16x32_bf16 v[20:23], a[48:51], v[164:167], v[20:23]
    s_mov_b32 s21, 233472
    buffer_load_dwordx4 a[48:51], v1, s[68:71], s21 offen offset:0
    s_waitcnt vmcnt(23)
    v_mfma_f32_16x16x32_bf16 v[24:27], a[52:55], v[152:155], v[24:27]
    ds_read_b128 v[176:179], v3 offset:50176
    v_mfma_f32_16x16x32_bf16 v[28:31], a[52:55], v[156:159], v[28:31]
    ds_read_b128 v[180:183], v4 offset:13312
    v_mfma_f32_16x16x32_bf16 v[32:35], a[52:55], v[160:163], v[32:35]
    v_mfma_f32_16x16x32_bf16 v[36:39], a[52:55], v[164:167], v[36:39]
    buffer_load_dwordx4 a[52:55], v1, s[68:71], s21 offen offset:1024
    s_waitcnt vmcnt(23)
    v_mfma_f32_16x16x32_bf16 v[40:43], a[56:59], v[152:155], v[40:43]
    v_mfma_f32_16x16x32_bf16 v[44:47], a[56:59], v[156:159], v[44:47]
    v_mfma_f32_16x16x32_bf16 v[48:51], a[56:59], v[160:163], v[48:51]
    v_mfma_f32_16x16x32_bf16 v[52:55], a[56:59], v[164:167], v[52:55]
    buffer_load_dwordx4 a[56:59], v1, s[68:71], s21 offen offset:2048
    s_waitcnt lgkmcnt(0)
    s_waitcnt vmcnt(23)
    v_mfma_f32_16x16x32_bf16 v[8:11], a[60:63], v[168:171], v[8:11]
    v_mfma_f32_16x16x32_bf16 v[12:15], a[60:63], v[172:175], v[12:15]
    ds_read_b128 v[152:155], v3 offset:16384
    v_mfma_f32_16x16x32_bf16 v[16:19], a[60:63], v[176:179], v[16:19]
    ds_read_b128 v[156:159], v3 offset:34816
    v_mfma_f32_16x16x32_bf16 v[20:23], a[60:63], v[180:183], v[20:23]
    buffer_load_dwordx4 a[60:63], v1, s[68:71], s21 offen offset:3072
    s_waitcnt vmcnt(23)
    v_mfma_f32_16x16x32_bf16 v[24:27], a[64:67], v[168:171], v[24:27]
    ds_read_b128 v[160:163], v3 offset:53248
    v_mfma_f32_16x16x32_bf16 v[28:31], a[64:67], v[172:175], v[28:31]
    ds_read_b128 v[164:167], v4 offset:16384
    v_mfma_f32_16x16x32_bf16 v[32:35], a[64:67], v[176:179], v[32:35]
    v_mfma_f32_16x16x32_bf16 v[36:39], a[64:67], v[180:183], v[36:39]
    s_mov_b32 s21, 237568
    buffer_load_dwordx4 a[64:67], v1, s[68:71], s21 offen offset:0
    s_waitcnt vmcnt(23)
    v_mfma_f32_16x16x32_bf16 v[40:43], a[68:71], v[168:171], v[40:43]
    v_mfma_f32_16x16x32_bf16 v[44:47], a[68:71], v[172:175], v[44:47]
    v_mfma_f32_16x16x32_bf16 v[48:51], a[68:71], v[176:179], v[48:51]
    v_mfma_f32_16x16x32_bf16 v[52:55], a[68:71], v[180:183], v[52:55]
    buffer_load_dwordx4 a[68:71], v1, s[68:71], s21 offen offset:1024
    s_waitcnt lgkmcnt(0)
    s_waitcnt vmcnt(23)
    v_mfma_f32_16x16x32_bf16 v[8:11], a[72:75], v[152:155], v[8:11]
    v_mfma_f32_16x16x32_bf16 v[12:15], a[72:75], v[156:159], v[12:15]
    ds_read_b128 v[168:171], v3 offset:17408
    v_mfma_f32_16x16x32_bf16 v[16:19], a[72:75], v[160:163], v[16:19]
    ds_read_b128 v[172:175], v3 offset:35840
    v_mfma_f32_16x16x32_bf16 v[20:23], a[72:75], v[164:167], v[20:23]
    buffer_load_dwordx4 a[72:75], v1, s[68:71], s21 offen offset:2048
    s_waitcnt vmcnt(23)
    v_mfma_f32_16x16x32_bf16 v[24:27], a[76:79], v[152:155], v[24:27]
    ds_read_b128 v[176:179], v3 offset:54272
    v_mfma_f32_16x16x32_bf16 v[28:31], a[76:79], v[156:159], v[28:31]
    ds_read_b128 v[180:183], v4 offset:17408
    v_mfma_f32_16x16x32_bf16 v[32:35], a[76:79], v[160:163], v[32:35]
    v_mfma_f32_16x16x32_bf16 v[36:39], a[76:79], v[164:167], v[36:39]
    buffer_load_dwordx4 a[76:79], v1, s[68:71], s21 offen offset:3072
    s_waitcnt vmcnt(23)
    v_mfma_f32_16x16x32_bf16 v[40:43], a[80:83], v[152:155], v[40:43]
    v_mfma_f32_16x16x32_bf16 v[44:47], a[80:83], v[156:159], v[44:47]
    v_mfma_f32_16x16x32_bf16 v[48:51], a[80:83], v[160:163], v[48:51]
    v_mfma_f32_16x16x32_bf16 v[52:55], a[80:83], v[164:167], v[52:55]
    s_mov_b32 s21, 241664
    buffer_load_dwordx4 a[80:83], v1, s[68:71], s21 offen offset:0
    s_waitcnt lgkmcnt(0)
    s_waitcnt vmcnt(23)
    v_mfma_f32_16x16x32_bf16 v[8:11], a[84:87], v[168:171], v[8:11]
    v_mfma_f32_16x16x32_bf16 v[12:15], a[84:87], v[172:175], v[12:15]
    ds_read_b128 v[152:155], v3 offset:0
    v_mfma_f32_16x16x32_bf16 v[16:19], a[84:87], v[176:179], v[16:19]
    ds_read_b128 v[156:159], v3 offset:18432
    v_mfma_f32_16x16x32_bf16 v[20:23], a[84:87], v[180:183], v[20:23]
    buffer_load_dwordx4 a[84:87], v1, s[68:71], s21 offen offset:1024
    s_waitcnt vmcnt(23)
    v_mfma_f32_16x16x32_bf16 v[24:27], a[88:91], v[168:171], v[24:27]
    ds_read_b128 v[160:163], v3 offset:36864
    v_mfma_f32_16x16x32_bf16 v[28:31], a[88:91], v[172:175], v[28:31]
    ds_read_b128 v[164:167], v4 offset:0
    v_mfma_f32_16x16x32_bf16 v[32:35], a[88:91], v[176:179], v[32:35]
    v_mfma_f32_16x16x32_bf16 v[36:39], a[88:91], v[180:183], v[36:39]
    buffer_load_dwordx4 a[88:91], v1, s[68:71], s21 offen offset:2048
    s_waitcnt vmcnt(23)
    v_mfma_f32_16x16x32_bf16 v[40:43], a[92:95], v[168:171], v[40:43]
    v_mfma_f32_16x16x32_bf16 v[44:47], a[92:95], v[172:175], v[44:47]
    v_mfma_f32_16x16x32_bf16 v[48:51], a[92:95], v[176:179], v[48:51]
    v_mfma_f32_16x16x32_bf16 v[52:55], a[92:95], v[180:183], v[52:55]
    buffer_load_dwordx4 a[92:95], v1, s[68:71], s21 offen offset:3072
    s_waitcnt lgkmcnt(0)
    s_waitcnt vmcnt(23)
    v_mfma_f32_16x16x32_bf16 v[88:91], a[0:3], v[152:155], 0
    v_mfma_f32_16x16x32_bf16 v[92:95], a[0:3], v[156:159], 0
    ds_read_b128 v[168:171], v3 offset:1024
    v_mfma_f32_16x16x32_bf16 v[96:99], a[0:3], v[160:163], 0
    ds_read_b128 v[172:175], v3 offset:19456
    v_mfma_f32_16x16x32_bf16 v[100:103], a[0:3], v[164:167], 0
    s_mov_b32 s21, 245760
    buffer_load_dwordx4 a[0:3], v1, s[68:71], s21 offen offset:0
    s_waitcnt vmcnt(23)
    v_mfma_f32_16x16x32_bf16 v[104:107], a[4:7], v[152:155], 0
    ds_read_b128 v[176:179], v3 offset:37888
    v_mfma_f32_16x16x32_bf16 v[108:111], a[4:7], v[156:159], 0
    ds_read_b128 v[180:183], v4 offset:1024
    v_mfma_f32_16x16x32_bf16 v[112:115], a[4:7], v[160:163], 0
    v_cvt_pk_bf16_f32 v184, v40, v41
    v_mfma_f32_16x16x32_bf16 v[116:119], a[4:7], v[164:167], 0
    buffer_load_dwordx4 a[4:7], v1, s[68:71], s21 offen offset:1024
    s_waitcnt vmcnt(23)
    v_mfma_f32_16x16x32_bf16 v[120:123], a[8:11], v[152:155], 0
    v_cvt_pk_bf16_f32 v185, v42, v43
    v_mfma_f32_16x16x32_bf16 v[124:127], a[8:11], v[156:159], 0
    ds_write_b64 v7, v[184:185] offset:0
    v_mfma_f32_16x16x32_bf16 v[128:131], a[8:11], v[160:163], 0
    v_cvt_pk_bf16_f32 v186, v44, v45
    v_mfma_f32_16x16x32_bf16 v[132:135], a[8:11], v[164:167], 0
    buffer_load_dwordx4 a[8:11], v1, s[68:71], s21 offen offset:2048
    s_waitcnt vmcnt(23)
    v_mfma_f32_16x16x32_bf16 v[136:139], a[12:15], v[152:155], 0
    v_cvt_pk_bf16_f32 v187, v46, v47
    v_mfma_f32_16x16x32_bf16 v[140:143], a[12:15], v[156:159], 0
    ds_write_b64 v7, v[186:187] offset:1024
    v_mfma_f32_16x16x32_bf16 v[144:147], a[12:15], v[160:163], 0
    v_cvt_pk_bf16_f32 v188, v48, v49
    v_mfma_f32_16x16x32_bf16 v[148:151], a[12:15], v[164:167], 0
    buffer_load_dwordx4 a[12:15], v1, s[68:71], s21 offen offset:3072
    s_waitcnt lgkmcnt(2)
    s_waitcnt vmcnt(23)
    v_mfma_f32_16x16x32_bf16 v[88:91], a[16:19], v[168:171], v[88:91]
    v_cvt_pk_bf16_f32 v189, v50, v51
    v_mfma_f32_16x16x32_bf16 v[92:95], a[16:19], v[172:175], v[92:95]
    ds_read_b128 v[152:155], v3 offset:5120
    v_mfma_f32_16x16x32_bf16 v[96:99], a[16:19], v[176:179], v[96:99]
    ds_read_b128 v[156:159], v3 offset:23552
    v_mfma_f32_16x16x32_bf16 v[100:103], a[16:19], v[180:183], v[100:103]
    s_mov_b32 s21, 249856
    buffer_load_dwordx4 a[16:19], v1, s[68:71], s21 offen offset:0
    s_waitcnt vmcnt(23)
    v_mfma_f32_16x16x32_bf16 v[104:107], a[20:23], v[168:171], v[104:107]
    ds_read_b128 v[160:163], v3 offset:41984
    v_mfma_f32_16x16x32_bf16 v[108:111], a[20:23], v[172:175], v[108:111]
    ds_read_b128 v[164:167], v4 offset:5120
    v_mfma_f32_16x16x32_bf16 v[112:115], a[20:23], v[176:179], v[112:115]
    ds_write_b64 v7, v[188:189] offset:2048
    v_mfma_f32_16x16x32_bf16 v[116:119], a[20:23], v[180:183], v[116:119]
    buffer_load_dwordx4 a[20:23], v1, s[68:71], s21 offen offset:1024
    s_waitcnt vmcnt(23)
    v_mfma_f32_16x16x32_bf16 v[120:123], a[24:27], v[168:171], v[120:123]
    v_cvt_pk_bf16_f32 v190, v52, v53
    v_mfma_f32_16x16x32_bf16 v[124:127], a[24:27], v[172:175], v[124:127]
    v_cvt_pk_bf16_f32 v191, v54, v55
    v_mfma_f32_16x16x32_bf16 v[128:131], a[24:27], v[176:179], v[128:131]
    ds_write_b64 v7, v[190:191] offset:3072
    v_mfma_f32_16x16x32_bf16 v[132:135], a[24:27], v[180:183], v[132:135]
    buffer_load_dwordx4 a[24:27], v1, s[68:71], s21 offen offset:2048
    s_waitcnt vmcnt(23)
    v_mfma_f32_16x16x32_bf16 v[136:139], a[28:31], v[168:171], v[136:139]
    v_cvt_pk_bf16_f32 v200, v8, v9
    v_mfma_f32_16x16x32_bf16 v[140:143], a[28:31], v[172:175], v[140:143]
    v_cvt_pk_bf16_f32 v201, v10, v11
    v_mfma_f32_16x16x32_bf16 v[144:147], a[28:31], v[176:179], v[144:147]
    v_cvt_pk_bf16_f32 v202, v24, v25
    v_mfma_f32_16x16x32_bf16 v[148:151], a[28:31], v[180:183], v[148:151]
    buffer_load_dwordx4 a[28:31], v1, s[68:71], s21 offen offset:3072
    s_waitcnt lgkmcnt(2)
    s_waitcnt vmcnt(23)
    v_mfma_f32_16x16x32_bf16 v[88:91], a[32:35], v[152:155], v[88:91]
    v_cvt_pk_bf16_f32 v203, v26, v27
    v_mfma_f32_16x16x32_bf16 v[92:95], a[32:35], v[156:159], v[92:95]
    ds_read_b128 v[168:171], v3 offset:6144
    v_mfma_f32_16x16x32_bf16 v[96:99], a[32:35], v[160:163], v[96:99]
    ds_read_b128 v[172:175], v3 offset:24576
    v_mfma_f32_16x16x32_bf16 v[100:103], a[32:35], v[164:167], v[100:103]
    s_mov_b32 s21, 253952
    buffer_load_dwordx4 a[32:35], v1, s[68:71], s21 offen offset:0
    s_waitcnt vmcnt(23)
    v_mfma_f32_16x16x32_bf16 v[104:107], a[36:39], v[152:155], v[104:107]
    ds_read_b128 v[176:179], v3 offset:43008
    v_mfma_f32_16x16x32_bf16 v[108:111], a[36:39], v[156:159], v[108:111]
    ds_read_b128 v[180:183], v4 offset:6144
    v_mfma_f32_16x16x32_bf16 v[112:115], a[36:39], v[160:163], v[112:115]
    buffer_store_dwordx4 v[200:203], v217, s[16:19], s32 offen offset:0 sc1
    v_mfma_f32_16x16x32_bf16 v[116:119], a[36:39], v[164:167], v[116:119]
    buffer_load_dwordx4 a[36:39], v1, s[68:71], s21 offen offset:1024
    s_waitcnt vmcnt(24)
    v_mfma_f32_16x16x32_bf16 v[120:123], a[40:43], v[152:155], v[120:123]
    v_cvt_pk_bf16_f32 v204, v12, v13
    v_mfma_f32_16x16x32_bf16 v[124:127], a[40:43], v[156:159], v[124:127]
    v_cvt_pk_bf16_f32 v205, v14, v15
    v_mfma_f32_16x16x32_bf16 v[128:131], a[40:43], v[160:163], v[128:131]
    v_cvt_pk_bf16_f32 v206, v28, v29
    v_mfma_f32_16x16x32_bf16 v[132:135], a[40:43], v[164:167], v[132:135]
    buffer_load_dwordx4 a[40:43], v1, s[68:71], s21 offen offset:2048
    s_waitcnt vmcnt(24)
    v_mfma_f32_16x16x32_bf16 v[136:139], a[44:47], v[152:155], v[136:139]
    v_cvt_pk_bf16_f32 v207, v30, v31
    v_mfma_f32_16x16x32_bf16 v[140:143], a[44:47], v[156:159], v[140:143]
    buffer_store_dwordx4 v[204:207], v217, s[16:19], s33 offen offset:0 sc1
    v_mfma_f32_16x16x32_bf16 v[144:147], a[44:47], v[160:163], v[144:147]
    v_cvt_pk_bf16_f32 v208, v16, v17
    v_mfma_f32_16x16x32_bf16 v[148:151], a[44:47], v[164:167], v[148:151]
    buffer_load_dwordx4 a[44:47], v1, s[68:71], s21 offen offset:3072
    s_waitcnt lgkmcnt(0)
    s_waitcnt vmcnt(25)
    v_mfma_f32_16x16x32_bf16 v[88:91], a[48:51], v[168:171], v[88:91]
    v_cvt_pk_bf16_f32 v209, v18, v19
    v_mfma_f32_16x16x32_bf16 v[92:95], a[48:51], v[172:175], v[92:95]
    ds_read_b128 v[152:155], v3 offset:9216
    v_mfma_f32_16x16x32_bf16 v[96:99], a[48:51], v[176:179], v[96:99]
    ds_read_b128 v[156:159], v3 offset:27648
    v_mfma_f32_16x16x32_bf16 v[100:103], a[48:51], v[180:183], v[100:103]
    s_mov_b32 s21, 258048
    buffer_load_dwordx4 a[48:51], v1, s[68:71], s21 offen offset:0
    s_waitcnt vmcnt(25)
    v_mfma_f32_16x16x32_bf16 v[104:107], a[52:55], v[168:171], v[104:107]
    ds_read_b128 v[160:163], v3 offset:46080
    v_mfma_f32_16x16x32_bf16 v[108:111], a[52:55], v[172:175], v[108:111]
    ds_read_b128 v[164:167], v4 offset:9216
    v_mfma_f32_16x16x32_bf16 v[112:115], a[52:55], v[176:179], v[112:115]
    v_cvt_pk_bf16_f32 v210, v32, v33
    v_mfma_f32_16x16x32_bf16 v[116:119], a[52:55], v[180:183], v[116:119]
    buffer_load_dwordx4 a[52:55], v1, s[68:71], s21 offen offset:1024
    s_waitcnt vmcnt(25)
    v_mfma_f32_16x16x32_bf16 v[120:123], a[56:59], v[168:171], v[120:123]
    v_cvt_pk_bf16_f32 v211, v34, v35
    v_mfma_f32_16x16x32_bf16 v[124:127], a[56:59], v[172:175], v[124:127]
    buffer_store_dwordx4 v[208:211], v217, s[16:19], s34 offen offset:0 sc1
    v_mfma_f32_16x16x32_bf16 v[128:131], a[56:59], v[176:179], v[128:131]
    v_cvt_pk_bf16_f32 v212, v20, v21
    v_mfma_f32_16x16x32_bf16 v[132:135], a[56:59], v[180:183], v[132:135]
    buffer_load_dwordx4 a[56:59], v1, s[68:71], s21 offen offset:2048
    s_waitcnt vmcnt(26)
    v_mfma_f32_16x16x32_bf16 v[136:139], a[60:63], v[168:171], v[136:139]
    v_cvt_pk_bf16_f32 v213, v22, v23
    v_mfma_f32_16x16x32_bf16 v[140:143], a[60:63], v[172:175], v[140:143]
    v_cvt_pk_bf16_f32 v214, v36, v37
    v_mfma_f32_16x16x32_bf16 v[144:147], a[60:63], v[176:179], v[144:147]
    v_cvt_pk_bf16_f32 v215, v38, v39
    v_mfma_f32_16x16x32_bf16 v[148:151], a[60:63], v[180:183], v[148:151]
    buffer_load_dwordx4 a[60:63], v1, s[68:71], s21 offen offset:3072
    s_waitcnt lgkmcnt(0)
    s_waitcnt vmcnt(26)
    v_mfma_f32_16x16x32_bf16 v[88:91], a[64:67], v[152:155], v[88:91]
    buffer_store_dwordx4 v[212:215], v217, s[16:19], s35 offen offset:0 sc1
    v_mfma_f32_16x16x32_bf16 v[92:95], a[64:67], v[156:159], v[92:95]
    ds_read_b128 v[168:171], v3 offset:10240
    v_mfma_f32_16x16x32_bf16 v[96:99], a[64:67], v[160:163], v[96:99]
    ds_read_b128 v[172:175], v3 offset:28672
    v_mfma_f32_16x16x32_bf16 v[100:103], a[64:67], v[164:167], v[100:103]
    s_mov_b32 s21, 262144
    buffer_load_dwordx4 a[64:67], v1, s[68:71], s21 offen offset:0
    s_waitcnt vmcnt(27)
    v_mfma_f32_16x16x32_bf16 v[104:107], a[68:71], v[152:155], v[104:107]
    ds_read_b128 v[176:179], v3 offset:47104
    v_mfma_f32_16x16x32_bf16 v[108:111], a[68:71], v[156:159], v[108:111]
    ds_read_b128 v[180:183], v4 offset:10240
    v_mfma_f32_16x16x32_bf16 v[112:115], a[68:71], v[160:163], v[112:115]
    v_mfma_f32_16x16x32_bf16 v[116:119], a[68:71], v[164:167], v[116:119]
    buffer_load_dwordx4 a[68:71], v1, s[68:71], s21 offen offset:1024
    s_waitcnt vmcnt(27)
    v_mfma_f32_16x16x32_bf16 v[120:123], a[72:75], v[152:155], v[120:123]
    v_mfma_f32_16x16x32_bf16 v[124:127], a[72:75], v[156:159], v[124:127]
    v_mfma_f32_16x16x32_bf16 v[128:131], a[72:75], v[160:163], v[128:131]
    v_mfma_f32_16x16x32_bf16 v[132:135], a[72:75], v[164:167], v[132:135]
    buffer_load_dwordx4 a[72:75], v1, s[68:71], s21 offen offset:2048
    s_waitcnt vmcnt(27)
    v_mfma_f32_16x16x32_bf16 v[136:139], a[76:79], v[152:155], v[136:139]
    v_mfma_f32_16x16x32_bf16 v[140:143], a[76:79], v[156:159], v[140:143]
    v_mfma_f32_16x16x32_bf16 v[144:147], a[76:79], v[160:163], v[144:147]
    v_mfma_f32_16x16x32_bf16 v[148:151], a[76:79], v[164:167], v[148:151]
    buffer_load_dwordx4 a[76:79], v1, s[68:71], s21 offen offset:3072
    s_waitcnt lgkmcnt(0)
    s_waitcnt vmcnt(27)
    v_mfma_f32_16x16x32_bf16 v[88:91], a[80:83], v[168:171], v[88:91]
    v_mfma_f32_16x16x32_bf16 v[92:95], a[80:83], v[172:175], v[92:95]
    ds_read_b128 v[152:155], v3 offset:14336
    v_mfma_f32_16x16x32_bf16 v[96:99], a[80:83], v[176:179], v[96:99]
    ds_read_b128 v[156:159], v3 offset:32768
    v_mfma_f32_16x16x32_bf16 v[100:103], a[80:83], v[180:183], v[100:103]
    s_mov_b32 s21, 266240
    buffer_load_dwordx4 a[80:83], v1, s[68:71], s21 offen offset:0
    s_waitcnt vmcnt(27)
    v_mfma_f32_16x16x32_bf16 v[104:107], a[84:87], v[168:171], v[104:107]
    ds_read_b128 v[160:163], v3 offset:51200
    v_mfma_f32_16x16x32_bf16 v[108:111], a[84:87], v[172:175], v[108:111]
    ds_read_b128 v[164:167], v4 offset:14336
    v_mfma_f32_16x16x32_bf16 v[112:115], a[84:87], v[176:179], v[112:115]
    v_mfma_f32_16x16x32_bf16 v[116:119], a[84:87], v[180:183], v[116:119]
    buffer_load_dwordx4 a[84:87], v1, s[68:71], s21 offen offset:1024
    s_waitcnt vmcnt(27)
    v_mfma_f32_16x16x32_bf16 v[120:123], a[88:91], v[168:171], v[120:123]
    v_mfma_f32_16x16x32_bf16 v[124:127], a[88:91], v[172:175], v[124:127]
    v_mfma_f32_16x16x32_bf16 v[128:131], a[88:91], v[176:179], v[128:131]
    v_mfma_f32_16x16x32_bf16 v[132:135], a[88:91], v[180:183], v[132:135]
    buffer_load_dwordx4 a[88:91], v1, s[68:71], s21 offen offset:2048
    s_waitcnt vmcnt(27)
    v_mfma_f32_16x16x32_bf16 v[136:139], a[92:95], v[168:171], v[136:139]
    v_mfma_f32_16x16x32_bf16 v[140:143], a[92:95], v[172:175], v[140:143]
    v_mfma_f32_16x16x32_bf16 v[144:147], a[92:95], v[176:179], v[144:147]
    v_mfma_f32_16x16x32_bf16 v[148:151], a[92:95], v[180:183], v[148:151]
    buffer_load_dwordx4 a[92:95], v1, s[68:71], s21 offen offset:3072
    s_waitcnt lgkmcnt(15)
    s_barrier
    s_waitcnt lgkmcnt(0)
    s_waitcnt vmcnt(27)
    v_mfma_f32_16x16x32_bf16 v[88:91], a[0:3], v[152:155], v[88:91]
    v_mfma_f32_16x16x32_bf16 v[92:95], a[0:3], v[156:159], v[92:95]
    ds_read_b128 v[168:171], v3 offset:15360
    v_mfma_f32_16x16x32_bf16 v[96:99], a[0:3], v[160:163], v[96:99]
    ds_read_b128 v[172:175], v3 offset:33792
    v_mfma_f32_16x16x32_bf16 v[100:103], a[0:3], v[164:167], v[100:103]
    s_mov_b32 s21, 270336
    buffer_load_dwordx4 a[0:3], v1, s[68:71], s21 offen offset:0
    s_waitcnt vmcnt(27)
    v_mfma_f32_16x16x32_bf16 v[104:107], a[4:7], v[152:155], v[104:107]
    ds_read_b128 v[176:179], v3 offset:52224
    v_mfma_f32_16x16x32_bf16 v[108:111], a[4:7], v[156:159], v[108:111]
    ds_read_b128 v[180:183], v4 offset:15360
    v_mfma_f32_16x16x32_bf16 v[112:115], a[4:7], v[160:163], v[112:115]
    ds_read_b128 v[220:223], v216 offset:0
    v_mfma_f32_16x16x32_bf16 v[116:119], a[4:7], v[164:167], v[116:119]
    buffer_load_dwordx4 a[4:7], v1, s[68:71], s21 offen offset:1024
    s_waitcnt vmcnt(27)
    v_mfma_f32_16x16x32_bf16 v[120:123], a[8:11], v[152:155], v[120:123]
    ds_read_b128 v[224:227], v216 offset:1024
    v_mfma_f32_16x16x32_bf16 v[124:127], a[8:11], v[156:159], v[124:127]
    v_mfma_f32_16x16x32_bf16 v[128:131], a[8:11], v[160:163], v[128:131]
    v_mfma_f32_16x16x32_bf16 v[132:135], a[8:11], v[164:167], v[132:135]
    buffer_load_dwordx4 a[8:11], v1, s[68:71], s21 offen offset:2048
    s_waitcnt vmcnt(27)
    v_mfma_f32_16x16x32_bf16 v[136:139], a[12:15], v[152:155], v[136:139]
    v_mfma_f32_16x16x32_bf16 v[140:143], a[12:15], v[156:159], v[140:143]
    v_mfma_f32_16x16x32_bf16 v[144:147], a[12:15], v[160:163], v[144:147]
    v_mfma_f32_16x16x32_bf16 v[148:151], a[12:15], v[164:167], v[148:151]
    buffer_load_dwordx4 a[12:15], v1, s[68:71], s21 offen offset:3072
    s_waitcnt lgkmcnt(2)
    s_waitcnt vmcnt(27)
    v_mfma_f32_16x16x32_bf16 v[88:91], a[16:19], v[168:171], v[88:91]
    v_mfma_f32_16x16x32_bf16 v[92:95], a[16:19], v[172:175], v[92:95]
    ds_read_b128 v[152:155], v3 offset:2048
    v_mfma_f32_16x16x32_bf16 v[96:99], a[16:19], v[176:179], v[96:99]
    ds_read_b128 v[156:159], v3 offset:20480
    v_mfma_f32_16x16x32_bf16 v[100:103], a[16:19], v[180:183], v[100:103]
    s_mov_b32 s21, 274432
    buffer_load_dwordx4 a[16:19], v1, s[68:71], s21 offen offset:0
    s_waitcnt vmcnt(27)
    v_mfma_f32_16x16x32_bf16 v[104:107], a[20:23], v[168:171], v[104:107]
    ds_read_b128 v[160:163], v3 offset:38912
    v_mfma_f32_16x16x32_bf16 v[108:111], a[20:23], v[172:175], v[108:111]
    ds_read_b128 v[164:167], v4 offset:2048
    v_mfma_f32_16x16x32_bf16 v[112:115], a[20:23], v[176:179], v[112:115]
    v_mfma_f32_16x16x32_bf16 v[116:119], a[20:23], v[180:183], v[116:119]
    buffer_load_dwordx4 a[20:23], v1, s[68:71], s21 offen offset:1024
    s_waitcnt vmcnt(27)
    v_mfma_f32_16x16x32_bf16 v[120:123], a[24:27], v[168:171], v[120:123]
    s_waitcnt lgkmcnt(4)
    buffer_store_dwordx4 v[220:223], v217, s[16:19], s36 offen sc1
    v_mfma_f32_16x16x32_bf16 v[124:127], a[24:27], v[172:175], v[124:127]
    v_mfma_f32_16x16x32_bf16 v[128:131], a[24:27], v[176:179], v[128:131]
    v_mfma_f32_16x16x32_bf16 v[132:135], a[24:27], v[180:183], v[132:135]
    buffer_load_dwordx4 a[24:27], v1, s[68:71], s21 offen offset:2048
    s_waitcnt vmcnt(28)
    v_mfma_f32_16x16x32_bf16 v[136:139], a[28:31], v[168:171], v[136:139]
    v_mfma_f32_16x16x32_bf16 v[140:143], a[28:31], v[172:175], v[140:143]
    v_mfma_f32_16x16x32_bf16 v[144:147], a[28:31], v[176:179], v[144:147]
    v_mfma_f32_16x16x32_bf16 v[148:151], a[28:31], v[180:183], v[148:151]
    buffer_load_dwordx4 a[28:31], v1, s[68:71], s21 offen offset:3072
    s_waitcnt lgkmcnt(0)
    s_waitcnt vmcnt(28)
    v_mfma_f32_16x16x32_bf16 v[88:91], a[32:35], v[152:155], v[88:91]
    v_mfma_f32_16x16x32_bf16 v[92:95], a[32:35], v[156:159], v[92:95]
    ds_read_b128 v[168:171], v3 offset:3072
    v_mfma_f32_16x16x32_bf16 v[96:99], a[32:35], v[160:163], v[96:99]
    ds_read_b128 v[172:175], v3 offset:21504
    v_mfma_f32_16x16x32_bf16 v[100:103], a[32:35], v[164:167], v[100:103]
    s_mov_b32 s21, 278528
    buffer_load_dwordx4 a[32:35], v1, s[68:71], s21 offen offset:0
    s_waitcnt vmcnt(27)
    v_mfma_f32_16x16x32_bf16 v[104:107], a[36:39], v[152:155], v[104:107]
    ds_read_b128 v[176:179], v3 offset:39936
    v_mfma_f32_16x16x32_bf16 v[108:111], a[36:39], v[156:159], v[108:111]
    ds_read_b128 v[180:183], v4 offset:3072
    v_mfma_f32_16x16x32_bf16 v[112:115], a[36:39], v[160:163], v[112:115]
    v_mfma_f32_16x16x32_bf16 v[116:119], a[36:39], v[164:167], v[116:119]
    buffer_load_dwordx4 a[36:39], v1, s[68:71], s21 offen offset:1024
    s_waitcnt vmcnt(27)
    v_mfma_f32_16x16x32_bf16 v[120:123], a[40:43], v[152:155], v[120:123]
    s_waitcnt lgkmcnt(8)
    buffer_store_dwordx4 v[224:227], v217, s[16:19], s37 offen sc1
    v_mfma_f32_16x16x32_bf16 v[124:127], a[40:43], v[156:159], v[124:127]
    v_mfma_f32_16x16x32_bf16 v[128:131], a[40:43], v[160:163], v[128:131]
    v_mfma_f32_16x16x32_bf16 v[132:135], a[40:43], v[164:167], v[132:135]
    buffer_load_dwordx4 a[40:43], v1, s[68:71], s21 offen offset:2048
    s_waitcnt vmcnt(27)
    v_mfma_f32_16x16x32_bf16 v[136:139], a[44:47], v[152:155], v[136:139]
    v_mfma_f32_16x16x32_bf16 v[140:143], a[44:47], v[156:159], v[140:143]
    v_mfma_f32_16x16x32_bf16 v[144:147], a[44:47], v[160:163], v[144:147]
    v_mfma_f32_16x16x32_bf16 v[148:151], a[44:47], v[164:167], v[148:151]
    buffer_load_dwordx4 a[44:47], v1, s[68:71], s21 offen offset:3072
    s_waitcnt lgkmcnt(0)
    s_waitcnt vmcnt(27)
    v_mfma_f32_16x16x32_bf16 v[88:91], a[48:51], v[168:171], v[88:91]
    v_mfma_f32_16x16x32_bf16 v[92:95], a[48:51], v[172:175], v[92:95]
    ds_read_b128 v[152:155], v3 offset:4096
    v_mfma_f32_16x16x32_bf16 v[96:99], a[48:51], v[176:179], v[96:99]
    ds_read_b128 v[156:159], v3 offset:22528
    v_mfma_f32_16x16x32_bf16 v[100:103], a[48:51], v[180:183], v[100:103]
    s_mov_b32 s21, 282624
    buffer_load_dwordx4 a[48:51], v1, s[68:71], s21 offen offset:0
    s_waitcnt vmcnt(27)
    v_mfma_f32_16x16x32_bf16 v[104:107], a[52:55], v[168:171], v[104:107]
    ds_read_b128 v[160:163], v3 offset:40960
    v_mfma_f32_16x16x32_bf16 v[108:111], a[52:55], v[172:175], v[108:111]
    ds_read_b128 v[164:167], v4 offset:4096
    v_mfma_f32_16x16x32_bf16 v[112:115], a[52:55], v[176:179], v[112:115]
    v_mfma_f32_16x16x32_bf16 v[116:119], a[52:55], v[180:183], v[116:119]
    buffer_load_dwordx4 a[52:55], v1, s[68:71], s21 offen offset:1024
    s_waitcnt vmcnt(26)
    v_mfma_f32_16x16x32_bf16 v[120:123], a[56:59], v[168:171], v[120:123]
    v_mfma_f32_16x16x32_bf16 v[124:127], a[56:59], v[172:175], v[124:127]
    v_mfma_f32_16x16x32_bf16 v[128:131], a[56:59], v[176:179], v[128:131]
    v_mfma_f32_16x16x32_bf16 v[132:135], a[56:59], v[180:183], v[132:135]
    buffer_load_dwordx4 a[56:59], v1, s[68:71], s21 offen offset:2048
    s_waitcnt vmcnt(26)
    v_mfma_f32_16x16x32_bf16 v[136:139], a[60:63], v[168:171], v[136:139]
    v_mfma_f32_16x16x32_bf16 v[140:143], a[60:63], v[172:175], v[140:143]
    v_mfma_f32_16x16x32_bf16 v[144:147], a[60:63], v[176:179], v[144:147]
    v_mfma_f32_16x16x32_bf16 v[148:151], a[60:63], v[180:183], v[148:151]
    buffer_load_dwordx4 a[60:63], v1, s[68:71], s21 offen offset:3072
    s_waitcnt lgkmcnt(0)
    s_waitcnt vmcnt(25)
    v_mfma_f32_16x16x32_bf16 v[88:91], a[64:67], v[152:155], v[88:91]
    v_mfma_f32_16x16x32_bf16 v[92:95], a[64:67], v[156:159], v[92:95]
    ds_read_b128 v[168:171], v3 offset:7168
    v_mfma_f32_16x16x32_bf16 v[96:99], a[64:67], v[160:163], v[96:99]
    ds_read_b128 v[172:175], v3 offset:25600
    v_mfma_f32_16x16x32_bf16 v[100:103], a[64:67], v[164:167], v[100:103]
    s_mov_b32 s21, 286720
    buffer_load_dwordx4 a[64:67], v1, s[68:71], s21 offen offset:0
    s_waitcnt vmcnt(25)
    v_mfma_f32_16x16x32_bf16 v[104:107], a[68:71], v[152:155], v[104:107]
    ds_read_b128 v[176:179], v3 offset:44032
    v_mfma_f32_16x16x32_bf16 v[108:111], a[68:71], v[156:159], v[108:111]
    ds_read_b128 v[180:183], v4 offset:7168
    v_mfma_f32_16x16x32_bf16 v[112:115], a[68:71], v[160:163], v[112:115]
    v_mfma_f32_16x16x32_bf16 v[116:119], a[68:71], v[164:167], v[116:119]
    buffer_load_dwordx4 a[68:71], v1, s[68:71], s21 offen offset:1024
    s_waitcnt vmcnt(25)
    v_mfma_f32_16x16x32_bf16 v[120:123], a[72:75], v[152:155], v[120:123]
    v_mfma_f32_16x16x32_bf16 v[124:127], a[72:75], v[156:159], v[124:127]
    v_mfma_f32_16x16x32_bf16 v[128:131], a[72:75], v[160:163], v[128:131]
    v_mfma_f32_16x16x32_bf16 v[132:135], a[72:75], v[164:167], v[132:135]
    buffer_load_dwordx4 a[72:75], v1, s[68:71], s21 offen offset:2048
    s_waitcnt vmcnt(25)
    v_mfma_f32_16x16x32_bf16 v[136:139], a[76:79], v[152:155], v[136:139]
    v_mfma_f32_16x16x32_bf16 v[140:143], a[76:79], v[156:159], v[140:143]
    v_mfma_f32_16x16x32_bf16 v[144:147], a[76:79], v[160:163], v[144:147]
    v_mfma_f32_16x16x32_bf16 v[148:151], a[76:79], v[164:167], v[148:151]
    buffer_load_dwordx4 a[76:79], v1, s[68:71], s21 offen offset:3072
    s_waitcnt lgkmcnt(0)
    s_waitcnt vmcnt(25)
    v_mfma_f32_16x16x32_bf16 v[88:91], a[80:83], v[168:171], v[88:91]
    v_mfma_f32_16x16x32_bf16 v[92:95], a[80:83], v[172:175], v[92:95]
    ds_read_b128 v[152:155], v3 offset:8192
    v_mfma_f32_16x16x32_bf16 v[96:99], a[80:83], v[176:179], v[96:99]
    ds_read_b128 v[156:159], v3 offset:26624
    v_mfma_f32_16x16x32_bf16 v[100:103], a[80:83], v[180:183], v[100:103]
    s_mov_b32 s21, 290816
    buffer_load_dwordx4 a[80:83], v1, s[68:71], s21 offen offset:0
    s_waitcnt vmcnt(25)
    v_mfma_f32_16x16x32_bf16 v[104:107], a[84:87], v[168:171], v[104:107]
    ds_read_b128 v[160:163], v3 offset:45056
    v_mfma_f32_16x16x32_bf16 v[108:111], a[84:87], v[172:175], v[108:111]
    ds_read_b128 v[164:167], v4 offset:8192
    v_mfma_f32_16x16x32_bf16 v[112:115], a[84:87], v[176:179], v[112:115]
    v_mfma_f32_16x16x32_bf16 v[116:119], a[84:87], v[180:183], v[116:119]
    buffer_load_dwordx4 a[84:87], v1, s[68:71], s21 offen offset:1024
    s_waitcnt vmcnt(25)
    v_mfma_f32_16x16x32_bf16 v[120:123], a[88:91], v[168:171], v[120:123]
    v_mfma_f32_16x16x32_bf16 v[124:127], a[88:91], v[172:175], v[124:127]
    v_mfma_f32_16x16x32_bf16 v[128:131], a[88:91], v[176:179], v[128:131]
    v_mfma_f32_16x16x32_bf16 v[132:135], a[88:91], v[180:183], v[132:135]
    buffer_load_dwordx4 a[88:91], v1, s[68:71], s21 offen offset:2048
    s_waitcnt vmcnt(25)
    v_mfma_f32_16x16x32_bf16 v[136:139], a[92:95], v[168:171], v[136:139]
    v_mfma_f32_16x16x32_bf16 v[140:143], a[92:95], v[172:175], v[140:143]
    v_mfma_f32_16x16x32_bf16 v[144:147], a[92:95], v[176:179], v[144:147]
    v_mfma_f32_16x16x32_bf16 v[148:151], a[92:95], v[180:183], v[148:151]
    buffer_load_dwordx4 a[92:95], v1, s[68:71], s21 offen offset:3072
    s_waitcnt lgkmcnt(0)
    s_waitcnt vmcnt(25)
    v_mfma_f32_16x16x32_bf16 v[88:91], a[0:3], v[152:155], v[88:91]
    v_mfma_f32_16x16x32_bf16 v[92:95], a[0:3], v[156:159], v[92:95]
    ds_read_b128 v[168:171], v3 offset:11264
    v_mfma_f32_16x16x32_bf16 v[96:99], a[0:3], v[160:163], v[96:99]
    ds_read_b128 v[172:175], v3 offset:29696
    v_mfma_f32_16x16x32_bf16 v[100:103], a[0:3], v[164:167], v[100:103]
    s_mov_b32 s21, 294912
    buffer_load_dwordx4 a[0:3], v1, s[68:71], s21 offen offset:0
    s_waitcnt vmcnt(25)
    v_mfma_f32_16x16x32_bf16 v[104:107], a[4:7], v[152:155], v[104:107]
    ds_read_b128 v[176:179], v3 offset:48128
    v_mfma_f32_16x16x32_bf16 v[108:111], a[4:7], v[156:159], v[108:111]
    ds_read_b128 v[180:183], v4 offset:11264
    v_mfma_f32_16x16x32_bf16 v[112:115], a[4:7], v[160:163], v[112:115]
    v_mfma_f32_16x16x32_bf16 v[116:119], a[4:7], v[164:167], v[116:119]
    buffer_load_dwordx4 a[4:7], v1, s[68:71], s21 offen offset:1024
    s_waitcnt vmcnt(25)
    v_mfma_f32_16x16x32_bf16 v[120:123], a[8:11], v[152:155], v[120:123]
    v_mfma_f32_16x16x32_bf16 v[124:127], a[8:11], v[156:159], v[124:127]
    v_mfma_f32_16x16x32_bf16 v[128:131], a[8:11], v[160:163], v[128:131]
    v_mfma_f32_16x16x32_bf16 v[132:135], a[8:11], v[164:167], v[132:135]
    buffer_load_dwordx4 a[8:11], v1, s[68:71], s21 offen offset:2048
    s_waitcnt vmcnt(25)
    v_mfma_f32_16x16x32_bf16 v[136:139], a[12:15], v[152:155], v[136:139]
    v_mfma_f32_16x16x32_bf16 v[140:143], a[12:15], v[156:159], v[140:143]
    v_mfma_f32_16x16x32_bf16 v[144:147], a[12:15], v[160:163], v[144:147]
    v_mfma_f32_16x16x32_bf16 v[148:151], a[12:15], v[164:167], v[148:151]
    buffer_load_dwordx4 a[12:15], v1, s[68:71], s21 offen offset:3072
    s_waitcnt lgkmcnt(0)
    s_waitcnt vmcnt(25)
    v_mfma_f32_16x16x32_bf16 v[88:91], a[16:19], v[168:171], v[88:91]
    v_mfma_f32_16x16x32_bf16 v[92:95], a[16:19], v[172:175], v[92:95]
    ds_read_b128 v[152:155], v3 offset:12288
    v_mfma_f32_16x16x32_bf16 v[96:99], a[16:19], v[176:179], v[96:99]
    ds_read_b128 v[156:159], v3 offset:30720
    v_mfma_f32_16x16x32_bf16 v[100:103], a[16:19], v[180:183], v[100:103]
    s_mov_b32 s21, 299008
    buffer_load_dwordx4 a[16:19], v1, s[68:71], s21 offen offset:0
    s_waitcnt vmcnt(25)
    v_mfma_f32_16x16x32_bf16 v[104:107], a[20:23], v[168:171], v[104:107]
    ds_read_b128 v[160:163], v3 offset:49152
    v_mfma_f32_16x16x32_bf16 v[108:111], a[20:23], v[172:175], v[108:111]
    ds_read_b128 v[164:167], v4 offset:12288
    v_mfma_f32_16x16x32_bf16 v[112:115], a[20:23], v[176:179], v[112:115]
    v_mfma_f32_16x16x32_bf16 v[116:119], a[20:23], v[180:183], v[116:119]
    buffer_load_dwordx4 a[20:23], v1, s[68:71], s21 offen offset:1024
    s_waitcnt vmcnt(24)
    v_mfma_f32_16x16x32_bf16 v[120:123], a[24:27], v[168:171], v[120:123]
    v_mfma_f32_16x16x32_bf16 v[124:127], a[24:27], v[172:175], v[124:127]
    v_mfma_f32_16x16x32_bf16 v[128:131], a[24:27], v[176:179], v[128:131]
    v_mfma_f32_16x16x32_bf16 v[132:135], a[24:27], v[180:183], v[132:135]
    buffer_load_dwordx4 a[24:27], v1, s[68:71], s21 offen offset:2048
    s_waitcnt vmcnt(24)
    v_mfma_f32_16x16x32_bf16 v[136:139], a[28:31], v[168:171], v[136:139]
    v_mfma_f32_16x16x32_bf16 v[140:143], a[28:31], v[172:175], v[140:143]
    v_mfma_f32_16x16x32_bf16 v[144:147], a[28:31], v[176:179], v[144:147]
    v_mfma_f32_16x16x32_bf16 v[148:151], a[28:31], v[180:183], v[148:151]
    buffer_load_dwordx4 a[28:31], v1, s[68:71], s21 offen offset:3072
    s_waitcnt lgkmcnt(0)
    s_waitcnt vmcnt(24)
    v_mfma_f32_16x16x32_bf16 v[88:91], a[32:35], v[152:155], v[88:91]
    v_mfma_f32_16x16x32_bf16 v[92:95], a[32:35], v[156:159], v[92:95]
    ds_read_b128 v[168:171], v3 offset:13312
    v_mfma_f32_16x16x32_bf16 v[96:99], a[32:35], v[160:163], v[96:99]
    ds_read_b128 v[172:175], v3 offset:31744
    v_mfma_f32_16x16x32_bf16 v[100:103], a[32:35], v[164:167], v[100:103]
    s_mov_b32 s21, 303104
    buffer_load_dwordx4 a[32:35], v1, s[68:71], s21 offen offset:0
    s_waitcnt vmcnt(24)
    v_mfma_f32_16x16x32_bf16 v[104:107], a[36:39], v[152:155], v[104:107]
    ds_read_b128 v[176:179], v3 offset:50176
    v_mfma_f32_16x16x32_bf16 v[108:111], a[36:39], v[156:159], v[108:111]
    ds_read_b128 v[180:183], v4 offset:13312
    v_mfma_f32_16x16x32_bf16 v[112:115], a[36:39], v[160:163], v[112:115]
    v_mfma_f32_16x16x32_bf16 v[116:119], a[36:39], v[164:167], v[116:119]
    buffer_load_dwordx4 a[36:39], v1, s[68:71], s21 offen offset:1024
    s_waitcnt vmcnt(23)
    v_mfma_f32_16x16x32_bf16 v[120:123], a[40:43], v[152:155], v[120:123]
    v_mfma_f32_16x16x32_bf16 v[124:127], a[40:43], v[156:159], v[124:127]
    v_mfma_f32_16x16x32_bf16 v[128:131], a[40:43], v[160:163], v[128:131]
    v_mfma_f32_16x16x32_bf16 v[132:135], a[40:43], v[164:167], v[132:135]
    buffer_load_dwordx4 a[40:43], v1, s[68:71], s21 offen offset:2048
    s_waitcnt vmcnt(23)
    v_mfma_f32_16x16x32_bf16 v[136:139], a[44:47], v[152:155], v[136:139]
    v_mfma_f32_16x16x32_bf16 v[140:143], a[44:47], v[156:159], v[140:143]
    v_mfma_f32_16x16x32_bf16 v[144:147], a[44:47], v[160:163], v[144:147]
    v_mfma_f32_16x16x32_bf16 v[148:151], a[44:47], v[164:167], v[148:151]
    buffer_load_dwordx4 a[44:47], v1, s[68:71], s21 offen offset:3072
    s_waitcnt lgkmcnt(0)
    s_waitcnt vmcnt(23)
    v_mfma_f32_16x16x32_bf16 v[88:91], a[48:51], v[168:171], v[88:91]
    v_mfma_f32_16x16x32_bf16 v[92:95], a[48:51], v[172:175], v[92:95]
    ds_read_b128 v[152:155], v3 offset:16384
    v_mfma_f32_16x16x32_bf16 v[96:99], a[48:51], v[176:179], v[96:99]
    ds_read_b128 v[156:159], v3 offset:34816
    v_mfma_f32_16x16x32_bf16 v[100:103], a[48:51], v[180:183], v[100:103]
    s_mov_b32 s21, 307200
    buffer_load_dwordx4 a[48:51], v1, s[68:71], s21 offen offset:0
    s_waitcnt vmcnt(23)
    v_mfma_f32_16x16x32_bf16 v[104:107], a[52:55], v[168:171], v[104:107]
    ds_read_b128 v[160:163], v3 offset:53248
    v_mfma_f32_16x16x32_bf16 v[108:111], a[52:55], v[172:175], v[108:111]
    ds_read_b128 v[164:167], v4 offset:16384
    v_mfma_f32_16x16x32_bf16 v[112:115], a[52:55], v[176:179], v[112:115]
    v_mfma_f32_16x16x32_bf16 v[116:119], a[52:55], v[180:183], v[116:119]
    buffer_load_dwordx4 a[52:55], v1, s[68:71], s21 offen offset:1024
    s_waitcnt vmcnt(23)
    v_mfma_f32_16x16x32_bf16 v[120:123], a[56:59], v[168:171], v[120:123]
    v_mfma_f32_16x16x32_bf16 v[124:127], a[56:59], v[172:175], v[124:127]
    v_mfma_f32_16x16x32_bf16 v[128:131], a[56:59], v[176:179], v[128:131]
    v_mfma_f32_16x16x32_bf16 v[132:135], a[56:59], v[180:183], v[132:135]
    buffer_load_dwordx4 a[56:59], v1, s[68:71], s21 offen offset:2048
    s_waitcnt vmcnt(23)
    v_mfma_f32_16x16x32_bf16 v[136:139], a[60:63], v[168:171], v[136:139]
    v_mfma_f32_16x16x32_bf16 v[140:143], a[60:63], v[172:175], v[140:143]
    v_mfma_f32_16x16x32_bf16 v[144:147], a[60:63], v[176:179], v[144:147]
    v_mfma_f32_16x16x32_bf16 v[148:151], a[60:63], v[180:183], v[148:151]
    buffer_load_dwordx4 a[60:63], v1, s[68:71], s21 offen offset:3072
    s_waitcnt lgkmcnt(0)
    s_waitcnt vmcnt(23)
    v_mfma_f32_16x16x32_bf16 v[88:91], a[64:67], v[152:155], v[88:91]
    v_mfma_f32_16x16x32_bf16 v[92:95], a[64:67], v[156:159], v[92:95]
    ds_read_b128 v[168:171], v3 offset:17408
    v_mfma_f32_16x16x32_bf16 v[96:99], a[64:67], v[160:163], v[96:99]
    ds_read_b128 v[172:175], v3 offset:35840
    v_mfma_f32_16x16x32_bf16 v[100:103], a[64:67], v[164:167], v[100:103]
    s_mov_b32 s21, 311296
    buffer_load_dwordx4 a[64:67], v1, s[68:71], s21 offen offset:0
    s_waitcnt vmcnt(23)
    v_mfma_f32_16x16x32_bf16 v[104:107], a[68:71], v[152:155], v[104:107]
    ds_read_b128 v[176:179], v3 offset:54272
    v_mfma_f32_16x16x32_bf16 v[108:111], a[68:71], v[156:159], v[108:111]
    ds_read_b128 v[180:183], v4 offset:17408
    v_mfma_f32_16x16x32_bf16 v[112:115], a[68:71], v[160:163], v[112:115]
    v_mfma_f32_16x16x32_bf16 v[116:119], a[68:71], v[164:167], v[116:119]
    buffer_load_dwordx4 a[68:71], v1, s[68:71], s21 offen offset:1024
    s_waitcnt vmcnt(23)
    v_mfma_f32_16x16x32_bf16 v[120:123], a[72:75], v[152:155], v[120:123]
    v_mfma_f32_16x16x32_bf16 v[124:127], a[72:75], v[156:159], v[124:127]
    v_mfma_f32_16x16x32_bf16 v[128:131], a[72:75], v[160:163], v[128:131]
    v_mfma_f32_16x16x32_bf16 v[132:135], a[72:75], v[164:167], v[132:135]
    buffer_load_dwordx4 a[72:75], v1, s[68:71], s21 offen offset:2048
    s_waitcnt vmcnt(23)
    v_mfma_f32_16x16x32_bf16 v[136:139], a[76:79], v[152:155], v[136:139]
    v_mfma_f32_16x16x32_bf16 v[140:143], a[76:79], v[156:159], v[140:143]
    v_mfma_f32_16x16x32_bf16 v[144:147], a[76:79], v[160:163], v[144:147]
    v_mfma_f32_16x16x32_bf16 v[148:151], a[76:79], v[164:167], v[148:151]
    buffer_load_dwordx4 a[76:79], v1, s[68:71], s21 offen offset:3072
    s_waitcnt lgkmcnt(0)
    s_waitcnt vmcnt(23)
    v_mfma_f32_16x16x32_bf16 v[88:91], a[80:83], v[168:171], v[88:91]
    v_mfma_f32_16x16x32_bf16 v[92:95], a[80:83], v[172:175], v[92:95]
    ds_read_b128 v[152:155], v3 offset:0
    v_mfma_f32_16x16x32_bf16 v[96:99], a[80:83], v[176:179], v[96:99]
    ds_read_b128 v[156:159], v3 offset:18432
    v_mfma_f32_16x16x32_bf16 v[100:103], a[80:83], v[180:183], v[100:103]
    s_mov_b32 s21, 315392
    buffer_load_dwordx4 a[80:83], v1, s[68:71], s21 offen offset:0
    s_waitcnt vmcnt(23)
    v_mfma_f32_16x16x32_bf16 v[104:107], a[84:87], v[168:171], v[104:107]
    ds_read_b128 v[160:163], v3 offset:36864
    v_mfma_f32_16x16x32_bf16 v[108:111], a[84:87], v[172:175], v[108:111]
    ds_read_b128 v[164:167], v4 offset:0
    v_mfma_f32_16x16x32_bf16 v[112:115], a[84:87], v[176:179], v[112:115]
    v_mfma_f32_16x16x32_bf16 v[116:119], a[84:87], v[180:183], v[116:119]
    buffer_load_dwordx4 a[84:87], v1, s[68:71], s21 offen offset:1024
    s_waitcnt vmcnt(23)
    v_mfma_f32_16x16x32_bf16 v[120:123], a[88:91], v[168:171], v[120:123]
    v_mfma_f32_16x16x32_bf16 v[124:127], a[88:91], v[172:175], v[124:127]
    v_mfma_f32_16x16x32_bf16 v[128:131], a[88:91], v[176:179], v[128:131]
    v_mfma_f32_16x16x32_bf16 v[132:135], a[88:91], v[180:183], v[132:135]
    buffer_load_dwordx4 a[88:91], v1, s[68:71], s21 offen offset:2048
    s_waitcnt vmcnt(23)
    v_mfma_f32_16x16x32_bf16 v[136:139], a[92:95], v[168:171], v[136:139]
    v_mfma_f32_16x16x32_bf16 v[140:143], a[92:95], v[172:175], v[140:143]
    v_mfma_f32_16x16x32_bf16 v[144:147], a[92:95], v[176:179], v[144:147]
    v_mfma_f32_16x16x32_bf16 v[148:151], a[92:95], v[180:183], v[148:151]
    buffer_load_dwordx4 a[92:95], v1, s[68:71], s21 offen offset:3072
    s_waitcnt lgkmcnt(0)
    s_waitcnt vmcnt(23)
    v_mfma_f32_16x16x32_bf16 v[56:59], a[0:3], v[152:155], 0
    v_mfma_f32_16x16x32_bf16 v[60:63], a[0:3], v[156:159], 0
    ds_read_b128 v[168:171], v3 offset:1024
    v_mfma_f32_16x16x32_bf16 v[64:67], a[0:3], v[160:163], 0
    ds_read_b128 v[172:175], v3 offset:19456
    v_mfma_f32_16x16x32_bf16 v[68:71], a[0:3], v[164:167], 0
    s_mov_b32 s21, 319488
    buffer_load_dwordx4 a[0:3], v1, s[68:71], s21 offen offset:0
    s_waitcnt vmcnt(23)
    v_mfma_f32_16x16x32_bf16 v[72:75], a[4:7], v[152:155], 0
    ds_read_b128 v[176:179], v3 offset:37888
    v_mfma_f32_16x16x32_bf16 v[76:79], a[4:7], v[156:159], 0
    ds_read_b128 v[180:183], v4 offset:1024
    v_mfma_f32_16x16x32_bf16 v[80:83], a[4:7], v[160:163], 0
    v_cvt_pk_bf16_f32 v200, v88, v89
    v_mfma_f32_16x16x32_bf16 v[84:87], a[4:7], v[164:167], 0
    buffer_load_dwordx4 a[4:7], v1, s[68:71], s21 offen offset:1024
    s_waitcnt lgkmcnt(0)
    s_waitcnt vmcnt(23)
    v_mfma_f32_16x16x32_bf16 v[56:59], a[8:11], v[168:171], v[56:59]
    v_cvt_pk_bf16_f32 v201, v90, v91
    v_mfma_f32_16x16x32_bf16 v[60:63], a[8:11], v[172:175], v[60:63]
    ds_read_b128 v[152:155], v3 offset:5120
    v_mfma_f32_16x16x32_bf16 v[64:67], a[8:11], v[176:179], v[64:67]
    ds_read_b128 v[156:159], v3 offset:23552
    v_mfma_f32_16x16x32_bf16 v[68:71], a[8:11], v[180:183], v[68:71]
    buffer_load_dwordx4 a[8:11], v1, s[68:71], s21 offen offset:2048
    s_waitcnt vmcnt(23)
    v_mfma_f32_16x16x32_bf16 v[72:75], a[12:15], v[168:171], v[72:75]
    ds_read_b128 v[160:163], v3 offset:41984
    v_mfma_f32_16x16x32_bf16 v[76:79], a[12:15], v[172:175], v[76:79]
    ds_read_b128 v[164:167], v4 offset:5120
    v_mfma_f32_16x16x32_bf16 v[80:83], a[12:15], v[176:179], v[80:83]
    v_cvt_pk_bf16_f32 v202, v104, v105
    v_mfma_f32_16x16x32_bf16 v[84:87], a[12:15], v[180:183], v[84:87]
    buffer_load_dwordx4 a[12:15], v1, s[68:71], s21 offen offset:3072
    s_waitcnt lgkmcnt(0)
    s_waitcnt vmcnt(23)
    v_mfma_f32_16x16x32_bf16 v[56:59], a[16:19], v[152:155], v[56:59]
    v_cvt_pk_bf16_f32 v203, v106, v107
    v_mfma_f32_16x16x32_bf16 v[60:63], a[16:19], v[156:159], v[60:63]
    ds_read_b128 v[168:171], v3 offset:6144
    v_mfma_f32_16x16x32_bf16 v[64:67], a[16:19], v[160:163], v[64:67]
    ds_read_b128 v[172:175], v3 offset:24576
    v_mfma_f32_16x16x32_bf16 v[68:71], a[16:19], v[164:167], v[68:71]
    s_mov_b32 s21, 323584
    buffer_load_dwordx4 a[16:19], v1, s[68:71], s21 offen offset:0
    s_waitcnt vmcnt(23)
    v_mfma_f32_16x16x32_bf16 v[72:75], a[20:23], v[152:155], v[72:75]
    ds_read_b128 v[176:179], v3 offset:43008
    v_mfma_f32_16x16x32_bf16 v[76:79], a[20:23], v[156:159], v[76:79]
    ds_read_b128 v[180:183], v4 offset:6144
    v_mfma_f32_16x16x32_bf16 v[80:83], a[20:23], v[160:163], v[80:83]
    buffer_store_dwordx4 v[200:203], v217, s[16:19], s32 offen offset:512 sc1
    v_mfma_f32_16x16x32_bf16 v[84:87], a[20:23], v[164:167], v[84:87]
    buffer_load_dwordx4 a[20:23], v1, s[68:71], s21 offen offset:1024
    s_waitcnt lgkmcnt(0)
    s_waitcnt vmcnt(24)
    v_mfma_f32_16x16x32_bf16 v[56:59], a[24:27], v[168:171], v[56:59]
    v_cvt_pk_bf16_f32 v204, v92, v93
    v_mfma_f32_16x16x32_bf16 v[60:63], a[24:27], v[172:175], v[60:63]
    ds_read_b128 v[152:155], v3 offset:9216
    v_mfma_f32_16x16x32_bf16 v[64:67], a[24:27], v[176:179], v[64:67]
    ds_read_b128 v[156:159], v3 offset:27648
    v_mfma_f32_16x16x32_bf16 v[68:71], a[24:27], v[180:183], v[68:71]
    buffer_load_dwordx4 a[24:27], v1, s[68:71], s21 offen offset:2048
    s_waitcnt vmcnt(24)
    v_mfma_f32_16x16x32_bf16 v[72:75], a[28:31], v[168:171], v[72:75]
    ds_read_b128 v[160:163], v3 offset:46080
    v_mfma_f32_16x16x32_bf16 v[76:79], a[28:31], v[172:175], v[76:79]
    ds_read_b128 v[164:167], v4 offset:9216
    v_mfma_f32_16x16x32_bf16 v[80:83], a[28:31], v[176:179], v[80:83]
    v_cvt_pk_bf16_f32 v205, v94, v95
    v_mfma_f32_16x16x32_bf16 v[84:87], a[28:31], v[180:183], v[84:87]
    buffer_load_dwordx4 a[28:31], v1, s[68:71], s21 offen offset:3072
    s_waitcnt lgkmcnt(0)
    s_waitcnt vmcnt(24)
    v_mfma_f32_16x16x32_bf16 v[56:59], a[32:35], v[152:155], v[56:59]
    v_cvt_pk_bf16_f32 v206, v108, v109
    v_mfma_f32_16x16x32_bf16 v[60:63], a[32:35], v[156:159], v[60:63]
    ds_read_b128 v[168:171], v3 offset:10240
    v_mfma_f32_16x16x32_bf16 v[64:67], a[32:35], v[160:163], v[64:67]
    ds_read_b128 v[172:175], v3 offset:28672
    v_mfma_f32_16x16x32_bf16 v[68:71], a[32:35], v[164:167], v[68:71]
    s_mov_b32 s21, 327680
    buffer_load_dwordx4 a[32:35], v1, s[68:71], s21 offen offset:0
    s_waitcnt vmcnt(24)
    v_mfma_f32_16x16x32_bf16 v[72:75], a[36:39], v[152:155], v[72:75]
    ds_read_b128 v[176:179], v3 offset:47104
    v_mfma_f32_16x16x32_bf16 v[76:79], a[36:39], v[156:159], v[76:79]
    ds_read_b128 v[180:183], v4 offset:10240
    v_mfma_f32_16x16x32_bf16 v[80:83], a[36:39], v[160:163], v[80:83]
    v_cvt_pk_bf16_f32 v207, v110, v111
    v_mfma_f32_16x16x32_bf16 v[84:87], a[36:39], v[164:167], v[84:87]
    buffer_load_dwordx4 a[36:39], v1, s[68:71], s21 offen offset:1024
    s_waitcnt lgkmcnt(0)
    s_waitcnt vmcnt(24)
    v_mfma_f32_16x16x32_bf16 v[56:59], a[40:43], v[168:171], v[56:59]
    buffer_store_dwordx4 v[204:207], v217, s[16:19], s33 offen offset:512 sc1
    v_mfma_f32_16x16x32_bf16 v[60:63], a[40:43], v[172:175], v[60:63]
    ds_read_b128 v[152:155], v3 offset:14336
    v_mfma_f32_16x16x32_bf16 v[64:67], a[40:43], v[176:179], v[64:67]
    ds_read_b128 v[156:159], v3 offset:32768
    v_mfma_f32_16x16x32_bf16 v[68:71], a[40:43], v[180:183], v[68:71]
    buffer_load_dwordx4 a[40:43], v1, s[68:71], s21 offen offset:2048
    s_waitcnt vmcnt(25)
    v_mfma_f32_16x16x32_bf16 v[72:75], a[44:47], v[168:171], v[72:75]
    ds_read_b128 v[160:163], v3 offset:51200
    v_mfma_f32_16x16x32_bf16 v[76:79], a[44:47], v[172:175], v[76:79]
    ds_read_b128 v[164:167], v4 offset:14336
    v_mfma_f32_16x16x32_bf16 v[80:83], a[44:47], v[176:179], v[80:83]
    v_cvt_pk_bf16_f32 v208, v96, v97
    v_mfma_f32_16x16x32_bf16 v[84:87], a[44:47], v[180:183], v[84:87]
    buffer_load_dwordx4 a[44:47], v1, s[68:71], s21 offen offset:3072
    s_waitcnt lgkmcnt(0)
    s_waitcnt vmcnt(25)
    v_mfma_f32_16x16x32_bf16 v[56:59], a[48:51], v[152:155], v[56:59]
    v_cvt_pk_bf16_f32 v209, v98, v99
    v_mfma_f32_16x16x32_bf16 v[60:63], a[48:51], v[156:159], v[60:63]
    ds_read_b128 v[168:171], v3 offset:15360
    v_mfma_f32_16x16x32_bf16 v[64:67], a[48:51], v[160:163], v[64:67]
    ds_read_b128 v[172:175], v3 offset:33792
    v_mfma_f32_16x16x32_bf16 v[68:71], a[48:51], v[164:167], v[68:71]
    v_cvt_pk_bf16_f32 v210, v112, v113
    s_waitcnt vmcnt(24)
    v_mfma_f32_16x16x32_bf16 v[72:75], a[52:55], v[152:155], v[72:75]
    ds_read_b128 v[176:179], v3 offset:52224
    v_mfma_f32_16x16x32_bf16 v[76:79], a[52:55], v[156:159], v[76:79]
    ds_read_b128 v[180:183], v4 offset:15360
    v_mfma_f32_16x16x32_bf16 v[80:83], a[52:55], v[160:163], v[80:83]
    v_cvt_pk_bf16_f32 v211, v114, v115
    v_mfma_f32_16x16x32_bf16 v[84:87], a[52:55], v[164:167], v[84:87]
    buffer_store_dwordx4 v[208:211], v217, s[16:19], s34 offen offset:512 sc1
    s_waitcnt lgkmcnt(0)
    s_waitcnt vmcnt(24)
    v_mfma_f32_16x16x32_bf16 v[56:59], a[56:59], v[168:171], v[56:59]
    v_cvt_pk_bf16_f32 v212, v100, v101
    v_mfma_f32_16x16x32_bf16 v[60:63], a[56:59], v[172:175], v[60:63]
    ds_read_b128 v[152:155], v3 offset:2048
    v_mfma_f32_16x16x32_bf16 v[64:67], a[56:59], v[176:179], v[64:67]
    ds_read_b128 v[156:159], v3 offset:20480
    v_mfma_f32_16x16x32_bf16 v[68:71], a[56:59], v[180:183], v[68:71]
    v_cvt_pk_bf16_f32 v213, v102, v103
    s_waitcnt vmcnt(23)
    v_mfma_f32_16x16x32_bf16 v[72:75], a[60:63], v[168:171], v[72:75]
    ds_read_b128 v[160:163], v3 offset:38912
    v_mfma_f32_16x16x32_bf16 v[76:79], a[60:63], v[172:175], v[76:79]
    ds_read_b128 v[164:167], v4 offset:2048
    v_mfma_f32_16x16x32_bf16 v[80:83], a[60:63], v[176:179], v[80:83]
    v_cvt_pk_bf16_f32 v214, v116, v117
    v_mfma_f32_16x16x32_bf16 v[84:87], a[60:63], v[180:183], v[84:87]
    v_cvt_pk_bf16_f32 v215, v118, v119
    s_waitcnt lgkmcnt(0)
    s_waitcnt vmcnt(22)
    v_mfma_f32_16x16x32_bf16 v[56:59], a[64:67], v[152:155], v[56:59]
    buffer_store_dwordx4 v[212:215], v217, s[16:19], s35 offen offset:512 sc1
    v_mfma_f32_16x16x32_bf16 v[60:63], a[64:67], v[156:159], v[60:63]
    ds_read_b128 v[168:171], v3 offset:3072
    v_mfma_f32_16x16x32_bf16 v[64:67], a[64:67], v[160:163], v[64:67]
    ds_read_b128 v[172:175], v3 offset:21504
    v_mfma_f32_16x16x32_bf16 v[68:71], a[64:67], v[164:167], v[68:71]
    v_cvt_pk_bf16_f32 v200, v120, v121
    s_waitcnt vmcnt(22)
    v_mfma_f32_16x16x32_bf16 v[72:75], a[68:71], v[152:155], v[72:75]
    ds_read_b128 v[176:179], v3 offset:39936
    v_mfma_f32_16x16x32_bf16 v[76:79], a[68:71], v[156:159], v[76:79]
    ds_read_b128 v[180:183], v4 offset:3072
    v_mfma_f32_16x16x32_bf16 v[80:83], a[68:71], v[160:163], v[80:83]
    v_cvt_pk_bf16_f32 v201, v122, v123
    v_mfma_f32_16x16x32_bf16 v[84:87], a[68:71], v[164:167], v[84:87]
    v_cvt_pk_bf16_f32 v202, v136, v137
    s_waitcnt lgkmcnt(0)
    s_waitcnt vmcnt(21)
    v_mfma_f32_16x16x32_bf16 v[56:59], a[72:75], v[168:171], v[56:59]
    v_cvt_pk_bf16_f32 v203, v138, v139
    v_mfma_f32_16x16x32_bf16 v[60:63], a[72:75], v[172:175], v[60:63]
    ds_read_b128 v[152:155], v3 offset:4096
    v_mfma_f32_16x16x32_bf16 v[64:67], a[72:75], v[176:179], v[64:67]
    ds_read_b128 v[156:159], v3 offset:22528
    v_mfma_f32_16x16x32_bf16 v[68:71], a[72:75], v[180:183], v[68:71]
    buffer_store_dwordx4 v[200:203], v217, s[16:19], s32 offen offset:1024 sc1
    s_waitcnt vmcnt(21)
    v_mfma_f32_16x16x32_bf16 v[72:75], a[76:79], v[168:171], v[72:75]
    ds_read_b128 v[160:163], v3 offset:40960
    v_mfma_f32_16x16x32_bf16 v[76:79], a[76:79], v[172:175], v[76:79]
    ds_read_b128 v[164:167], v4 offset:4096
    v_mfma_f32_16x16x32_bf16 v[80:83], a[76:79], v[176:179], v[80:83]
    v_cvt_pk_bf16_f32 v204, v124, v125
    v_mfma_f32_16x16x32_bf16 v[84:87], a[76:79], v[180:183], v[84:87]
    v_cvt_pk_bf16_f32 v205, v126, v127
    s_waitcnt lgkmcnt(0)
    s_waitcnt vmcnt(20)
    v_mfma_f32_16x16x32_bf16 v[56:59], a[80:83], v[152:155], v[56:59]
    v_cvt_pk_bf16_f32 v206, v140, v141
    v_mfma_f32_16x16x32_bf16 v[60:63], a[80:83], v[156:159], v[60:63]
    ds_read_b128 v[168:171], v3 offset:7168
    v_mfma_f32_16x16x32_bf16 v[64:67], a[80:83], v[160:163], v[64:67]
    ds_read_b128 v[172:175], v3 offset:25600
    v_mfma_f32_16x16x32_bf16 v[68:71], a[80:83], v[164:167], v[68:71]
    v_cvt_pk_bf16_f32 v207, v142, v143
    s_waitcnt vmcnt(19)
    v_mfma_f32_16x16x32_bf16 v[72:75], a[84:87], v[152:155], v[72:75]
    ds_read_b128 v[176:179], v3 offset:44032
    v_mfma_f32_16x16x32_bf16 v[76:79], a[84:87], v[156:159], v[76:79]
    ds_read_b128 v[180:183], v4 offset:7168
    v_mfma_f32_16x16x32_bf16 v[80:83], a[84:87], v[160:163], v[80:83]
    buffer_store_dwordx4 v[204:207], v217, s[16:19], s33 offen offset:1024 sc1
    v_mfma_f32_16x16x32_bf16 v[84:87], a[84:87], v[164:167], v[84:87]
    v_cvt_pk_bf16_f32 v208, v128, v129
    s_waitcnt lgkmcnt(0)
    s_waitcnt vmcnt(19)
    v_mfma_f32_16x16x32_bf16 v[56:59], a[88:91], v[168:171], v[56:59]
    v_cvt_pk_bf16_f32 v209, v130, v131
    v_mfma_f32_16x16x32_bf16 v[60:63], a[88:91], v[172:175], v[60:63]
    ds_read_b128 v[152:155], v3 offset:8192
    v_mfma_f32_16x16x32_bf16 v[64:67], a[88:91], v[176:179], v[64:67]
    ds_read_b128 v[156:159], v3 offset:26624
    v_mfma_f32_16x16x32_bf16 v[68:71], a[88:91], v[180:183], v[68:71]
    v_cvt_pk_bf16_f32 v210, v144, v145
    s_waitcnt vmcnt(18)
    v_mfma_f32_16x16x32_bf16 v[72:75], a[92:95], v[168:171], v[72:75]
    ds_read_b128 v[160:163], v3 offset:45056
    v_mfma_f32_16x16x32_bf16 v[76:79], a[92:95], v[172:175], v[76:79]
    ds_read_b128 v[164:167], v4 offset:8192
    v_mfma_f32_16x16x32_bf16 v[80:83], a[92:95], v[176:179], v[80:83]
    v_cvt_pk_bf16_f32 v211, v146, v147
    v_mfma_f32_16x16x32_bf16 v[84:87], a[92:95], v[180:183], v[84:87]
    buffer_store_dwordx4 v[208:211], v217, s[16:19], s34 offen offset:1024 sc1
    s_waitcnt lgkmcnt(0)
    s_waitcnt vmcnt(18)
    v_mfma_f32_16x16x32_bf16 v[56:59], a[0:3], v[152:155], v[56:59]
    v_cvt_pk_bf16_f32 v212, v132, v133
    v_mfma_f32_16x16x32_bf16 v[60:63], a[0:3], v[156:159], v[60:63]
    ds_read_b128 v[168:171], v3 offset:11264
    v_mfma_f32_16x16x32_bf16 v[64:67], a[0:3], v[160:163], v[64:67]
    ds_read_b128 v[172:175], v3 offset:29696
    v_mfma_f32_16x16x32_bf16 v[68:71], a[0:3], v[164:167], v[68:71]
    v_cvt_pk_bf16_f32 v213, v134, v135
    s_waitcnt vmcnt(17)
    v_mfma_f32_16x16x32_bf16 v[72:75], a[4:7], v[152:155], v[72:75]
    ds_read_b128 v[176:179], v3 offset:48128
    v_mfma_f32_16x16x32_bf16 v[76:79], a[4:7], v[156:159], v[76:79]
    ds_read_b128 v[180:183], v4 offset:11264
    v_mfma_f32_16x16x32_bf16 v[80:83], a[4:7], v[160:163], v[80:83]
    v_cvt_pk_bf16_f32 v214, v148, v149
    v_mfma_f32_16x16x32_bf16 v[84:87], a[4:7], v[164:167], v[84:87]
    v_cvt_pk_bf16_f32 v215, v150, v151
    s_waitcnt lgkmcnt(0)
    s_waitcnt vmcnt(16)
    v_mfma_f32_16x16x32_bf16 v[56:59], a[8:11], v[168:171], v[56:59]
    buffer_store_dwordx4 v[212:215], v217, s[16:19], s35 offen offset:1024 sc1
    v_mfma_f32_16x16x32_bf16 v[60:63], a[8:11], v[172:175], v[60:63]
    ds_read_b128 v[152:155], v3 offset:12288
    v_mfma_f32_16x16x32_bf16 v[64:67], a[8:11], v[176:179], v[64:67]
    ds_read_b128 v[156:159], v3 offset:30720
    v_mfma_f32_16x16x32_bf16 v[68:71], a[8:11], v[180:183], v[68:71]
    s_waitcnt vmcnt(16)
    v_mfma_f32_16x16x32_bf16 v[72:75], a[12:15], v[168:171], v[72:75]
    ds_read_b128 v[160:163], v3 offset:49152
    v_mfma_f32_16x16x32_bf16 v[76:79], a[12:15], v[172:175], v[76:79]
    ds_read_b128 v[164:167], v4 offset:12288
    v_mfma_f32_16x16x32_bf16 v[80:83], a[12:15], v[176:179], v[80:83]
    v_mfma_f32_16x16x32_bf16 v[84:87], a[12:15], v[180:183], v[84:87]
    s_waitcnt lgkmcnt(0)
    s_waitcnt vmcnt(15)
    v_mfma_f32_16x16x32_bf16 v[56:59], a[16:19], v[152:155], v[56:59]
    v_mfma_f32_16x16x32_bf16 v[60:63], a[16:19], v[156:159], v[60:63]
    ds_read_b128 v[168:171], v3 offset:13312
    v_mfma_f32_16x16x32_bf16 v[64:67], a[16:19], v[160:163], v[64:67]
    ds_read_b128 v[172:175], v3 offset:31744
    v_mfma_f32_16x16x32_bf16 v[68:71], a[16:19], v[164:167], v[68:71]
    s_waitcnt vmcnt(13)
    v_mfma_f32_16x16x32_bf16 v[72:75], a[20:23], v[152:155], v[72:75]
    ds_read_b128 v[176:179], v3 offset:50176
    v_mfma_f32_16x16x32_bf16 v[76:79], a[20:23], v[156:159], v[76:79]
    ds_read_b128 v[180:183], v4 offset:13312
    v_mfma_f32_16x16x32_bf16 v[80:83], a[20:23], v[160:163], v[80:83]
    v_mfma_f32_16x16x32_bf16 v[84:87], a[20:23], v[164:167], v[84:87]
    s_waitcnt lgkmcnt(0)
    s_waitcnt vmcnt(12)
    v_mfma_f32_16x16x32_bf16 v[56:59], a[24:27], v[168:171], v[56:59]
    v_mfma_f32_16x16x32_bf16 v[60:63], a[24:27], v[172:175], v[60:63]
    ds_read_b128 v[152:155], v3 offset:16384
    v_mfma_f32_16x16x32_bf16 v[64:67], a[24:27], v[176:179], v[64:67]
    ds_read_b128 v[156:159], v3 offset:34816
    v_mfma_f32_16x16x32_bf16 v[68:71], a[24:27], v[180:183], v[68:71]
    s_waitcnt vmcnt(11)
    v_mfma_f32_16x16x32_bf16 v[72:75], a[28:31], v[168:171], v[72:75]
    ds_read_b128 v[160:163], v3 offset:53248
    v_mfma_f32_16x16x32_bf16 v[76:79], a[28:31], v[172:175], v[76:79]
    ds_read_b128 v[164:167], v4 offset:16384
    v_mfma_f32_16x16x32_bf16 v[80:83], a[28:31], v[176:179], v[80:83]
    v_mfma_f32_16x16x32_bf16 v[84:87], a[28:31], v[180:183], v[84:87]
    s_waitcnt lgkmcnt(0)
    s_waitcnt vmcnt(10)
    v_mfma_f32_16x16x32_bf16 v[56:59], a[32:35], v[152:155], v[56:59]
    v_mfma_f32_16x16x32_bf16 v[60:63], a[32:35], v[156:159], v[60:63]
    ds_read_b128 v[168:171], v3 offset:17408
    v_mfma_f32_16x16x32_bf16 v[64:67], a[32:35], v[160:163], v[64:67]
    ds_read_b128 v[172:175], v3 offset:35840
    v_mfma_f32_16x16x32_bf16 v[68:71], a[32:35], v[164:167], v[68:71]
    s_waitcnt vmcnt(9)
    v_mfma_f32_16x16x32_bf16 v[72:75], a[36:39], v[152:155], v[72:75]
    ds_read_b128 v[176:179], v3 offset:54272
    v_mfma_f32_16x16x32_bf16 v[76:79], a[36:39], v[156:159], v[76:79]
    ds_read_b128 v[180:183], v4 offset:17408
    v_mfma_f32_16x16x32_bf16 v[80:83], a[36:39], v[160:163], v[80:83]
    v_mfma_f32_16x16x32_bf16 v[84:87], a[36:39], v[164:167], v[84:87]
    s_waitcnt lgkmcnt(0)
    s_waitcnt vmcnt(7)
    v_mfma_f32_16x16x32_bf16 v[56:59], a[40:43], v[168:171], v[56:59]
    v_mfma_f32_16x16x32_bf16 v[60:63], a[40:43], v[172:175], v[60:63]
    v_mfma_f32_16x16x32_bf16 v[64:67], a[40:43], v[176:179], v[64:67]
    v_mfma_f32_16x16x32_bf16 v[68:71], a[40:43], v[180:183], v[68:71]
    s_waitcnt vmcnt(6)
    v_mfma_f32_16x16x32_bf16 v[72:75], a[44:47], v[168:171], v[72:75]
    v_mfma_f32_16x16x32_bf16 v[76:79], a[44:47], v[172:175], v[76:79]
    v_mfma_f32_16x16x32_bf16 v[80:83], a[44:47], v[176:179], v[80:83]
    v_mfma_f32_16x16x32_bf16 v[84:87], a[44:47], v[180:183], v[84:87]
    s_cmp_eq_u32 s75, 0
    s_cbranch_scc1 sf_kernel_tl
    s_nop 7
    v_cvt_pk_bf16_f32 v200, v56, v57
    v_cvt_pk_bf16_f32 v201, v58, v59
    v_cvt_pk_bf16_f32 v202, v72, v73
    v_cvt_pk_bf16_f32 v203, v74, v75
    buffer_store_dwordx4 v[200:203], v217, s[16:19], s32 offen offset:1536 sc1
    v_cvt_pk_bf16_f32 v204, v60, v61
    v_cvt_pk_bf16_f32 v205, v62, v63
    v_cvt_pk_bf16_f32 v206, v76, v77
    v_cvt_pk_bf16_f32 v207, v78, v79
    buffer_store_dwordx4 v[204:207], v217, s[16:19], s33 offen offset:1536 sc1
    v_cvt_pk_bf16_f32 v208, v64, v65
    v_cvt_pk_bf16_f32 v209, v66, v67
    v_cvt_pk_bf16_f32 v210, v80, v81
    v_cvt_pk_bf16_f32 v211, v82, v83
    buffer_store_dwordx4 v[208:211], v217, s[16:19], s34 offen offset:1536 sc1
    v_cvt_pk_bf16_f32 v212, v68, v69
    v_cvt_pk_bf16_f32 v213, v70, v71
    v_cvt_pk_bf16_f32 v214, v84, v85
    v_cvt_pk_bf16_f32 v215, v86, v87
    buffer_store_dwordx4 v[212:215], v217, s[16:19], s35 offen offset:1536 sc1
sf_kernel_end:
    s_endpgm
sf_kernel_tl:
    s_lshl_b32 s21, s7, 3
    s_add_u32 s21, s21, s6
    s_lshr_b32 s22, s21, 1
    s_mul_i32 s22, s22, 18432
    s_and_b32 s24, s21, 1
    s_lshl_b32 s24, s24, 7
    s_add_u32 s22, s22, s24
    v_and_b32 v2, 7, v0
    v_lshrrev_b32 v3, 3, v0
    v_lshlrev_b32 v4, 8, v3
    v_lshl_add_u32 v4, v2, 4, v4
    s_add_u32 s24, s22, 8192
    s_add_u32 s25, s22, 16384
    s_cmp_eq_u32 s20, 0
    s_cselect_b32 s25, s25, s24
    buffer_load_dwordx4 v[88:91], v4, s[12:15], s22 offen
    buffer_load_dwordx4 v[92:95], v4, s[12:15], s24 offen
    buffer_load_dwordx4 v[96:99], v4, s[12:15], s25 offen
    v_cvt_pk_bf16_f32 v200, v56, v57
    v_cvt_pk_bf16_f32 v201, v58, v59
    v_cvt_pk_bf16_f32 v202, v72, v73
    v_cvt_pk_bf16_f32 v203, v74, v75
    buffer_store_dwordx4 v[200:203], v217, s[16:19], s32 offen offset:1536 sc1
    v_cvt_pk_bf16_f32 v204, v60, v61
    v_cvt_pk_bf16_f32 v205, v62, v63
    v_cvt_pk_bf16_f32 v206, v76, v77
    v_cvt_pk_bf16_f32 v207, v78, v79
    buffer_store_dwordx4 v[204:207], v217, s[16:19], s33 offen offset:1536 sc1
    v_cvt_pk_bf16_f32 v208, v64, v65
    v_cvt_pk_bf16_f32 v209, v66, v67
    v_cvt_pk_bf16_f32 v210, v80, v81
    v_cvt_pk_bf16_f32 v211, v82, v83
    buffer_store_dwordx4 v[208:211], v217, s[16:19], s34 offen offset:1536 sc1
    v_cvt_pk_bf16_f32 v212, v68, v69
    v_cvt_pk_bf16_f32 v213, v70, v71
    v_cvt_pk_bf16_f32 v214, v84, v85
    v_cvt_pk_bf16_f32 v215, v86, v87
    buffer_store_dwordx4 v[212:215], v217, s[16:19], s35 offen offset:1536 sc1
    s_waitcnt vmcnt(4)
    s_mov_b32 s26, 0xffff0000
    s_cselect_b32 s27, 1.0, 0
    v_lshlrev_b32 v100, 16, v88
    v_and_b32 v101, s26, v88
    v_lshlrev_b32 v102, 16, v89
    v_and_b32 v103, s26, v89
    v_lshlrev_b32 v104, 16, v90
    v_and_b32 v105, s26, v90
    v_lshlrev_b32 v106, 16, v91
    v_and_b32 v107, s26, v91
    v_lshlrev_b32 v108, 16, v92
    v_and_b32 v109, s26, v92
    v_lshlrev_b32 v110, 16, v93
    v_and_b32 v111, s26, v93
    v_lshlrev_b32 v112, 16, v94
    v_and_b32 v113, s26, v94
    v_lshlrev_b32 v114, 16, v95
    v_and_b32 v115, s26, v95
    v_lshlrev_b32 v116, 16, v96
    v_and_b32 v117, s26, v96
    v_lshlrev_b32 v118, 16, v97
    v_and_b32 v119, s26, v97
    v_lshlrev_b32 v120, 16, v98
    v_and_b32 v121, s26, v98
    v_lshlrev_b32 v122, 16, v99
    v_and_b32 v123, s26, v99
    v_pk_add_f32 v[88:89], v[116:117], v[118:119]
    v_pk_mul_f32 v[90:91], v[116:117], v[116:117]
    v_pk_add_f32 v[88:89], v[88:89], v[120:121]
    v_pk_add_f32 v[88:89], v[88:89], v[122:123]
    v_pk_fma_f32 v[90:91], v[118:119], v[118:119], v[90:91]
    v_pk_fma_f32 v[90:91], v[120:121], v[120:121], v[90:91]
    v_pk_fma_f32 v[90:91], v[122:123], v[122:123], v[90:91]
    v_pk_mul_f32 v[88:89], s[26:27], v[88:89] op_sel:[1,0] op_sel_hi:[1,1]
    v_pk_mul_f32 v[90:91], s[26:27], v[90:91] op_sel:[1,0] op_sel_hi:[1,1]
    v_pk_add_f32 v[88:89], v[88:89], v[100:101]
    v_pk_fma_f32 v[90:91], v[100:101], v[100:101], v[90:91]
    v_pk_add_f32 v[88:89], v[88:89], v[102:103]
    v_pk_fma_f32 v[90:91], v[102:103], v[102:103], v[90:91]
    v_pk_add_f32 v[88:89], v[88:89], v[104:105]
    v_pk_fma_f32 v[90:91], v[104:105], v[104:105], v[90:91]
    v_pk_add_f32 v[88:89], v[88:89], v[106:107]
    v_pk_fma_f32 v[90:91], v[106:107], v[106:107], v[90:91]
    v_pk_add_f32 v[88:89], v[88:89], v[108:109]
    v_pk_fma_f32 v[90:91], v[108:109], v[108:109], v[90:91]
    v_pk_add_f32 v[88:89], v[88:89], v[110:111]
    v_pk_fma_f32 v[90:91], v[110:111], v[110:111], v[90:91]
    v_pk_add_f32 v[88:89], v[88:89], v[112:113]
    v_pk_fma_f32 v[90:91], v[112:113], v[112:113], v[90:91]
    v_pk_add_f32 v[88:89], v[88:89], v[114:115]
    v_pk_fma_f32 v[90:91], v[114:115], v[114:115], v[90:91]
    v_add_f32 v88, v88, v89
    v_add_f32 v89, v90, v91
    v_bfe_u32 v5, v0, 5, 1
    v_lshl_add_u32 v5, v5, 3, v2
    v_permlane32_swap_b32 v88, v89
    v_add_f32 v88, v88, v89
    v_mov_b32 v89, v88
    s_lshl_b32 s28, s20, 2
    v_lshl_add_u32 v5, v5, 4, s28
    v_permlane16_swap_b32 v88, v89
    v_add_f32 v88, v88, v89
    s_nop 1
    v_add_f32_dpp v88, v88, v88 row_ror:8 row_mask:0xf bank_mask:0xf
    ds_write_b32 v5, v88 offset:16384
    s_lshl_b32 s28, s7, 5
    s_lshl_b32 s29, s6, 2
    s_add_u32 s29, s29, s28
    s_add_u32 s29, s29, 2048
    v_mov_b32 v90, 1
    v_mov_b32 v91, 0
    s_waitcnt vmcnt(0) lgkmcnt(0)
    s_barrier
    s_cmp_lg_u32 s20, 0
    s_cbranch_scc1 sf_kernel_tf
    s_mov_b64 exec, 1
    buffer_store_dword v90, v91, s[44:47], s29 offen sc0 sc1
    s_mov_b64 exec, -1
sf_kernel_tf:
    v_lshlrev_b32 v5, 4, v2
    ds_read_b128 v[88:91], v5 offset:16384
    ds_read_b128 v[92:95], v5 offset:16512
    s_and_b32 s23, s21, 127
    s_lshl_b32 s23, s23, 2
    s_lshr_b32 s24, s21, 7
    s_add_u32 s23, s23, s24
    v_and_b32 v5, 1, v2
    v_lshl_add_u32 v5, v5, 1, s23
    v_lshrrev_b32 v6, 1, v2
    v_sub_u32 v7, 0, v5
    v_add_u32 v96, 1, v6
    v_and_b32 v96, 2, v96
    v_cmp_ne_u32 vcc, 0, v96
    v_mov_b32 v97, 1024
    v_lshlrev_b32 v96, 10, v6
    v_cndmask_b32 v7, v5, v7, vcc
    v_cmp_eq_u32 vcc, 3, v6
    s_nop 1
    v_cndmask_b32 v96, v96, v97, vcc
    v_add_u32 v7, v7, v96
    v_cmp_eq_u32 vcc, 0, v5
    v_lshlrev_b32 v96, 9, v6
    s_nop 0
    v_cndmask_b32 v7, v7, v96, vcc
    v_mul_u32_u24 v7, 1152, v7
    v_lshl_add_u32 v7, v3, 4, v7
    v_mul_u32_u24 v6, 1168, v2
    v_add_u32 v5, 0, v3
    v_lshlrev_b32 v124, 3, v5
    v_cmp_le_u32 vcc, 36, v5
    v_subrev_u32 v125, 287, v124
    v_mov_b32 v96, 288
    v_cndmask_b32 v124, v124, v125, vcc
    v_cmp_eq_u32 vcc, 0, v5
    v_sub_u32 v125, 570, v124
    v_sub_u32 v127, 576, v124
    v_mov_b32 v97, 0
    v_cndmask_b32 v126, v124, v96, vcc
    v_cndmask_b32 v127, v127, v97, vcc
    v_lshl_add_u32 v124, v124, 1, v6
    v_lshl_add_u32 v125, v125, 1, v6
    v_lshl_add_u32 v126, v126, 1, v6
    v_lshl_add_u32 v127, v127, 1, v6
    v_add_u32 v5, 32, v3
    v_lshlrev_b32 v128, 3, v5
    v_cmp_le_u32 vcc, 36, v5
    v_subrev_u32 v129, 287, v128
    v_mov_b32 v96, 288
    v_cndmask_b32 v128, v128, v129, vcc
    v_cmp_eq_u32 vcc, 0, v5
    v_sub_u32 v129, 570, v128
    v_sub_u32 v131, 576, v128
    v_mov_b32 v97, 0
    v_cndmask_b32 v130, v128, v96, vcc
    v_cndmask_b32 v131, v131, v97, vcc
    v_lshl_add_u32 v128, v128, 1, v6
    v_lshl_add_u32 v129, v129, 1, v6
    v_lshl_add_u32 v130, v130, 1, v6
    v_lshl_add_u32 v131, v131, 1, v6
    v_add_u32 v5, 64, v3
    v_lshlrev_b32 v132, 3, v5
    v_cmp_le_u32 vcc, 36, v5
    v_subrev_u32 v133, 287, v132
    v_mov_b32 v96, 288
    v_cndmask_b32 v132, v132, v133, vcc
    v_cmp_eq_u32 vcc, 0, v5
    v_sub_u32 v133, 570, v132
    v_sub_u32 v135, 576, v132
    v_mov_b32 v97, 0
    v_cndmask_b32 v134, v132, v96, vcc
    v_cndmask_b32 v135, v135, v97, vcc
    v_lshl_add_u32 v132, v132, 1, v6
    v_lshl_add_u32 v133, v133, 1, v6
    v_lshl_add_u32 v134, v134, 1, v6
    v_lshl_add_u32 v135, v135, 1, v6
    v_lshl_add_u32 v6, v3, 4, v6
    s_mov_b32 s30, 0x3ae38e39
    s_waitcnt lgkmcnt(0)
    v_pk_add_f32 v[88:89], v[88:89], v[90:91]
    v_pk_add_f32 v[92:93], v[92:93], v[94:95]
    v_add_f32 v88, v88, v89
    v_add_f32 v92, v92, v93
    v_mul_f32 v88, s30, v88
    v_mul_f32 v92, s30, v92
    v_fma_f32 v92, -v88, v88, v92
    v_max_f32 v92, 0, v92
    v_add_f32 v92, 0x3727c5ac, v92
    v_rsq_f32 v92, v92
    v_and_b32 v5, 7, v0
    v_lshl_add_u32 v5, v5, 2, s28
    v_lshlrev_b32 v4, 4, v0
    s_mul_i32 s21, s21, 9216
    s_add_u32 s8, s4, 217843712
    s_addc_u32 s9, s5, 0
    s_mov_b32 s10, 18874368
    s_mov_b32 s11, 0x20000
    s_mov_b32 s16, s66
    s_mov_b32 s17, s67
    s_mov_b32 s18, 2359296
    s_mov_b32 s19, 0x20000
    s_mov_b64 exec, 0xff
sf_kernel_tp:
    buffer_load_dword v88, v5, s[44:47], 0 offen offset:2048 sc0 sc1
    s_waitcnt vmcnt(0)
    v_cmp_ne_u32 vcc, 1, v88
    s_sub_u32 s41, s41, 1
    s_cbranch_scc1 sf_kernel_td
    s_cmp_eq_u32 vcc_lo, 0
    s_cbranch_scc0 sf_kernel_tp
sf_kernel_td:
    s_mov_b64 exec, -1
    s_mov_b32 s28, 0x3f80
    s_mov_b32 s29, 0x3f800000
    s_cmp_lg_u32 s20, 0
    s_cbranch_scc1 sf_kernel_t1
    s_add_u32 s22, s21, 8192
    buffer_load_dwordx4 v[152:155], v4, s[8:11], s22 offen sc1
    s_add_u32 s22, s21, 2367488
    buffer_load_dwordx4 v[156:159], v4, s[8:11], s22 offen sc1
    s_add_u32 s22, s21, 4726784
    buffer_load_dwordx4 v[160:163], v4, s[8:11], s22 offen sc1
    s_add_u32 s22, s21, 7086080
    buffer_load_dwordx4 v[164:167], v4, s[8:11], s22 offen sc1
    s_add_u32 s22, s21, 9445376
    buffer_load_dwordx4 v[168:171], v4, s[8:11], s22 offen sc1
    s_add_u32 s22, s21, 11804672
    buffer_load_dwordx4 v[172:175], v4, s[8:11], s22 offen sc1
    s_add_u32 s22, s21, 14163968
    buffer_load_dwordx4 v[176:179], v4, s[8:11], s22 offen sc1
    s_add_u32 s22, s21, 16523264
    buffer_load_dwordx4 v[180:183], v4, s[8:11], s22 offen sc1
sf_kernel_t1:
    s_add_u32 s22, s21, 0
    buffer_load_dwordx4 v[8:11], v4, s[8:11], s22 offen sc1
    s_add_u32 s22, s21, 2359296
    buffer_load_dwordx4 v[12:15], v4, s[8:11], s22 offen sc1
    s_add_u32 s22, s21, 4718592
    buffer_load_dwordx4 v[16:19], v4, s[8:11], s22 offen sc1
    s_add_u32 s22, s21, 7077888
    buffer_load_dwordx4 v[20:23], v4, s[8:11], s22 offen sc1
    s_add_u32 s22, s21, 9437184
    buffer_load_dwordx4 v[24:27], v4, s[8:11], s22 offen sc1
    s_add_u32 s22, s21, 11796480
    buffer_load_dwordx4 v[28:31], v4, s[8:11], s22 offen sc1
    s_add_u32 s22, s21, 14155776
    buffer_load_dwordx4 v[32:35], v4, s[8:11], s22 offen sc1
    s_add_u32 s22, s21, 16515072
    buffer_load_dwordx4 v[36:39], v4, s[8:11], s22 offen sc1
    s_add_u32 s22, s21, 4096
    buffer_load_dwordx4 v[40:43], v4, s[8:11], s22 offen sc1
    s_add_u32 s22, s21, 2363392
    buffer_load_dwordx4 v[44:47], v4, s[8:11], s22 offen sc1
    s_add_u32 s22, s21, 4722688
    buffer_load_dwordx4 v[48:51], v4, s[8:11], s22 offen sc1
    s_add_u32 s22, s21, 7081984
    buffer_load_dwordx4 v[52:55], v4, s[8:11], s22 offen sc1
    s_add_u32 s22, s21, 9441280
    buffer_load_dwordx4 v[56:59], v4, s[8:11], s22 offen sc1
    s_add_u32 s22, s21, 11800576
    buffer_load_dwordx4 v[60:63], v4, s[8:11], s22 offen sc1
    s_add_u32 s22, s21, 14159872
    buffer_load_dwordx4 v[64:67], v4, s[8:11], s22 offen sc1
    s_add_u32 s22, s21, 16519168
    buffer_load_dwordx4 v[68:71], v4, s[8:11], s22 offen sc1
    s_cmp_lg_u32 s20, 0
    s_cbranch_scc1 sf_kernel_t2
    s_waitcnt vmcnt(23)
    v_dot2_f32_bf16 v136, v152, s28, 0
    v_dot2_f32_bf16 v137, v152, s29, 0
    v_dot2_f32_bf16 v138, v153, s28, 0
    v_dot2_f32_bf16 v139, v153, s29, 0
    v_dot2_f32_bf16 v140, v154, s28, 0
    v_dot2_f32_bf16 v141, v154, s29, 0
    v_dot2_f32_bf16 v142, v155, s28, 0
    v_dot2_f32_bf16 v143, v155, s29, 0
    s_waitcnt vmcnt(22)
    v_dot2_f32_bf16 v136, v156, s28, v136
    v_dot2_f32_bf16 v137, v156, s29, v137
    v_dot2_f32_bf16 v138, v157, s28, v138
    v_dot2_f32_bf16 v139, v157, s29, v139
    v_dot2_f32_bf16 v140, v158, s28, v140
    v_dot2_f32_bf16 v141, v158, s29, v141
    v_dot2_f32_bf16 v142, v159, s28, v142
    v_dot2_f32_bf16 v143, v159, s29, v143
    s_waitcnt vmcnt(21)
    v_dot2_f32_bf16 v136, v160, s28, v136
    v_dot2_f32_bf16 v137, v160, s29, v137
    v_dot2_f32_bf16 v138, v161, s28, v138
    v_dot2_f32_bf16 v139, v161, s29, v139
    v_dot2_f32_bf16 v140, v162, s28, v140
    v_dot2_f32_bf16 v141, v162, s29, v141
    v_dot2_f32_bf16 v142, v163, s28, v142
    v_dot2_f32_bf16 v143, v163, s29, v143
    s_waitcnt vmcnt(20)
    v_dot2_f32_bf16 v136, v164, s28, v136
    v_dot2_f32_bf16 v137, v164, s29, v137
    v_dot2_f32_bf16 v138, v165, s28, v138
    v_dot2_f32_bf16 v139, v165, s29, v139
    v_dot2_f32_bf16 v140, v166, s28, v140
    v_dot2_f32_bf16 v141, v166, s29, v141
    v_dot2_f32_bf16 v142, v167, s28, v142
    v_dot2_f32_bf16 v143, v167, s29, v143
    s_waitcnt vmcnt(19)
    v_dot2_f32_bf16 v136, v168, s28, v136
    v_dot2_f32_bf16 v137, v168, s29, v137
    v_dot2_f32_bf16 v138, v169, s28, v138
    v_dot2_f32_bf16 v139, v169, s29, v139
    v_dot2_f32_bf16 v140, v170, s28, v140
    v_dot2_f32_bf16 v141, v170, s29, v141
    v_dot2_f32_bf16 v142, v171, s28, v142
    v_dot2_f32_bf16 v143, v171, s29, v143
    s_waitcnt vmcnt(18)
    v_dot2_f32_bf16 v136, v172, s28, v136
    v_dot2_f32_bf16 v137, v172, s29, v137
    v_dot2_f32_bf16 v138, v173, s28, v138
    v_dot2_f32_bf16 v139, v173, s29, v139
    v_dot2_f32_bf16 v140, v174, s28, v140
    v_dot2_f32_bf16 v141, v174, s29, v141
    v_dot2_f32_bf16 v142, v175, s28, v142
    v_dot2_f32_bf16 v143, v175, s29, v143
    s_waitcnt vmcnt(17)
    v_dot2_f32_bf16 v136, v176, s28, v136
    v_dot2_f32_bf16 v137, v176, s29, v137
    v_dot2_f32_bf16 v138, v177, s28, v138
    v_dot2_f32_bf16 v139, v177, s29, v139
    v_dot2_f32_bf16 v140, v178, s28, v140
    v_dot2_f32_bf16 v141, v178, s29, v141
    v_dot2_f32_bf16 v142, v179, s28, v142
    v_dot2_f32_bf16 v143, v179, s29, v143
    s_waitcnt vmcnt(16)
    v_dot2_f32_bf16 v136, v180, s28, v136
    v_dot2_f32_bf16 v137, v180, s29, v137
    v_dot2_f32_bf16 v138, v181, s28, v138
    v_dot2_f32_bf16 v139, v181, s29, v139
    v_dot2_f32_bf16 v140, v182, s28, v140
    v_dot2_f32_bf16 v141, v182, s29, v141
    v_dot2_f32_bf16 v142, v183, s28, v142
    v_dot2_f32_bf16 v143, v183, s29, v143
    s_nop 2
    v_pk_fma_f32 v[136:137], v[136:137], v[92:93], v[116:117] op_sel_hi:[1,0,1]
    v_pk_fma_f32 v[138:139], v[138:139], v[92:93], v[118:119] op_sel_hi:[1,0,1]
    v_pk_fma_f32 v[140:141], v[140:141], v[92:93], v[120:121] op_sel_hi:[1,0,1]
    v_pk_fma_f32 v[142:143], v[142:143], v[92:93], v[122:123] op_sel_hi:[1,0,1]
    v_cvt_pk_bf16_f32 v144, v136, v137
    v_cvt_pk_bf16_f32 v145, v138, v139
    v_cvt_pk_bf16_f32 v146, v140, v141
    v_cvt_pk_bf16_f32 v147, v142, v143
    ds_write_b16 v134, v144 offset:20480
    ds_write_b16_d16_hi v132, v144 offset:20484
    ds_write_b16 v132, v145 offset:20488
    ds_write_b16_d16_hi v132, v145 offset:20492
    ds_write_b16 v135, v146 offset:20480
    ds_write_b16_d16_hi v133, v146 offset:20488
    ds_write_b16 v133, v147 offset:20484
    ds_write_b16_d16_hi v133, v147 offset:20480
sf_kernel_t2:
    s_waitcnt vmcnt(15)
    v_dot2_f32_bf16 v136, v8, s28, 0
    v_dot2_f32_bf16 v137, v8, s29, 0
    v_dot2_f32_bf16 v138, v9, s28, 0
    v_dot2_f32_bf16 v139, v9, s29, 0
    v_dot2_f32_bf16 v140, v10, s28, 0
    v_dot2_f32_bf16 v141, v10, s29, 0
    v_dot2_f32_bf16 v142, v11, s28, 0
    v_dot2_f32_bf16 v143, v11, s29, 0
    s_waitcnt vmcnt(14)
    v_dot2_f32_bf16 v136, v12, s28, v136
    v_dot2_f32_bf16 v137, v12, s29, v137
    v_dot2_f32_bf16 v138, v13, s28, v138
    v_dot2_f32_bf16 v139, v13, s29, v139
    v_dot2_f32_bf16 v140, v14, s28, v140
    v_dot2_f32_bf16 v141, v14, s29, v141
    v_dot2_f32_bf16 v142, v15, s28, v142
    v_dot2_f32_bf16 v143, v15, s29, v143
    s_waitcnt vmcnt(13)
    v_dot2_f32_bf16 v136, v16, s28, v136
    v_dot2_f32_bf16 v137, v16, s29, v137
    v_dot2_f32_bf16 v138, v17, s28, v138
    v_dot2_f32_bf16 v139, v17, s29, v139
    v_dot2_f32_bf16 v140, v18, s28, v140
    v_dot2_f32_bf16 v141, v18, s29, v141
    v_dot2_f32_bf16 v142, v19, s28, v142
    v_dot2_f32_bf16 v143, v19, s29, v143
    s_waitcnt vmcnt(12)
    v_dot2_f32_bf16 v136, v20, s28, v136
    v_dot2_f32_bf16 v137, v20, s29, v137
    v_dot2_f32_bf16 v138, v21, s28, v138
    v_dot2_f32_bf16 v139, v21, s29, v139
    v_dot2_f32_bf16 v140, v22, s28, v140
    v_dot2_f32_bf16 v141, v22, s29, v141
    v_dot2_f32_bf16 v142, v23, s28, v142
    v_dot2_f32_bf16 v143, v23, s29, v143
    s_waitcnt vmcnt(11)
    v_dot2_f32_bf16 v136, v24, s28, v136
    v_dot2_f32_bf16 v137, v24, s29, v137
    v_dot2_f32_bf16 v138, v25, s28, v138
    v_dot2_f32_bf16 v139, v25, s29, v139
    v_dot2_f32_bf16 v140, v26, s28, v140
    v_dot2_f32_bf16 v141, v26, s29, v141
    v_dot2_f32_bf16 v142, v27, s28, v142
    v_dot2_f32_bf16 v143, v27, s29, v143
    s_waitcnt vmcnt(10)
    v_dot2_f32_bf16 v136, v28, s28, v136
    v_dot2_f32_bf16 v137, v28, s29, v137
    v_dot2_f32_bf16 v138, v29, s28, v138
    v_dot2_f32_bf16 v139, v29, s29, v139
    v_dot2_f32_bf16 v140, v30, s28, v140
    v_dot2_f32_bf16 v141, v30, s29, v141
    v_dot2_f32_bf16 v142, v31, s28, v142
    v_dot2_f32_bf16 v143, v31, s29, v143
    s_waitcnt vmcnt(9)
    v_dot2_f32_bf16 v136, v32, s28, v136
    v_dot2_f32_bf16 v137, v32, s29, v137
    v_dot2_f32_bf16 v138, v33, s28, v138
    v_dot2_f32_bf16 v139, v33, s29, v139
    v_dot2_f32_bf16 v140, v34, s28, v140
    v_dot2_f32_bf16 v141, v34, s29, v141
    v_dot2_f32_bf16 v142, v35, s28, v142
    v_dot2_f32_bf16 v143, v35, s29, v143
    s_waitcnt vmcnt(8)
    v_dot2_f32_bf16 v136, v36, s28, v136
    v_dot2_f32_bf16 v137, v36, s29, v137
    v_dot2_f32_bf16 v138, v37, s28, v138
    v_dot2_f32_bf16 v139, v37, s29, v139
    v_dot2_f32_bf16 v140, v38, s28, v140
    v_dot2_f32_bf16 v141, v38, s29, v141
    v_dot2_f32_bf16 v142, v39, s28, v142
    v_dot2_f32_bf16 v143, v39, s29, v143
    s_nop 2
    v_pk_fma_f32 v[136:137], v[136:137], v[92:93], v[100:101] op_sel_hi:[1,0,1]
    v_pk_fma_f32 v[138:139], v[138:139], v[92:93], v[102:103] op_sel_hi:[1,0,1]
    v_pk_fma_f32 v[140:141], v[140:141], v[92:93], v[104:105] op_sel_hi:[1,0,1]
    v_pk_fma_f32 v[142:143], v[142:143], v[92:93], v[106:107] op_sel_hi:[1,0,1]
    v_cvt_pk_bf16_f32 v144, v136, v137
    v_cvt_pk_bf16_f32 v145, v138, v139
    v_cvt_pk_bf16_f32 v146, v140, v141
    v_cvt_pk_bf16_f32 v147, v142, v143
    ds_write_b16 v126, v144 offset:20480
    ds_write_b16_d16_hi v124, v144 offset:20484
    ds_write_b16 v124, v145 offset:20488
    ds_write_b16_d16_hi v124, v145 offset:20492
    ds_write_b16 v127, v146 offset:20480
    ds_write_b16_d16_hi v125, v146 offset:20488
    ds_write_b16 v125, v147 offset:20484
    ds_write_b16_d16_hi v125, v147 offset:20480
    s_waitcnt vmcnt(7)
    v_dot2_f32_bf16 v136, v40, s28, 0
    v_dot2_f32_bf16 v137, v40, s29, 0
    v_dot2_f32_bf16 v138, v41, s28, 0
    v_dot2_f32_bf16 v139, v41, s29, 0
    v_dot2_f32_bf16 v140, v42, s28, 0
    v_dot2_f32_bf16 v141, v42, s29, 0
    v_dot2_f32_bf16 v142, v43, s28, 0
    v_dot2_f32_bf16 v143, v43, s29, 0
    s_waitcnt vmcnt(6)
    v_dot2_f32_bf16 v136, v44, s28, v136
    v_dot2_f32_bf16 v137, v44, s29, v137
    v_dot2_f32_bf16 v138, v45, s28, v138
    v_dot2_f32_bf16 v139, v45, s29, v139
    v_dot2_f32_bf16 v140, v46, s28, v140
    v_dot2_f32_bf16 v141, v46, s29, v141
    v_dot2_f32_bf16 v142, v47, s28, v142
    v_dot2_f32_bf16 v143, v47, s29, v143
    s_waitcnt vmcnt(5)
    v_dot2_f32_bf16 v136, v48, s28, v136
    v_dot2_f32_bf16 v137, v48, s29, v137
    v_dot2_f32_bf16 v138, v49, s28, v138
    v_dot2_f32_bf16 v139, v49, s29, v139
    v_dot2_f32_bf16 v140, v50, s28, v140
    v_dot2_f32_bf16 v141, v50, s29, v141
    v_dot2_f32_bf16 v142, v51, s28, v142
    v_dot2_f32_bf16 v143, v51, s29, v143
    s_waitcnt vmcnt(4)
    v_dot2_f32_bf16 v136, v52, s28, v136
    v_dot2_f32_bf16 v137, v52, s29, v137
    v_dot2_f32_bf16 v138, v53, s28, v138
    v_dot2_f32_bf16 v139, v53, s29, v139
    v_dot2_f32_bf16 v140, v54, s28, v140
    v_dot2_f32_bf16 v141, v54, s29, v141
    v_dot2_f32_bf16 v142, v55, s28, v142
    v_dot2_f32_bf16 v143, v55, s29, v143
    s_waitcnt vmcnt(3)
    v_dot2_f32_bf16 v136, v56, s28, v136
    v_dot2_f32_bf16 v137, v56, s29, v137
    v_dot2_f32_bf16 v138, v57, s28, v138
    v_dot2_f32_bf16 v139, v57, s29, v139
    v_dot2_f32_bf16 v140, v58, s28, v140
    v_dot2_f32_bf16 v141, v58, s29, v141
    v_dot2_f32_bf16 v142, v59, s28, v142
    v_dot2_f32_bf16 v143, v59, s29, v143
    s_waitcnt vmcnt(2)
    v_dot2_f32_bf16 v136, v60, s28, v136
    v_dot2_f32_bf16 v137, v60, s29, v137
    v_dot2_f32_bf16 v138, v61, s28, v138
    v_dot2_f32_bf16 v139, v61, s29, v139
    v_dot2_f32_bf16 v140, v62, s28, v140
    v_dot2_f32_bf16 v141, v62, s29, v141
    v_dot2_f32_bf16 v142, v63, s28, v142
    v_dot2_f32_bf16 v143, v63, s29, v143
    s_waitcnt vmcnt(1)
    v_dot2_f32_bf16 v136, v64, s28, v136
    v_dot2_f32_bf16 v137, v64, s29, v137
    v_dot2_f32_bf16 v138, v65, s28, v138
    v_dot2_f32_bf16 v139, v65, s29, v139
    v_dot2_f32_bf16 v140, v66, s28, v140
    v_dot2_f32_bf16 v141, v66, s29, v141
    v_dot2_f32_bf16 v142, v67, s28, v142
    v_dot2_f32_bf16 v143, v67, s29, v143
    s_waitcnt vmcnt(0)
    v_dot2_f32_bf16 v136, v68, s28, v136
    v_dot2_f32_bf16 v137, v68, s29, v137
    v_dot2_f32_bf16 v138, v69, s28, v138
    v_dot2_f32_bf16 v139, v69, s29, v139
    v_dot2_f32_bf16 v140, v70, s28, v140
    v_dot2_f32_bf16 v141, v70, s29, v141
    v_dot2_f32_bf16 v142, v71, s28, v142
    v_dot2_f32_bf16 v143, v71, s29, v143
    s_nop 2
    v_pk_fma_f32 v[136:137], v[136:137], v[92:93], v[108:109] op_sel_hi:[1,0,1]
    v_pk_fma_f32 v[138:139], v[138:139], v[92:93], v[110:111] op_sel_hi:[1,0,1]
    v_pk_fma_f32 v[140:141], v[140:141], v[92:93], v[112:113] op_sel_hi:[1,0,1]
    v_pk_fma_f32 v[142:143], v[142:143], v[92:93], v[114:115] op_sel_hi:[1,0,1]
    v_cvt_pk_bf16_f32 v148, v136, v137
    v_cvt_pk_bf16_f32 v149, v138, v139
    v_cvt_pk_bf16_f32 v150, v140, v141
    v_cvt_pk_bf16_f32 v151, v142, v143
    ds_write_b16 v130, v148 offset:20480
    ds_write_b16_d16_hi v128, v148 offset:20484
    ds_write_b16 v128, v149 offset:20488
    ds_write_b16_d16_hi v128, v149 offset:20492
    ds_write_b16 v131, v150 offset:20480
    ds_write_b16_d16_hi v129, v150 offset:20488
    ds_write_b16 v129, v151 offset:20484
    ds_write_b16_d16_hi v129, v151 offset:20480
    s_waitcnt lgkmcnt(0)
    s_barrier
    ds_read_b128 v[8:11], v6 offset:20480
    ds_read_b128 v[12:15], v6 offset:20992
    ds_read_b128 v[16:19], v6 offset:21504
    s_waitcnt lgkmcnt(0)
    buffer_store_dwordx4 v[8:11], v7, s[16:19], 0 offen offset:0
    buffer_store_dwordx4 v[12:15], v7, s[16:19], 0 offen offset:512
    s_cmp_lg_u32 s20, 0
    s_cbranch_scc1 sf_kernel_t3
    buffer_store_dwordx4 v[16:19], v7, s[16:19], 0 offen offset:1024
sf_kernel_t3:
    s_endpgm

.globl row2_kernel
.p2align 8
.type row2_kernel,@function
row2_kernel:
    s_cmp_ge_u32 s2, 256
    s_cbranch_scc1 row2_kernel_end
    s_load_dwordx2 s[4:5], s[0:1], 80
    v_lshrrev_b32 v1, 3, v0
    v_and_b32 v2, 7, v0
    v_lshrrev_b32 v4, 6, v0
    v_lshlrev_b32 v3, 8, v1
    v_readfirstlane_b32 s20, v4
    v_lshl_add_u32 v3, v2, 4, v3
    v_and_b32 v4, 63, v0
    s_lshr_b32 s21, s2, 1
    s_mul_i32 s21, s21, 18432
    s_and_b32 s22, s2, 1
    s_lshl_b32 s22, s22, 7
    s_add_u32 s21, s21, s22
    s_and_b32 s23, s2, 127
    s_lshl_b32 s23, s23, 2
    s_lshr_b32 s24, s2, 7
    s_add_u32 s23, s23, s24
    s_mov_b32 s30, 0x3ae38e39
    s_mov_b32 s31, 0x3727c5ac
    s_mov_b32 s32, 0xffff0000
    s_mov_b32 s33, 0x3b638e39
    s_waitcnt lgkmcnt(0)
    s_add_u32 s8, s4, 214302720
    s_addc_u32 s9, s5, 0
    s_mov_b32 s10, 2359296
    s_mov_b32 s11, 0x20000
    s_add_u32 s12, s4, 217843712
    s_addc_u32 s13, s5, 0
    s_mov_b32 s14, 18874368
    s_mov_b32 s15, 0x20000
    buffer_load_dwordx4 v[8:11], v3, s[8:11], s21 offen
    v_lshlrev_b32 v5, 4, v0
    s_mul_i32 s26, s2, 9216
    s_add_u32 s25, s26, 0
    buffer_load_dwordx4 v[104:107], v5, s[12:15], s25 offen
    s_add_u32 s25, s26, 2359296
    buffer_load_dwordx4 v[108:111], v5, s[12:15], s25 offen
    s_add_u32 s25, s26, 4718592
    buffer_load_dwordx4 v[144:147], v5, s[12:15], s25 offen
    s_add_u32 s25, s26, 7077888
    buffer_load_dwordx4 v[148:151], v5, s[12:15], s25 offen
    s_add_u32 s25, s26, 9437184
    buffer_load_dwordx4 v[152:155], v5, s[12:15], s25 offen
    s_add_u32 s25, s26, 11796480
    buffer_load_dwordx4 v[156:159], v5, s[12:15], s25 offen
    s_add_u32 s25, s26, 14155776
    buffer_load_dwordx4 v[160:163], v5, s[12:15], s25 offen
    s_add_u32 s25, s26, 16515072
    buffer_load_dwordx4 v[164:167], v5, s[12:15], s25 offen
    s_add_u32 s16, s4, 211943424
    s_addc_u32 s17, s5, 0
    s_mov_b32 s18, 2359296
    s_mov_b32 s19, 0x20000
    s_add_u32 s36, s4, 216662016
    s_addc_u32 s37, s5, 0
    s_mov_b32 s38, 1181696
    s_mov_b32 s39, 0x20000
    s_cmp_lg_u32 s2, 255
    s_cbranch_scc1 row2_kernel_nz
    v_lshlrev_b32 v20, 3, v0
    v_mov_b32 v22, 0
    v_mov_b32 v23, 0
    s_add_u32 s44, s4, 236718080
    s_addc_u32 s45, s5, 0
    s_mov_b32 s46, 8192
    s_mov_b32 s47, 0x20000
    v_cmp_eq_u32 vcc, 384, v0
    v_mov_b32 v21, 0x10000
    v_cmp_gt_u32 s[48:49], s2, v0
    v_cndmask_b32 v22, v22, 1, vcc
    s_or_b64 vcc, vcc, s[48:49]
    s_nop 1
    v_cndmask_b32 v20, v21, v20, vcc
    buffer_store_dwordx2 v[22:23], v20, s[44:47], 0 offen
row2_kernel_nz:
    v_and_b32 v5, 15, v4
    s_lshl_b32 s26, s20, 4
    v_add_u32 v5, s26, v5
    v_lshrrev_b32 v6, 4, v4
    v_cmp_eq_u32 vcc, 0, v5
    v_mov_b32 v20, 144
    s_nop 0
    v_cndmask_b32 v5, v5, v20, vcc
    v_lshlrev_b32 v5, 1, v5
    v_lshlrev_b32 v6, 3, v6
    v_mul_u32_u24 v22, v5, v6
    v_lshlrev_b32 v23, 5, v5
    v_add_u32 v30, v22, v5
    v_add_u32 v44, v22, v23
    v_add_u32 v46, v44, v5
    v_cvt_f32_u32 v29, v22
    v_mul_f32 v29, 0x3ae38e39, v29
    v_fract_f32 v29, v29
    v_cvt_f32_u32 v31, v30
    v_mul_f32 v31, 0x3ae38e39, v31
    v_fract_f32 v31, v31
    v_cvt_f32_u32 v45, v44
    v_mul_f32 v45, 0x3ae38e39, v45
    v_fract_f32 v45, v45
    v_cvt_f32_u32 v47, v46
    v_mul_f32 v47, 0x3ae38e39, v47
    v_fract_f32 v47, v47
    v_cvt_f32_u32 v20, v5
    v_mul_f32 v20, 0x3ae38e39, v20
    v_fract_f32 v20, v20
    v_cvt_f32_u32 v21, v23
    v_mul_f32 v21, 0x3ae38e39, v21
    v_fract_f32 v21, v21
    v_cos_f32 v20, v20
    v_cos_f32 v21, v21
    v_cos_f32 v28, v29
    v_sin_f32 v29, -v29
    v_cos_f32 v30, v31
    v_sin_f32 v31, -v31
    v_cos_f32 v44, v45
    v_sin_f32 v45, -v45
    v_cos_f32 v46, v47
    v_sin_f32 v47, -v47
    v_add_f32 v20, v20, v20
    v_add_f32 v21, v21, v21
    v_pk_fma_f32 v[32:33], v[20:21], v[30:31], v[28:29] op_sel:[0,0,0] op_sel_hi:[0,1,1] neg_lo:[0,0,1] neg_hi:[0,0,1]
    v_pk_fma_f32 v[48:49], v[20:21], v[46:47], v[44:45] op_sel:[0,0,0] op_sel_hi:[0,1,1] neg_lo:[0,0,1] neg_hi:[0,0,1]
    v_pk_fma_f32 v[34:35], v[20:21], v[32:33], v[30:31] op_sel:[0,0,0] op_sel_hi:[0,1,1] neg_lo:[0,0,1] neg_hi:[0,0,1]
    v_pk_fma_f32 v[50:51], v[20:21], v[48:49], v[46:47] op_sel:[0,0,0] op_sel_hi:[0,1,1] neg_lo:[0,0,1] neg_hi:[0,0,1]
    v_pk_fma_f32 v[36:37], v[20:21], v[34:35], v[32:33] op_sel:[0,0,0] op_sel_hi:[0,1,1] neg_lo:[0,0,1] neg_hi:[0,0,1]
    v_pk_fma_f32 v[52:53], v[20:21], v[50:51], v[48:49] op_sel:[0,0,0] op_sel_hi:[0,1,1] neg_lo:[0,0,1] neg_hi:[0,0,1]
    v_pk_fma_f32 v[38:39], v[20:21], v[36:37], v[34:35] op_sel:[0,0,0] op_sel_hi:[0,1,1] neg_lo:[0,0,1] neg_hi:[0,0,1]
    v_pk_fma_f32 v[54:55], v[20:21], v[52:53], v[50:51] op_sel:[0,0,0] op_sel_hi:[0,1,1] neg_lo:[0,0,1] neg_hi:[0,0,1]
    v_pk_fma_f32 v[40:41], v[20:21], v[38:39], v[36:37] op_sel:[0,0,0] op_sel_hi:[0,1,1] neg_lo:[0,0,1] neg_hi:[0,0,1]
    v_pk_fma_f32 v[56:57], v[20:21], v[54:55], v[52:53] op_sel:[0,0,0] op_sel_hi:[0,1,1] neg_lo:[0,0,1] neg_hi:[0,0,1]
    v_pk_fma_f32 v[42:43], v[20:21], v[40:41], v[38:39] op_sel:[0,0,0] op_sel_hi:[0,1,1] neg_lo:[0,0,1] neg_hi:[0,0,1]
    v_pk_fma_f32 v[58:59], v[20:21], v[56:57], v[54:55] op_sel:[0,0,0] op_sel_hi:[0,1,1] neg_lo:[0,0,1] neg_hi:[0,0,1]
    v_cvt_pk_bf16_f32 v64, v28, v30
    v_cvt_pk_bf16_f32 v84, v29, v31
    v_cvt_pk_bf16_f32 v65, v32, v34
    v_cvt_pk_bf16_f32 v85, v33, v35
    v_cvt_pk_bf16_f32 v66, v36, v38
    v_cvt_pk_bf16_f32 v86, v37, v39
    v_cvt_pk_bf16_f32 v67, v40, v42
    v_cvt_pk_bf16_f32 v87, v41, v43
    v_pk_fma_f32 v[28:29], v[20:21], v[44:45], v[28:29] op_sel:[1,0,0] op_sel_hi:[1,1,1] neg_lo:[0,0,1] neg_hi:[0,0,1]
    v_pk_fma_f32 v[30:31], v[20:21], v[46:47], v[30:31] op_sel:[1,0,0] op_sel_hi:[1,1,1] neg_lo:[0,0,1] neg_hi:[0,0,1]
    v_pk_fma_f32 v[32:33], v[20:21], v[48:49], v[32:33] op_sel:[1,0,0] op_sel_hi:[1,1,1] neg_lo:[0,0,1] neg_hi:[0,0,1]
    v_pk_fma_f32 v[34:35], v[20:21], v[50:51], v[34:35] op_sel:[1,0,0] op_sel_hi:[1,1,1] neg_lo:[0,0,1] neg_hi:[0,0,1]
    v_pk_fma_f32 v[36:37], v[20:21], v[52:53], v[36:37] op_sel:[1,0,0] op_sel_hi:[1,1,1] neg_lo:[0,0,1] neg_hi:[0,0,1]
    v_pk_fma_f32 v[38:39], v[20:21], v[54:55], v[38:39] op_sel:[1,0,0] op_sel_hi:[1,1,1] neg_lo:[0,0,1] neg_hi:[0,0,1]
    v_pk_fma_f32 v[40:41], v[20:21], v[56:57], v[40:41] op_sel:[1,0,0] op_sel_hi:[1,1,1] neg_lo:[0,0,1] neg_hi:[0,0,1]
    v_pk_fma_f32 v[42:43], v[20:21], v[58:59], v[42:43] op_sel:[1,0,0] op_sel_hi:[1,1,1] neg_lo:[0,0,1] neg_hi:[0,0,1]
    v_cvt_pk_bf16_f32 v68, v44, v46
    v_cvt_pk_bf16_f32 v88, v45, v47
    v_cvt_pk_bf16_f32 v69, v48, v50
    v_cvt_pk_bf16_f32 v89, v49, v51
    v_cvt_pk_bf16_f32 v70, v52, v54
    v_cvt_pk_bf16_f32 v90, v53, v55
    v_cvt_pk_bf16_f32 v71, v56, v58
    v_cvt_pk_bf16_f32 v91, v57, v59
    v_pk_fma_f32 v[44:45], v[20:21], v[28:29], v[44:45] op_sel:[1,0,0] op_sel_hi:[1,1,1] neg_lo:[0,0,1] neg_hi:[0,0,1]
    v_pk_fma_f32 v[46:47], v[20:21], v[30:31], v[46:47] op_sel:[1,0,0] op_sel_hi:[1,1,1] neg_lo:[0,0,1] neg_hi:[0,0,1]
    v_pk_fma_f32 v[48:49], v[20:21], v[32:33], v[48:49] op_sel:[1,0,0] op_sel_hi:[1,1,1] neg_lo:[0,0,1] neg_hi:[0,0,1]
    v_pk_fma_f32 v[50:51], v[20:21], v[34:35], v[50:51] op_sel:[1,0,0] op_sel_hi:[1,1,1] neg_lo:[0,0,1] neg_hi:[0,0,1]
    v_pk_fma_f32 v[52:53], v[20:21], v[36:37], v[52:53] op_sel:[1,0,0] op_sel_hi:[1,1,1] neg_lo:[0,0,1] neg_hi:[0,0,1]
    v_pk_fma_f32 v[54:55], v[20:21], v[38:39], v[54:55] op_sel:[1,0,0] op_sel_hi:[1,1,1] neg_lo:[0,0,1] neg_hi:[0,0,1]
    v_pk_fma_f32 v[56:57], v[20:21], v[40:41], v[56:57] op_sel:[1,0,0] op_sel_hi:[1,1,1] neg_lo:[0,0,1] neg_hi:[0,0,1]
    v_pk_fma_f32 v[58:59], v[20:21], v[42:43], v[58:59] op_sel:[1,0,0] op_sel_hi:[1,1,1] neg_lo:[0,0,1] neg_hi:[0,0,1]
    v_cvt_pk_bf16_f32 v72, v28, v30
    v_cvt_pk_bf16_f32 v92, v29, v31
    v_cvt_pk_bf16_f32 v73, v32, v34
    v_cvt_pk_bf16_f32 v93, v33, v35
    v_cvt_pk_bf16_f32 v74, v36, v38
    v_cvt_pk_bf16_f32 v94, v37, v39
    v_cvt_pk_bf16_f32 v75, v40, v42
    v_cvt_pk_bf16_f32 v95, v41, v43
    v_pk_fma_f32 v[28:29], v[20:21], v[44:45], v[28:29] op_sel:[1,0,0] op_sel_hi:[1,1,1] neg_lo:[0,0,1] neg_hi:[0,0,1]
    v_pk_fma_f32 v[30:31], v[20:21], v[46:47], v[30:31] op_sel:[1,0,0] op_sel_hi:[1,1,1] neg_lo:[0,0,1] neg_hi:[0,0,1]
    v_pk_fma_f32 v[32:33], v[20:21], v[48:49], v[32:33] op_sel:[1,0,0] op_sel_hi:[1,1,1] neg_lo:[0,0,1] neg_hi:[0,0,1]
    v_pk_fma_f32 v[34:35], v[20:21], v[50:51], v[34:35] op_sel:[1,0,0] op_sel_hi:[1,1,1] neg_lo:[0,0,1] neg_hi:[0,0,1]
    v_pk_fma_f32 v[36:37], v[20:21], v[52:53], v[36:37] op_sel:[1,0,0] op_sel_hi:[1,1,1] neg_lo:[0,0,1] neg_hi:[0,0,1]
    v_pk_fma_f32 v[38:39], v[20:21], v[54:55], v[38:39] op_sel:[1,0,0] op_sel_hi:[1,1,1] neg_lo:[0,0,1] neg_hi:[0,0,1]
    v_pk_fma_f32 v[40:41], v[20:21], v[56:57], v[40:41] op_sel:[1,0,0] op_sel_hi:[1,1,1] neg_lo:[0,0,1] neg_hi:[0,0,1]
    v_pk_fma_f32 v[42:43], v[20:21], v[58:59], v[42:43] op_sel:[1,0,0] op_sel_hi:[1,1,1] neg_lo:[0,0,1] neg_hi:[0,0,1]
    v_cvt_pk_bf16_f32 v76, v44, v46
    v_cvt_pk_bf16_f32 v96, v45, v47
    v_cvt_pk_bf16_f32 v77, v48, v50
    v_cvt_pk_bf16_f32 v97, v49, v51
    v_cvt_pk_bf16_f32 v78, v52, v54
    v_cvt_pk_bf16_f32 v98, v53, v55
    v_cvt_pk_bf16_f32 v79, v56, v58
    v_cvt_pk_bf16_f32 v99, v57, v59
    v_cvt_pk_bf16_f32 v80, v28, v30
    v_cvt_pk_bf16_f32 v100, v29, v31
    v_cvt_pk_bf16_f32 v81, v32, v34
    v_cvt_pk_bf16_f32 v101, v33, v35
    v_cvt_pk_bf16_f32 v82, v36, v38
    v_cvt_pk_bf16_f32 v102, v37, v39
    v_cvt_pk_bf16_f32 v83, v40, v42
    v_cvt_pk_bf16_f32 v103, v41, v43
    s_waitcnt vmcnt(8)
    v_lshlrev_b32 v12, 16, v8
    v_and_b32 v13, s32, v8
    v_lshlrev_b32 v14, 16, v9
    v_and_b32 v15, s32, v9
    v_lshlrev_b32 v16, 16, v10
    v_and_b32 v17, s32, v10
    v_lshlrev_b32 v18, 16, v11
    v_and_b32 v19, s32, v11
    s_mov_b32 s28, 0x3f80
    s_mov_b32 s29, 0x3f800000
    s_waitcnt vmcnt(7)
    v_dot2_f32_bf16 v20, v104, s28, 0
    v_dot2_f32_bf16 v21, v104, s29, 0
    v_dot2_f32_bf16 v22, v105, s28, 0
    v_dot2_f32_bf16 v23, v105, s29, 0
    v_dot2_f32_bf16 v24, v106, s28, 0
    v_dot2_f32_bf16 v25, v106, s29, 0
    v_dot2_f32_bf16 v26, v107, s28, 0
    v_dot2_f32_bf16 v27, v107, s29, 0
    s_waitcnt vmcnt(6)
    v_dot2_f32_bf16 v20, v108, s28, v20
    v_dot2_f32_bf16 v21, v108, s29, v21
    v_dot2_f32_bf16 v22, v109, s28, v22
    v_dot2_f32_bf16 v23, v109, s29, v23
    v_dot2_f32_bf16 v24, v110, s28, v24
    v_dot2_f32_bf16 v25, v110, s29, v25
    v_dot2_f32_bf16 v26, v111, s28, v26
    v_dot2_f32_bf16 v27, v111, s29, v27
    v_and_b32 v5, 15, v4
    s_lshl_b32 s26, s20, 4
    v_add_u32 v5, s26, v5
    v_lshrrev_b32 v6, 4, v4
    v_lshl_add_u32 v5, v5, 1, 1
    v_lshlrev_b32 v6, 3, v6
    v_mul_u32_u24 v10, v5, v6
    v_lshlrev_b32 v11, 5, v5
    v_add_u32 v30, v10, v5
    v_add_u32 v44, v10, v11
    v_add_u32 v46, v44, v5
    v_cvt_f32_u32 v29, v10
    v_mul_f32 v29, 0x3ae38e39, v29
    v_fract_f32 v29, v29
    v_cvt_f32_u32 v31, v30
    v_mul_f32 v31, 0x3ae38e39, v31
    v_fract_f32 v31, v31
    v_cvt_f32_u32 v45, v44
    v_mul_f32 v45, 0x3ae38e39, v45
    v_fract_f32 v45, v45
    v_cvt_f32_u32 v47, v46
    v_mul_f32 v47, 0x3ae38e39, v47
    v_fract_f32 v47, v47
    v_cvt_f32_u32 v8, v5
    v_mul_f32 v8, 0x3ae38e39, v8
    v_fract_f32 v8, v8
    v_cvt_f32_u32 v9, v11
    v_mul_f32 v9, 0x3ae38e39, v9
    v_fract_f32 v9, v9
    v_cos_f32 v8, v8
    v_cos_f32 v9, v9
    v_cos_f32 v28, v29
    v_sin_f32 v29, -v29
    v_cos_f32 v30, v31
    v_sin_f32 v31, -v31
    v_cos_f32 v44, v45
    v_sin_f32 v45, -v45
    v_cos_f32 v46, v47
    v_sin_f32 v47, -v47
    v_add_f32 v8, v8, v8
    v_add_f32 v9, v9, v9
    v_pk_fma_f32 v[32:33], v[8:9], v[30:31], v[28:29] op_sel:[0,0,0] op_sel_hi:[0,1,1] neg_lo:[0,0,1] neg_hi:[0,0,1]
    v_pk_fma_f32 v[48:49], v[8:9], v[46:47], v[44:45] op_sel:[0,0,0] op_sel_hi:[0,1,1] neg_lo:[0,0,1] neg_hi:[0,0,1]
    v_pk_fma_f32 v[34:35], v[8:9], v[32:33], v[30:31] op_sel:[0,0,0] op_sel_hi:[0,1,1] neg_lo:[0,0,1] neg_hi:[0,0,1]
    v_pk_fma_f32 v[50:51], v[8:9], v[48:49], v[46:47] op_sel:[0,0,0] op_sel_hi:[0,1,1] neg_lo:[0,0,1] neg_hi:[0,0,1]
    v_pk_fma_f32 v[36:37], v[8:9], v[34:35], v[32:33] op_sel:[0,0,0] op_sel_hi:[0,1,1] neg_lo:[0,0,1] neg_hi:[0,0,1]
    v_pk_fma_f32 v[52:53], v[8:9], v[50:51], v[48:49] op_sel:[0,0,0] op_sel_hi:[0,1,1] neg_lo:[0,0,1] neg_hi:[0,0,1]
    v_pk_fma_f32 v[38:39], v[8:9], v[36:37], v[34:35] op_sel:[0,0,0] op_sel_hi:[0,1,1] neg_lo:[0,0,1] neg_hi:[0,0,1]
    v_pk_fma_f32 v[54:55], v[8:9], v[52:53], v[50:51] op_sel:[0,0,0] op_sel_hi:[0,1,1] neg_lo:[0,0,1] neg_hi:[0,0,1]
    v_pk_fma_f32 v[40:41], v[8:9], v[38:39], v[36:37] op_sel:[0,0,0] op_sel_hi:[0,1,1] neg_lo:[0,0,1] neg_hi:[0,0,1]
    v_pk_fma_f32 v[56:57], v[8:9], v[54:55], v[52:53] op_sel:[0,0,0] op_sel_hi:[0,1,1] neg_lo:[0,0,1] neg_hi:[0,0,1]
    v_pk_fma_f32 v[42:43], v[8:9], v[40:41], v[38:39] op_sel:[0,0,0] op_sel_hi:[0,1,1] neg_lo:[0,0,1] neg_hi:[0,0,1]
    v_pk_fma_f32 v[58:59], v[8:9], v[56:57], v[54:55] op_sel:[0,0,0] op_sel_hi:[0,1,1] neg_lo:[0,0,1] neg_hi:[0,0,1]
    v_cvt_pk_bf16_f32 v104, v28, v30
    v_cvt_pk_bf16_f32 v124, v29, v31
    v_cvt_pk_bf16_f32 v105, v32, v34
    v_cvt_pk_bf16_f32 v125, v33, v35
    v_cvt_pk_bf16_f32 v106, v36, v38
    v_cvt_pk_bf16_f32 v126, v37, v39
    v_cvt_pk_bf16_f32 v107, v40, v42
    v_cvt_pk_bf16_f32 v127, v41, v43
    v_pk_fma_f32 v[28:29], v[8:9], v[44:45], v[28:29] op_sel:[1,0,0] op_sel_hi:[1,1,1] neg_lo:[0,0,1] neg_hi:[0,0,1]
    v_pk_fma_f32 v[30:31], v[8:9], v[46:47], v[30:31] op_sel:[1,0,0] op_sel_hi:[1,1,1] neg_lo:[0,0,1] neg_hi:[0,0,1]
    v_pk_fma_f32 v[32:33], v[8:9], v[48:49], v[32:33] op_sel:[1,0,0] op_sel_hi:[1,1,1] neg_lo:[0,0,1] neg_hi:[0,0,1]
    v_pk_fma_f32 v[34:35], v[8:9], v[50:51], v[34:35] op_sel:[1,0,0] op_sel_hi:[1,1,1] neg_lo:[0,0,1] neg_hi:[0,0,1]
    v_pk_fma_f32 v[36:37], v[8:9], v[52:53], v[36:37] op_sel:[1,0,0] op_sel_hi:[1,1,1] neg_lo:[0,0,1] neg_hi:[0,0,1]
    v_pk_fma_f32 v[38:39], v[8:9], v[54:55], v[38:39] op_sel:[1,0,0] op_sel_hi:[1,1,1] neg_lo:[0,0,1] neg_hi:[0,0,1]
    v_pk_fma_f32 v[40:41], v[8:9], v[56:57], v[40:41] op_sel:[1,0,0] op_sel_hi:[1,1,1] neg_lo:[0,0,1] neg_hi:[0,0,1]
    v_pk_fma_f32 v[42:43], v[8:9], v[58:59], v[42:43] op_sel:[1,0,0] op_sel_hi:[1,1,1] neg_lo:[0,0,1] neg_hi:[0,0,1]
    v_cvt_pk_bf16_f32 v108, v44, v46
    v_cvt_pk_bf16_f32 v128, v45, v47
    v_cvt_pk_bf16_f32 v109, v48, v50
    v_cvt_pk_bf16_f32 v129, v49, v51
    v_cvt_pk_bf16_f32 v110, v52, v54
    v_cvt_pk_bf16_f32 v130, v53, v55
    v_cvt_pk_bf16_f32 v111, v56, v58
    v_cvt_pk_bf16_f32 v131, v57, v59
    v_pk_fma_f32 v[44:45], v[8:9], v[28:29], v[44:45] op_sel:[1,0,0] op_sel_hi:[1,1,1] neg_lo:[0,0,1] neg_hi:[0,0,1]
    v_pk_fma_f32 v[46:47], v[8:9], v[30:31], v[46:47] op_sel:[1,0,0] op_sel_hi:[1,1,1] neg_lo:[0,0,1] neg_hi:[0,0,1]
    v_pk_fma_f32 v[48:49], v[8:9], v[32:33], v[48:49] op_sel:[1,0,0] op_sel_hi:[1,1,1] neg_lo:[0,0,1] neg_hi:[0,0,1]
    v_pk_fma_f32 v[50:51], v[8:9], v[34:35], v[50:51] op_sel:[1,0,0] op_sel_hi:[1,1,1] neg_lo:[0,0,1] neg_hi:[0,0,1]
    v_pk_fma_f32 v[52:53], v[8:9], v[36:37], v[52:53] op_sel:[1,0,0] op_sel_hi:[1,1,1] neg_lo:[0,0,1] neg_hi:[0,0,1]
    v_pk_fma_f32 v[54:55], v[8:9], v[38:39], v[54:55] op_sel:[1,0,0] op_sel_hi:[1,1,1] neg_lo:[0,0,1] neg_hi:[0,0,1]
    v_pk_fma_f32 v[56:57], v[8:9], v[40:41], v[56:57] op_sel:[1,0,0] op_sel_hi:[1,1,1] neg_lo:[0,0,1] neg_hi:[0,0,1]
    v_pk_fma_f32 v[58:59], v[8:9], v[42:43], v[58:59] op_sel:[1,0,0] op_sel_hi:[1,1,1] neg_lo:[0,0,1] neg_hi:[0,0,1]
    v_cvt_pk_bf16_f32 v112, v28, v30
    v_cvt_pk_bf16_f32 v132, v29, v31
    v_cvt_pk_bf16_f32 v113, v32, v34
    v_cvt_pk_bf16_f32 v133, v33, v35
    v_cvt_pk_bf16_f32 v114, v36, v38
    v_cvt_pk_bf16_f32 v134, v37, v39
    v_cvt_pk_bf16_f32 v115, v40, v42
    v_cvt_pk_bf16_f32 v135, v41, v43
    v_pk_fma_f32 v[28:29], v[8:9], v[44:45], v[28:29] op_sel:[1,0,0] op_sel_hi:[1,1,1] neg_lo:[0,0,1] neg_hi:[0,0,1]
    v_pk_fma_f32 v[30:31], v[8:9], v[46:47], v[30:31] op_sel:[1,0,0] op_sel_hi:[1,1,1] neg_lo:[0,0,1] neg_hi:[0,0,1]
    v_pk_fma_f32 v[32:33], v[8:9], v[48:49], v[32:33] op_sel:[1,0,0] op_sel_hi:[1,1,1] neg_lo:[0,0,1] neg_hi:[0,0,1]
    v_pk_fma_f32 v[34:35], v[8:9], v[50:51], v[34:35] op_sel:[1,0,0] op_sel_hi:[1,1,1] neg_lo:[0,0,1] neg_hi:[0,0,1]
    v_pk_fma_f32 v[36:37], v[8:9], v[52:53], v[36:37] op_sel:[1,0,0] op_sel_hi:[1,1,1] neg_lo:[0,0,1] neg_hi:[0,0,1]
    v_pk_fma_f32 v[38:39], v[8:9], v[54:55], v[38:39] op_sel:[1,0,0] op_sel_hi:[1,1,1] neg_lo:[0,0,1] neg_hi:[0,0,1]
    v_pk_fma_f32 v[40:41], v[8:9], v[56:57], v[40:41] op_sel:[1,0,0] op_sel_hi:[1,1,1] neg_lo:[0,0,1] neg_hi:[0,0,1]
    v_pk_fma_f32 v[42:43], v[8:9], v[58:59], v[42:43] op_sel:[1,0,0] op_sel_hi:[1,1,1] neg_lo:[0,0,1] neg_hi:[0,0,1]
    v_cvt_pk_bf16_f32 v116, v44, v46
    v_cvt_pk_bf16_f32 v136, v45, v47
    v_cvt_pk_bf16_f32 v117, v48, v50
    v_cvt_pk_bf16_f32 v137, v49, v51
    v_cvt_pk_bf16_f32 v118, v52, v54
    v_cvt_pk_bf16_f32 v138, v53, v55
    v_cvt_pk_bf16_f32 v119, v56, v58
    v_cvt_pk_bf16_f32 v139, v57, v59
    v_cvt_pk_bf16_f32 v120, v28, v30
    v_cvt_pk_bf16_f32 v140, v29, v31
    v_cvt_pk_bf16_f32 v121, v32, v34
    v_cvt_pk_bf16_f32 v141, v33, v35
    v_cvt_pk_bf16_f32 v122, v36, v38
    v_cvt_pk_bf16_f32 v142, v37, v39
    v_cvt_pk_bf16_f32 v123, v40, v42
    v_cvt_pk_bf16_f32 v143, v41, v43
    v_and_b32 v50, 15, v4
    v_lshrrev_b32 v52, 4, v4
    v_min_u32 v51, 5, v50
    v_mul_u32_u24 v51, 336, v51
    v_lshl_add_u32 v55, v52, 4, v51
    v_and_b32 v53, 1, v50
    v_mul_u32_u24 v53, 589824, v53
    v_lshrrev_b32 v54, 1, v50
    v_lshl_add_u32 v53, v54, 7, v53
    v_lshl_add_u32 v5, v52, 3, v53
    v_lshlrev_b32 v6, 3, v52
    s_lshr_b32 s22, s2, 1
    s_and_b32 s22, s22, 1
    s_lshl_b32 s24, s23, 6
    s_add_u32 s25, s20, 0
    s_lshr_b32 s26, s25, 1
    s_lshl_b32 s26, s26, 16
    s_and_b32 s27, s25, 1
    s_xor_b32 s27, s27, s22
    s_lshl_b32 s27, s27, 5
    s_add_u32 s66, s26, s27
    s_add_u32 s66, s66, s24
    s_add_u32 s68, s66, 32768
    s_lshl_b32 s25, s25, 5
    s_add_u32 s70, s25, 1179648
    s_add_u32 s72, s25, 1180224
    s_add_u32 s25, s20, 9
    s_lshr_b32 s26, s25, 1
    s_lshl_b32 s26, s26, 16
    s_and_b32 s27, s25, 1
    s_xor_b32 s27, s27, s22
    s_lshl_b32 s27, s27, 5
    s_add_u32 s67, s26, s27
    s_add_u32 s67, s67, s24
    s_add_u32 s69, s67, 32768
    s_lshl_b32 s25, s25, 5
    s_add_u32 s71, s25, 1179648
    s_add_u32 s73, s25, 1180224
    v_cmp_gt_u32 s[40:41], 4, v50
    v_cmp_eq_u32 s[42:43], 4, v50
    v_mov_b32 v28, 0
    s_lshr_b32 s52, s20, 1
    s_and_b32 s52, s52, 3
    s_and_b32 s53, s52, 1
    s_lshr_b32 s54, s52, 1
    s_cmp_eq_u32 s54, 0
    s_cselect_b32 s55, 1.0, -1.0
    s_or_b32 s22, s2, s53
    s_cmp_eq_u32 s22, 0
    s_cselect_b32 s56, 0, 1.0
    s_or_b32 s22, s22, s54
    s_cmp_eq_u32 s22, 0
    s_cselect_b32 s57, 1.0, 0
    s_cmp_eq_u32 s54, 0
    s_cselect_b32 s58, 1.0, s56
    s_mov_b32 s59, s56
    s_lshl_b32 s60, s54, 3
    s_add_u32 s60, s60, s53
    s_mul_i32 s60, s60, 1168
    s_mul_i32 s22, s54, 12
    s_lshl_b32 s24, s53, 1
    s_add_u32 s24, s24, s22
    s_add_u32 s62, s24, s54
    s_add_u32 s61, s24, 1
    s_sub_u32 s61, s61, s54
    s_add_u32 s63, s22, s53
    s_add_u32 s63, s63, 4
    s_mul_i32 s61, s61, 336
    s_mul_i32 s62, s62, 336
    s_mul_i32 s63, s63, 336
    v_and_b32 v50, 127, v0
    v_min_u32 v50, 79, v50
    v_cmp_eq_u32 vcc, 0, v50
    v_sub_u32 v52, 144, v50
    v_mov_b32 v53, 288
    v_cndmask_b32 v51, v50, v53, vcc
    v_cndmask_b32 v52, v52, v28, vcc
    v_add_u32 v53, 144, v50
    v_sub_u32 v54, 287, v50
    v_lshl_add_u32 v44 , v51, 2, s60
    v_lshl_add_u32 v45 , v52, 2, s60
    v_lshl_add_u32 v46 , v53, 2, s60
    v_lshl_add_u32 v47 , v54, 2, s60
    s_movk_i32 s22, 72
    v_cmp_gt_u32 vcc, 72, v50
    v_cmp_eq_u32 s[64:65], s22, v50
    s_nop 0
    v_cndmask_b32 v49, 0, 1.0, vcc
    v_cndmask_b32 v48, v49, 0.5, s[64:65]
    v_lshl_add_u32 v52, v50, 2, s61
    v_lshl_add_u32 v53, v50, 2, s62
    v_lshl_add_u32 v54, v50, 2, s63
    v_mul_u32_u24 v50, 1168, v2
    v_lshl_add_u32 v51, v1, 4, v50
    v_lshlrev_b32 v41, 2, v2
    v_mul_u32_u24 v63, 48, v4
    v_mul_u32_u24 v7, 48, v2
    s_lshl_b32 s26, s20, 2
    v_lshrrev_b32 v28, 4, v4
    v_add_u32 v7, s26, v7
    v_mul_u32_u24 v29, 384, v28
    v_lshrrev_b32 v28, 1, v28
    v_add_u32 v62, v29, v7
    v_mul_u32_u24 v28, 384, v28
    v_add_u32 v7, v28, v7
    v_pk_add_f32 v[28:29], v[12:13], v[14:15]
    v_pk_add_f32 v[30:31], v[16:17], v[18:19]
    v_pk_add_f32 v[28:29], v[28:29], v[30:31]
    v_add_f32 v34, v28, v29
    v_pk_mul_f32 v[32:33], v[12:13], v[12:13]
    v_pk_fma_f32 v[32:33], v[14:15], v[14:15], v[32:33]
    v_pk_fma_f32 v[32:33], v[16:17], v[16:17], v[32:33]
    v_pk_fma_f32 v[32:33], v[18:19], v[18:19], v[32:33]
    v_add_f32 v35, v32, v33
    s_nop 1
    v_permlane32_swap_b32 v34, v35
    v_add_f32 v34, v34, v35
    v_mov_b32 v35, v34
    s_nop 1
    v_permlane16_swap_b32 v34, v35
    v_add_f32 v34, v34, v35
    s_nop 1
    v_add_f32_dpp v34, v34, v34 row_ror:8 row_mask:0xf bank_mask:0xf
    ds_write_b32 v7, v34 offset:37632
    s_waitcnt vmcnt(5)
    v_dot2_f32_bf16 v20, v144, s28, v20
    v_dot2_f32_bf16 v21, v144, s29, v21
    v_dot2_f32_bf16 v22, v145, s28, v22
    v_dot2_f32_bf16 v23, v145, s29, v23
    v_dot2_f32_bf16 v24, v146, s28, v24
    v_dot2_f32_bf16 v25, v146, s29, v25
    v_dot2_f32_bf16 v26, v147, s28, v26
    v_dot2_f32_bf16 v27, v147, s29, v27
    s_waitcnt vmcnt(4)
    v_dot2_f32_bf16 v20, v148, s28, v20
    v_dot2_f32_bf16 v21, v148, s29, v21
    v_dot2_f32_bf16 v22, v149, s28, v22
    v_dot2_f32_bf16 v23, v149, s29, v23
    v_dot2_f32_bf16 v24, v150, s28, v24
    v_dot2_f32_bf16 v25, v150, s29, v25
    v_dot2_f32_bf16 v26, v151, s28, v26
    v_dot2_f32_bf16 v27, v151, s29, v27
    s_waitcnt vmcnt(3)
    v_dot2_f32_bf16 v20, v152, s28, v20
    v_dot2_f32_bf16 v21, v152, s29, v21
    v_dot2_f32_bf16 v22, v153, s28, v22
    v_dot2_f32_bf16 v23, v153, s29, v23
    v_dot2_f32_bf16 v24, v154, s28, v24
    v_dot2_f32_bf16 v25, v154, s29, v25
    v_dot2_f32_bf16 v26, v155, s28, v26
    v_dot2_f32_bf16 v27, v155, s29, v27
    s_waitcnt vmcnt(2)
    v_dot2_f32_bf16 v20, v156, s28, v20
    v_dot2_f32_bf16 v21, v156, s29, v21
    v_dot2_f32_bf16 v22, v157, s28, v22
    v_dot2_f32_bf16 v23, v157, s29, v23
    v_dot2_f32_bf16 v24, v158, s28, v24
    v_dot2_f32_bf16 v25, v158, s29, v25
    v_dot2_f32_bf16 v26, v159, s28, v26
    v_dot2_f32_bf16 v27, v159, s29, v27
    s_waitcnt vmcnt(1)
    v_dot2_f32_bf16 v20, v160, s28, v20
    v_dot2_f32_bf16 v21, v160, s29, v21
    v_dot2_f32_bf16 v22, v161, s28, v22
    v_dot2_f32_bf16 v23, v161, s29, v23
    v_dot2_f32_bf16 v24, v162, s28, v24
    v_dot2_f32_bf16 v25, v162, s29, v25
    v_dot2_f32_bf16 v26, v163, s28, v26
    v_dot2_f32_bf16 v27, v163, s29, v27
    s_waitcnt vmcnt(0)
    v_dot2_f32_bf16 v20, v164, s28, v20
    v_dot2_f32_bf16 v21, v164, s29, v21
    v_dot2_f32_bf16 v22, v165, s28, v22
    v_dot2_f32_bf16 v23, v165, s29, v23
    v_dot2_f32_bf16 v24, v166, s28, v24
    v_dot2_f32_bf16 v25, v166, s29, v25
    v_dot2_f32_bf16 v26, v167, s28, v26
    v_dot2_f32_bf16 v27, v167, s29, v27
    s_nop 2
    v_pk_add_f32 v[28:29], v[20:21], v[22:23]
    v_pk_add_f32 v[30:31], v[24:25], v[26:27]
    v_pk_add_f32 v[28:29], v[28:29], v[30:31]
    v_add_f32 v38, v28, v29
    v_pk_mul_f32 v[32:33], v[20:21], v[20:21]
    v_pk_fma_f32 v[32:33], v[22:23], v[22:23], v[32:33]
    v_pk_fma_f32 v[32:33], v[24:25], v[24:25], v[32:33]
    v_pk_fma_f32 v[32:33], v[26:27], v[26:27], v[32:33]
    v_add_f32 v39, v32, v33
    v_pk_mul_f32 v[34:35], v[20:21], v[12:13]
    v_pk_fma_f32 v[34:35], v[22:23], v[14:15], v[34:35]
    v_pk_fma_f32 v[34:35], v[24:25], v[16:17], v[34:35]
    v_pk_fma_f32 v[34:35], v[26:27], v[18:19], v[34:35]
    v_add_f32 v36, v34, v35
    v_mov_b32 v37, 0
    s_nop 0
    v_permlane32_swap_b32 v38, v39
    v_permlane32_swap_b32 v36, v37
    v_add_f32 v38, v38, v39
    v_add_f32 v36, v36, v37
    s_nop 1
    v_permlane16_swap_b32 v38, v36
    v_add_f32 v38, v38, v36
    s_nop 1
    v_add_f32_dpp v38, v38, v38 row_ror:8 row_mask:0xf bank_mask:0xf
    ds_write_b32 v62, v38 offset:36096
    s_waitcnt lgkmcnt(0)
    s_barrier
    ds_read_b128 v[28:31], v63 offset:36096
    ds_read_b128 v[32:35], v63 offset:36112
    ds_read_b32 v36, v63 offset:36128
    s_waitcnt lgkmcnt(0)
    v_pk_add_f32 v[28:29], v[28:29], v[30:31]
    v_pk_add_f32 v[32:33], v[32:33], v[34:35]
    v_add_f32 v36, v36, v28
    v_add_f32 v32, v32, v33
    v_add_f32 v36, v36, v29
    v_add_f32 v36, v36, v32
    ds_bpermute_b32 v28, v41, v36 offset:128
    ds_bpermute_b32 v29, v41, v36 offset:160
    ds_bpermute_b32 v30, v41, v36 offset:0
    ds_bpermute_b32 v31, v41, v36 offset:64
    ds_bpermute_b32 v32, v41, v36 offset:32
    s_waitcnt lgkmcnt(0)
    v_pk_mul_f32 v[28:29], s[30:31], v[28:29] op_sel_hi:[0,1]
    v_pk_mul_f32 v[30:31], s[30:31], v[30:31] op_sel_hi:[0,1]
    v_fma_f32 v34, -v28, v28, v29
    v_mul_f32 v32, s33, v32
    v_max_f32 v34, 0, v34
    v_add_f32 v34, s31, v34
    v_rsq_f32 v34, v34
    s_nop 0
    v_fma_f32 v60, v34, v30, v28
    v_fma_f32 v31, v34, v31, v32
    v_fma_f32 v31, v34, v31, v29
    v_fma_f32 v31, -v60, v60, v31
    v_max_f32 v31, 0, v31
    v_add_f32 v31, s31, v31
    v_rsq_f32 v61, v31
    v_pk_fma_f32 v[12:13], v[20:21], v[34:35], v[12:13] op_sel_hi:[1,0,1]
    v_pk_fma_f32 v[14:15], v[22:23], v[34:35], v[14:15] op_sel_hi:[1,0,1]
    v_pk_fma_f32 v[16:17], v[24:25], v[34:35], v[16:17] op_sel_hi:[1,0,1]
    v_pk_fma_f32 v[18:19], v[26:27], v[34:35], v[18:19] op_sel_hi:[1,0,1]
    v_cvt_pk_bf16_f32 v56, v12, v13
    v_cvt_pk_bf16_f32 v57, v14, v15
    v_cvt_pk_bf16_f32 v58, v16, v17
    v_cvt_pk_bf16_f32 v59, v18, v19
    v_lshlrev_b32 v12, 16, v56
    v_and_b32 v13, s32, v56
    v_lshlrev_b32 v14, 16, v57
    v_and_b32 v15, s32, v57
    v_lshlrev_b32 v16, 16, v58
    v_and_b32 v17, s32, v58
    v_lshlrev_b32 v18, 16, v59
    v_and_b32 v19, s32, v59
    v_mul_f32 v60, v60, v61
    v_cmp_eq_u32 vcc, 0, v1
    v_mov_b32 v28, 0
    v_pk_fma_f32 v[12:13], v[12:13], v[60:61], v[60:61] op_sel:[0,1,0] op_sel_hi:[1,1,0] neg_lo:[0,0,1] neg_hi:[0,0,1]
    v_pk_fma_f32 v[14:15], v[14:15], v[60:61], v[60:61] op_sel:[0,1,0] op_sel_hi:[1,1,0] neg_lo:[0,0,1] neg_hi:[0,0,1]
    v_pk_fma_f32 v[16:17], v[16:17], v[60:61], v[60:61] op_sel:[0,1,0] op_sel_hi:[1,1,0] neg_lo:[0,0,1] neg_hi:[0,0,1]
    v_pk_fma_f32 v[18:19], v[18:19], v[60:61], v[60:61] op_sel:[0,1,0] op_sel_hi:[1,1,0] neg_lo:[0,0,1] neg_hi:[0,0,1]
    v_pk_add_f32 v[20:21], v[12:13], v[16:17]
    v_pk_add_f32 v[24:25], v[12:13], v[16:17] neg_lo:[0,1] neg_hi:[0,1]
    v_pk_add_f32 v[22:23], v[14:15], v[18:19]
    v_pk_add_f32 v[26:27], v[14:15], v[18:19] neg_lo:[0,1] neg_hi:[0,1]
    v_cndmask_b32 v20, v20, v12, vcc
    v_cndmask_b32 v24, v24, v28, vcc
    ds_write_b128 v51, v[20:23] offset:9344
    ds_write_b128 v51, v[24:27] offset:18688
    s_and_saveexec_b64 s[34:35], vcc
    s_cbranch_execz row2_kernel_no0
    ds_write_b32 v50, v16 offset:10496
    ds_write_b32 v50, v28 offset:19840
row2_kernel_no0:
    s_mov_b64 exec, s[34:35]
    s_waitcnt lgkmcnt(0)
    s_barrier
    ds_read_b32 v8, v44 offset:9344
    ds_read_b32 v9, v44 offset:11680
    ds_read_b32 v10, v44 offset:16352
    ds_read_b32 v11, v44 offset:14016
    ds_read_b32 v12, v45 offset:9344
    ds_read_b32 v13, v45 offset:11680
    ds_read_b32 v14, v45 offset:16352
    ds_read_b32 v15, v45 offset:14016
    ds_read_b32 v16, v46 offset:9344
    ds_read_b32 v17, v46 offset:11680
    ds_read_b32 v18, v46 offset:16352
    ds_read_b32 v19, v46 offset:14016
    ds_read_b32 v20, v47 offset:9344
    ds_read_b32 v21, v47 offset:11680
    ds_read_b32 v22, v47 offset:16352
    ds_read_b32 v23, v47 offset:14016
    s_waitcnt lgkmcnt(8)
    v_fma_f32 v24, s55, v12, v8
    v_fma_f32 v28, -s55, v12, v8
    v_fma_f32 v25, s55, v13, v9
    v_fma_f32 v29, -s55, v13, v9
    v_fma_f32 v26, s55, v14, v10
    v_fma_f32 v30, -s55, v14, v10
    v_fma_f32 v27, s55, v15, v11
    v_fma_f32 v31, -s55, v15, v11
    v_mul_f32 v24, v48, v24
    v_mul_f32 v28, v48, v28
    v_mul_f32 v25, v48, v25
    v_mul_f32 v29, v48, v29
    v_mul_f32 v26, v48, v26
    v_mul_f32 v30, v48, v30
    v_mul_f32 v27, v48, v27
    v_mul_f32 v31, v48, v31
    s_waitcnt lgkmcnt(0)
    v_fma_f32 v32, s55, v20, v16
    v_fma_f32 v36, -s55, v20, v16
    v_fma_f32 v33, s55, v21, v17
    v_fma_f32 v37, -s55, v21, v17
    v_fma_f32 v34, s55, v22, v18
    v_fma_f32 v38, -s55, v22, v18
    v_fma_f32 v35, s55, v23, v19
    v_fma_f32 v39, -s55, v23, v19
    v_mul_f32 v32, v49, v32
    v_mul_f32 v36, v49, v36
    v_mul_f32 v33, v49, v33
    v_mul_f32 v37, v49, v37
    v_mul_f32 v34, v49, v34
    v_mul_f32 v38, v49, v38
    v_mul_f32 v35, v49, v35
    v_mul_f32 v39, v49, v39
    v_fma_f32 v40, s55, v27, v24
    v_fma_f32 v10, s55, v26, v25
    v_sub_f32 v42, v24, v27
    v_sub_f32 v8, v40, v10
    v_mul_f32 v8, s56, v8
    v_fmac_f32 v8, s57, v42
    v_mul_f32 v9, s58, v40
    v_fmac_f32 v9, s59, v10
    v_fma_f32 v40, s55, v31, v28
    v_fma_f32 v13, s55, v30, v29
    v_sub_f32 v42, v28, v31
    v_sub_f32 v11, v40, v13
    v_mul_f32 v11, s56, v11
    v_fmac_f32 v11, s57, v42
    v_mul_f32 v12, s58, v40
    v_fmac_f32 v12, s59, v13
    v_fma_f32 v40, s55, v35, v32
    v_fma_f32 v16, s55, v34, v33
    v_sub_f32 v42, v32, v35
    v_sub_f32 v14, v40, v16
    v_mul_f32 v14, s56, v14
    v_fmac_f32 v14, s57, v42
    v_mul_f32 v15, s58, v40
    v_fmac_f32 v15, s59, v16
    v_fma_f32 v40, s55, v39, v36
    v_fma_f32 v19, s55, v38, v37
    v_sub_f32 v42, v36, v39
    v_sub_f32 v17, v40, v19
    v_mul_f32 v17, s56, v17
    v_fmac_f32 v17, s57, v42
    v_mul_f32 v18, s58, v40
    v_fmac_f32 v18, s59, v19
    v_cvt_pk_bf16_f32 v24, v8, v14
    ds_write_b32 v52, v24 offset:28032
    v_cvt_pk_bf16_f32 v25, v9, v15
    ds_write_b32 v53, v25 offset:28032
    v_cvt_pk_bf16_f32 v26, v10, v16
    ds_write_b32 v54, v26 offset:28032
    v_cvt_pk_bf16_f32 v27, v11, v17
    ds_write_b32 v52, v27 offset:30048
    v_cvt_pk_bf16_f32 v28, v12, v18
    ds_write_b32 v53, v28 offset:30048
    v_cvt_pk_bf16_f32 v29, v13, v19
    ds_write_b32 v54, v29 offset:30048
    s_waitcnt lgkmcnt(0)
    s_barrier
    ds_read_b128 v[8:11], v55 offset:28032
    ds_read_b128 v[12:15], v55 offset:28096
    ds_read_b128 v[16:19], v55 offset:28160
    ds_read_b128 v[20:23], v55 offset:28224
    ds_read_b128 v[24:27], v55 offset:28288
    ds_read_b128 v[28:31], v55 offset:30048
    ds_read_b128 v[32:35], v55 offset:30112
    ds_read_b128 v[36:39], v55 offset:30176
    ds_read_b128 v[40:43], v55 offset:30240
    ds_read_b128 v[44:47], v55 offset:30304
    s_waitcnt lgkmcnt(5)
    v_mfma_f32_16x16x32_bf16 v[144:147], v[64:67], v[8:11], 0
    v_mfma_f32_16x16x32_bf16 v[144:147], v[68:71], v[12:15], v[144:147]
    v_mfma_f32_16x16x32_bf16 v[144:147], v[72:75], v[16:19], v[144:147]
    v_mfma_f32_16x16x32_bf16 v[144:147], v[76:79], v[20:23], v[144:147]
    v_mfma_f32_16x16x32_bf16 v[144:147], v[80:83], v[24:27], v[144:147]
    s_waitcnt lgkmcnt(0)
    v_mfma_f32_16x16x32_bf16 v[148:151], v[104:107], v[28:31], 0
    v_mfma_f32_16x16x32_bf16 v[148:151], v[108:111], v[32:35], v[148:151]
    v_mfma_f32_16x16x32_bf16 v[148:151], v[112:115], v[36:39], v[148:151]
    v_mfma_f32_16x16x32_bf16 v[148:151], v[116:119], v[40:43], v[148:151]
    v_mfma_f32_16x16x32_bf16 v[148:151], v[120:123], v[44:47], v[148:151]
    ds_read_b128 v[8:11], v55 offset:32064
    ds_read_b128 v[12:15], v55 offset:32128
    ds_read_b128 v[16:19], v55 offset:32192
    ds_read_b128 v[20:23], v55 offset:32256
    ds_read_b128 v[24:27], v55 offset:32320
    ds_read_b128 v[28:31], v55 offset:34080
    ds_read_b128 v[32:35], v55 offset:34144
    ds_read_b128 v[36:39], v55 offset:34208
    ds_read_b128 v[40:43], v55 offset:34272
    ds_read_b128 v[44:47], v55 offset:34336
    s_waitcnt lgkmcnt(5)
    v_mfma_f32_16x16x32_bf16 v[152:155], v[84:87], v[8:11], 0
    v_mfma_f32_16x16x32_bf16 v[152:155], v[88:91], v[12:15], v[152:155]
    v_mfma_f32_16x16x32_bf16 v[152:155], v[92:95], v[16:19], v[152:155]
    v_mfma_f32_16x16x32_bf16 v[152:155], v[96:99], v[20:23], v[152:155]
    v_mfma_f32_16x16x32_bf16 v[152:155], v[100:103], v[24:27], v[152:155]
    s_waitcnt lgkmcnt(0)
    v_mfma_f32_16x16x32_bf16 v[156:159], v[124:127], v[28:31], 0
    v_mfma_f32_16x16x32_bf16 v[156:159], v[128:131], v[32:35], v[156:159]
    v_mfma_f32_16x16x32_bf16 v[156:159], v[132:135], v[36:39], v[156:159]
    v_mfma_f32_16x16x32_bf16 v[156:159], v[136:139], v[40:43], v[156:159]
    v_mfma_f32_16x16x32_bf16 v[156:159], v[140:143], v[44:47], v[156:159]
    buffer_store_dwordx4 v[56:59], v3, s[16:19], s21 offen sc1
    s_mov_b64 vcc, s[40:41]
    s_mov_b64 s[64:65], s[42:43]
    s_nop 7
    v_cvt_pk_bf16_f32 v160, v144, v145
    v_cvt_pk_bf16_f32 v161, v146, v147
    v_cvt_pk_bf16_f32 v162, v148, v149
    v_cvt_pk_bf16_f32 v163, v150, v151
    v_cvt_pk_bf16_f32 v164, v152, v153
    v_cvt_pk_bf16_f32 v165, v154, v155
    v_cvt_pk_bf16_f32 v166, v156, v157
    v_cvt_pk_bf16_f32 v167, v158, v159
    s_mov_b64 exec, vcc
    buffer_store_dwordx2 v[160:161], v5, s[36:39], s66 offen
    buffer_store_dwordx2 v[162:163], v5, s[36:39], s67 offen
    buffer_store_dwordx2 v[164:165], v5, s[36:39], s68 offen
    buffer_store_dwordx2 v[166:167], v5, s[36:39], s69 offen
    s_cmp_lg_u32 s2, 0
    s_cbranch_scc1 row2_kernel_fin
    s_mov_b64 exec, s[64:65]
    buffer_store_dwordx2 v[160:161], v6, s[36:39], s70 offen
    buffer_store_dwordx2 v[162:163], v6, s[36:39], s71 offen
    buffer_store_dwordx2 v[164:165], v6, s[36:39], s72 offen
    buffer_store_dwordx2 v[166:167], v6, s[36:39], s73 offen
row2_kernel_fin:
row2_kernel_end:
    s_endpgm

.section .rodata,"a"
.p2align 6
.amdhsa_kernel row1_kernel
  .amdhsa_next_free_vgpr 168
  .amdhsa_next_free_sgpr 100
  .amdhsa_accum_offset 168
  .amdhsa_group_segment_fixed_size 0
  .amdhsa_kernarg_size 88
  .amdhsa_user_sgpr_count 2
  .amdhsa_user_sgpr_kernarg_segment_ptr 1
  .amdhsa_system_sgpr_workgroup_id_x 1
  .amdhsa_float_denorm_mode_32 3
.end_amdhsa_kernel

.p2align 6
.amdhsa_kernel sf_kernel
  .amdhsa_next_free_vgpr 352
  .amdhsa_next_free_sgpr 100
  .amdhsa_accum_offset 256
  .amdhsa_group_segment_fixed_size 0
  .amdhsa_kernarg_size 88
  .amdhsa_user_sgpr_count 2
  .amdhsa_user_sgpr_kernarg_segment_ptr 1
  .amdhsa_system_sgpr_workgroup_id_x 1
  .amdhsa_float_denorm_mode_32 3
.end_amdhsa_kernel

.p2align 6
.amdhsa_kernel row2_kernel
  .amdhsa_next_free_vgpr 168
  .amdhsa_next_free_sgpr 100
  .amdhsa_accum_offset 168
  .amdhsa_group_segment_fixed_size 0
  .amdhsa_kernarg_size 88
  .amdhsa_user_sgpr_count 2
  .amdhsa_user_sgpr_kernarg_segment_ptr 1
  .amdhsa_system_sgpr_workgroup_id_x 1
  .amdhsa_float_denorm_mode_32 3
.end_amdhsa_kernel
```
